```python
import torch

def _softmax(x, axis=-1):
    return torch.softmax(x, dim=axis)
def _gelu(x):
    return torch.nn.functional.gelu(x, approximate="tanh")
def _silu(x):
    return torch.nn.functional.silu(x)
def _sigmoid(x):
    return torch.sigmoid(x)
def _layernorm(x, axis=-1, eps=1e-5):
    m = x.mean(dim=axis, keepdim=True)
    v = x.var(dim=axis, keepdim=True, unbiased=False)
    return (x - m) / torch.sqrt(v + eps)
def _scatter_add(tgt, idx, src, axis=0):
    return tgt.clone().index_add_(axis, idx, src)
def _segment_sum(src, seg, n):
    out = torch.zeros((n,) + src.shape[1:], dtype=src.dtype)
    return out.index_add_(0, seg, src)
def _pad(x, pw):
    flat = tuple(v for pair in reversed(pw) for v in pair)
    return torch.nn.functional.pad(x, flat)

kernel_name = 'recurrent_scan__ssm_conv_h3__glu_gated_geglu__prompt'

def setup_inputs():

    _w = (lambda a: (lambda t: t.to(torch.bfloat16) if t.is_floating_point() else t)(torch.as_tensor(a)))
    def _A_setup():
        B, S, D = 1, 2048, 512
        ks = 4
        return {
            "q": _w((lambda *s: torch.randn(*s, dtype=torch.bfloat16) * 0.05)(B, S, D)),
            "k": _w((lambda *s: torch.randn(*s, dtype=torch.bfloat16) * 0.8)(B, S, D)),
            "v": _w((lambda *s: torch.randn(*s, dtype=torch.bfloat16) * 0.8)(B, S, D)),
            "shift_k": _w((lambda *s: torch.randn(*s, dtype=torch.bfloat16) * 0.8)(D, ks) * 0.5),
            "ssm_k": _w((lambda *s: torch.randn(*s, dtype=torch.bfloat16) * 1.6)(D, S) * (1.0 / S ** 0.5)),
            "ssm_D": _w((lambda *s: torch.randn(*s, dtype=torch.bfloat16) * 0.8)(D)),
        }
    _A_in = _A_setup()

    def _B_setup():
        B, S, Dm, Df = 1, 2048, 512, 1792
        return {
            "x": _w((lambda *s: torch.randn(*s, dtype=torch.bfloat16) * 0.05)(B, S, Dm)),
            "w_gate": _w((lambda *s: torch.randn(*s, dtype=torch.bfloat16) * 0.2)(Dm, Df) * (Dm ** -0.5)),
            "w_up": _w((lambda *s: torch.randn(*s, dtype=torch.bfloat16) * 0.2)(Dm, Df) * (Dm ** -0.5)),
            "w_down": _w((lambda *s: torch.randn(*s, dtype=torch.bfloat16) * 0.2)(Df, Dm) * (Df ** -0.5)),
        }
    _B_in = _B_setup()

    return {
        "A_q": _A_in["q"],
        "A_k": _A_in["k"],
        "A_v": _A_in["v"],
        "A_shift_k": _A_in["shift_k"],
        "A_ssm_k": _A_in["ssm_k"],
        "A_ssm_D": _A_in["ssm_D"],
        "B_x": _B_in["x"],
        "B_w_gate": _B_in["w_gate"],
        "B_w_up": _B_in["w_up"],
        "B_w_down": _B_in["w_down"],
    }

def reference(A_q, A_k, A_v, A_shift_k, A_ssm_k, A_ssm_D, B_x, B_w_gate, B_w_up, B_w_down):
    def _A_ref(q, k, v, shift_k, ssm_k, ssm_D):
        B, S, D = q.shape
        ks = shift_k.shape[-1]
        k_pad = _pad(k, ((0, 0), (ks - 1, 0), (0, 0)))
        k_shift = torch.zeros_like(k)
        for t in range(ks):
            k_shift = k_shift + k_pad[:, t:t + S, :] * shift_k[:, ks - 1 - t][None, None, :]
        kv = k_shift * v
        L = 2 * S
        kv_pad = _pad(kv, ((0, 0), (0, S), (0, 0)))
        kf_pad = _pad(ssm_k, ((0, 0), (0, S)))
        kv_f = (lambda x, axes=(-2,-1): torch.fft.rfft2(x.float(), dim=axes))(kv_pad[:, None, :, :], axes=(1, 2))
        kf_f = (lambda x, axes=(-2,-1): torch.fft.rfft2(x.float(), dim=axes))(kf_pad[:, None, :], axes=(1, 2))
        kf_f = (lambda x, *d: x.permute(*d))(kf_f, 1, 2, 0)
        y_f = kv_f * kf_f[None, :, :, :]
        y = (lambda x, s, axes=(-2,-1): torch.fft.irfft2(x, s=s, dim=axes).to(torch.bfloat16))(y_f, (1, L), axes=(1, 2))[:, 0, :S, :]
        y = y + kv * ssm_D[None, None, :]
        return q * y

    def _B_ref(x, w_gate, w_up, w_down):
        g = torch.einsum("bsd,df->bsf", x, w_gate)
        u = torch.einsum("bsd,df->bsf", x, w_up)
        h = _gelu(g) * u
        return torch.einsum("bsf,fd->bsd", h, w_down)

    x = A_q
    xn = _layernorm(x, axis=-1)
    s = _A_ref(xn, A_k, A_v, A_shift_k, A_ssm_k, A_ssm_D)
    g = _silu(_B_ref(xn, B_w_gate, B_w_up, B_w_down))
    return x + s * g
```

```asm
; @launch grid=(256,1,1) block=(512,1,1) lds=163840
.amdgcn_target "amdgcn-amd-amdhsa--gfx950"
.text
.globl recurrent_scan__ssm_conv_h3__glu_gated_geglu__prompt_kernel
.p2align 8
.type recurrent_scan__ssm_conv_h3__glu_gated_geglu__prompt_kernel,@function
recurrent_scan__ssm_conv_h3__glu_gated_geglu__prompt_kernel:
    s_cmp_ge_u32 s2, 256
    s_cbranch_scc1 L_exit
    s_load_dwordx2 s[20:21], s[0:1], 56
    s_load_dwordx2 s[24:25], s[0:1], 64
    s_load_dwordx2 s[4:5], s[0:1], 0
    v_lshrrev_b32 v1, 6, v0
    s_lshr_b32 s51, s2, 3
    v_readfirstlane_b32 s49, v1
    v_and_b32 v0, 63, v0
    s_cmp_lg_u32 s49, 0
    s_cbranch_scc1 L_nopf
    s_getpc_b64 s[68:69]
L_pc:
    s_sub_u32 s68, s68, L_pc-recurrent_scan__ssm_conv_h3__glu_gated_geglu__prompt_kernel
    s_subb_u32 s69, s69, 0
    v_and_b32 v1, 15, v0
    v_lshlrev_b32 v1, 5, v1
    v_add_u32 v1, s51, v1
    v_lshlrev_b32 v1, 7, v1
    v_min_u32 v1, L_code_end-recurrent_scan__ssm_conv_h3__glu_gated_geglu__prompt_kernel-4, v1
    global_load_dword v255, v1, s[68:69]
L_nopf:
    s_bfm_b32 s7, 1, 17
    s_bfm_b32 s6, 1, 21
    s_and_b32 s48, s49, 3
    s_and_b32 s50, s2, 7
    s_and_b32 s66, s50, 1
    s_lshl_b32 s65, s66, 2
    s_lshr_b32 s3, s50, 1
    s_and_b32 s67, s51, 3
    s_lshr_b32 s56, s51, 2
    s_add_u32 s52, s65, s67
    s_lshl_b32 s52, s52, 8
    s_mul_i32 s53, s3, 7
    s_add_u32 s53, s53, s56
    s_mul_i32 s54, s67, 4
    s_mul_i32 s66, s66, 2
    s_add_u32 s54, s54, s66
    s_lshl_b32 s61, s48, 10
    s_lshl_b32 s62, s48, 12
    s_lshl_b32 s63, s48, 13
    s_cmp_ge_u32 s51, 28
    s_cbranch_scc1 L_role_p
    s_cmp_lt_u32 s49, 4
    s_cbranch_scc1 L_GA
L_GB:
    v_lshrrev_b32 v13, 3, v0
    v_and_b32 v14, 7, v0
    v_bfe_u32 v15, v0, 4, 1
    v_lshlrev_b32 v15, 1, v15
    v_xor_b32 v15, v15, v14
    v_mul_u32_u24 v1, 3584, v13
    v_lshl_add_u32 v1, v15, 4, v1
    v_xor_b32 v2, 64, v1
    s_lshl_b32 s65, s48, 2
    v_lshrrev_b32 v15, 1, v13
    v_add_u32 v15, s65, v15
    v_and_b32 v15, 7, v15
    v_xor_b32 v15, v15, v14
    v_lshlrev_b32 v3, 10, v13
    v_lshl_add_u32 v3, v15, 4, v3
    s_mul_i32 s71, s48, 57344
    s_lshl_b32 s65, s53, 7
    s_add_u32 s71, s71, s65
    s_add_u32 s69, s3, 0
    s_and_b32 s69, s69, 3
    s_lshl_b32 s69, s69, 6
    s_add_u32 s69, s69, s52
    s_lshl_b32 s69, s69, 10
    s_add_u32 s69, s69, s63
    s_mov_b32 s22, 1835008
    s_mov_b32 s23, s7
    s_mov_b64 s[26:27], s[22:23]
    s_waitcnt lgkmcnt(0)
    s_add_u32 s70, s54, 0
    s_and_b32 s70, s70, 7
    s_mul_i32 s46, s70, 229376
    s_add_u32 m0, s62, 92160
    s_add_u32 s46, s46, s71
    buffer_load_dwordx4 v1, s[20:23], s46 offen sc1 lds
    s_add_u32 m0, s62, 94208
    s_lshl_b32 s70, s70, 7
    buffer_load_dwordx4 v1, s[24:27], s46 offen sc1 lds
    s_add_u32 m0, s62, 93184
    s_add_u32 s46, s46, 28672
    buffer_load_dwordx4 v2, s[20:23], s46 offen sc1 lds
    s_add_u32 m0, s62, 95232
    s_add_u32 s70, s70, s69
    buffer_load_dwordx4 v2, s[24:27], s46 offen sc1 lds
    s_add_u32 m0, s61, 108544
    s_add_u32 s46, s70, 32768
    buffer_load_dwordx4 v3, s[4:7], s70 offen sc1 lds
    s_add_u32 m0, s61, 112640
    s_nop 0
    buffer_load_dwordx4 v3, s[4:7], s46 offen sc1 lds
    s_load_dwordx2 s[8:9], s[0:1], 96
    s_load_dwordx2 s[12:13], s[0:1], 72
    s_load_dwordx2 s[40:41], s[0:1], 32
    s_add_u32 s70, s54, 1
    s_and_b32 s70, s70, 7
    s_mul_i32 s46, s70, 229376
    s_add_u32 m0, s62, 116736
    s_add_u32 s46, s46, s71
    buffer_load_dwordx4 v1, s[20:23], s46 offen sc1 lds
    s_add_u32 m0, s62, 118784
    s_lshl_b32 s70, s70, 7
    buffer_load_dwordx4 v1, s[24:27], s46 offen sc1 lds
    s_add_u32 m0, s62, 117760
    s_add_u32 s46, s46, 28672
    buffer_load_dwordx4 v2, s[20:23], s46 offen sc1 lds
    s_add_u32 m0, s62, 119808
    s_add_u32 s70, s70, s69
    buffer_load_dwordx4 v2, s[24:27], s46 offen sc1 lds
    s_add_u32 m0, s61, 133120
    s_add_u32 s46, s70, 32768
    buffer_load_dwordx4 v3, s[4:7], s70 offen sc1 lds
    s_add_u32 m0, s61, 137216
    s_nop 0
    buffer_load_dwordx4 v3, s[4:7], s46 offen sc1 lds
    s_waitcnt lgkmcnt(0)
    s_load_dword s47, s[8:9], 0
    v_lshlrev_b32 v5, 4, v0
    s_lshl_b32 s65, s54, 3
    v_add_u32 v4, s65, v0
    v_and_b32 v4, 63, v4
    v_lshlrev_b32 v4, 4, v4
    s_mul_i32 s64, s48, 8448
    v_lshrrev_b32 v7, 2, v0
    v_min_u32 v7, 1, v7
    v_lshlrev_b32 v7, 28, v7
    v_add_lshl_u32 v7, v7, v0, 2
    s_lshl_b32 s44, s53, 7
    s_add_u32 s44, s44, 262144
    s_mov_b32 s10, 12582912
    s_mov_b32 s11, 0x00020000
    s_mov_b32 s14, 1835008
    s_mov_b32 s15, 0x00020000
    s_mov_b32 s42, 2097152
    s_mov_b32 s43, 0x00020000
    s_add_u32 s0, s2, 32
    s_and_b32 s0, s0, 255
    s_lshr_b32 s55, s52, 6
    s_add_u32 s65, s3, 0
    s_and_b32 s65, s65, 3
    s_add_u32 s55, s55, s65
    s_xor_b32 s56, s56, 4
    v_min_u32 v12, 1, v0
    v_lshlrev_b32 v12, 30, v12
    s_and_b32 s68, s50, 1
    s_lshl_b32 s68, s68, 2
    s_mul_i32 s65, s68, 37
    s_lshr_b32 s65, s65, 8
    s_mul_i32 s65, s65, 7
    s_sub_u32 s68, s68, s65
    s_add_u32 s65, s48, 0
    s_mul_i32 s66, s65, 37
    s_lshr_b32 s66, s66, 8
    s_mul_i32 s67, s66, 7
    s_sub_u32 s65, s65, s67
    s_add_u32 s65, s65, s68
    s_sub_u32 s67, s65, 7
    s_cmp_ge_u32 s65, 7
    s_cselect_b32 s65, s67, s65
    s_sub_u32 s66, s55, s66
    s_and_b32 s66, s66, 3
    s_mul_i32 s66, s66, 7
    s_add_u32 s57, s65, s66
    s_add_u32 s65, s48, 4
    s_mul_i32 s66, s65, 37
    s_lshr_b32 s66, s66, 8
    s_mul_i32 s67, s66, 7
    s_sub_u32 s65, s65, s67
    s_add_u32 s65, s65, s68
    s_sub_u32 s67, s65, 7
    s_cmp_ge_u32 s65, 7
    s_cselect_b32 s65, s67, s65
    s_sub_u32 s66, s55, s66
    s_and_b32 s66, s66, 3
    s_mul_i32 s66, s66, 7
    s_add_u32 s58, s65, s66
    s_add_u32 s65, s48, 8
    s_mul_i32 s66, s65, 37
    s_lshr_b32 s66, s66, 8
    s_mul_i32 s67, s66, 7
    s_sub_u32 s65, s65, s67
    s_add_u32 s65, s65, s68
    s_sub_u32 s67, s65, 7
    s_cmp_ge_u32 s65, 7
    s_cselect_b32 s65, s67, s65
    s_sub_u32 s66, s55, s66
    s_and_b32 s66, s66, 3
    s_mul_i32 s66, s66, 7
    s_add_u32 s59, s65, s66
    s_add_u32 s65, s48, 12
    s_mul_i32 s66, s65, 37
    s_lshr_b32 s66, s66, 8
    s_mul_i32 s67, s66, 7
    s_sub_u32 s65, s65, s67
    s_add_u32 s65, s65, s68
    s_sub_u32 s67, s65, 7
    s_cmp_ge_u32 s65, 7
    s_cselect_b32 s65, s67, s65
    s_sub_u32 s66, s55, s66
    s_and_b32 s66, s66, 3
    s_mul_i32 s66, s66, 7
    s_add_u32 s60, s65, s66
    s_add_u32 s65, s48, 16
    s_mul_i32 s66, s65, 37
    s_lshr_b32 s66, s66, 8
    s_mul_i32 s67, s66, 7
    s_sub_u32 s65, s65, s67
    s_add_u32 s65, s65, s68
    s_sub_u32 s67, s65, 7
    s_cmp_ge_u32 s65, 7
    s_cselect_b32 s65, s67, s65
    s_sub_u32 s66, s55, s66
    s_and_b32 s66, s66, 3
    s_mul_i32 s66, s66, 7
    s_add_u32 s37, s65, s66
    s_add_u32 s65, s48, 20
    s_mul_i32 s66, s65, 37
    s_waitcnt vmcnt(6)
    s_barrier
    s_add_u32 s70, s54, 2
    s_and_b32 s70, s70, 7
    s_mul_i32 s46, s70, 229376
    s_add_u32 m0, s62, 67584
    s_add_u32 s46, s46, s71
    buffer_load_dwordx4 v1, s[20:23], s46 offen sc1 lds
    s_lshr_b32 s66, s66, 8
    s_mul_i32 s67, s66, 7
    s_sub_u32 s65, s65, s67
    s_add_u32 s65, s65, s68
    s_sub_u32 s67, s65, 7
    s_cmp_ge_u32 s65, 7
    s_cselect_b32 s65, s67, s65
    s_sub_u32 s66, s55, s66
    s_add_u32 m0, s62, 69632
    s_lshl_b32 s70, s70, 7
    buffer_load_dwordx4 v1, s[24:27], s46 offen sc1 lds
    s_and_b32 s66, s66, 3
    s_mul_i32 s66, s66, 7
    s_add_u32 s38, s65, s66
    s_add_u32 s65, s48, 24
    s_mul_i32 s66, s65, 37
    s_lshr_b32 s66, s66, 8
    s_mul_i32 s67, s66, 7
    s_sub_u32 s65, s65, s67
    s_add_u32 m0, s62, 68608
    s_add_u32 s46, s46, 28672
    buffer_load_dwordx4 v2, s[20:23], s46 offen sc1 lds
    s_add_u32 s65, s65, s68
    s_sub_u32 s67, s65, 7
    s_cmp_ge_u32 s65, 7
    s_cselect_b32 s65, s67, s65
    s_sub_u32 s66, s55, s66
    s_and_b32 s66, s66, 3
    s_mul_i32 s66, s66, 7
    s_add_u32 s39, s65, s66
    s_add_u32 m0, s62, 70656
    s_add_u32 s70, s70, s69
    buffer_load_dwordx4 v2, s[24:27], s46 offen sc1 lds
    s_lshl_b32 s65, s56, 7
    s_sub_u32 s65, s65, 8192
    s_lshl_b32 s28, s57, 16
    s_add_u32 s28, s28, s65
    s_lshl_b32 s29, s58, 16
    s_add_u32 s29, s29, s65
    s_lshl_b32 s30, s59, 16
    s_add_u32 s30, s30, s65
    s_add_u32 m0, s61, 83968
    s_add_u32 s46, s70, 32768
    buffer_load_dwordx4 v3, s[4:7], s70 offen sc1 lds
    s_lshl_b32 s31, s60, 16
    s_add_u32 s31, s31, s65
    s_lshl_b32 s32, s37, 16
    s_add_u32 s32, s32, s65
    s_lshl_b32 s33, s38, 16
    s_add_u32 s33, s33, s65
    s_lshl_b32 s34, s39, 16
    s_add_u32 s34, s34, s65
    s_add_u32 m0, s61, 88064
    s_nop 0
    buffer_load_dwordx4 v3, s[4:7], s46 offen sc1 lds
    s_mul_i32 s16, s48, 12288
    v_lshrrev_b32 v13, 3, v0
    v_bfe_u32 v14, v0, 4, 1
    v_lshlrev_b32 v14, 1, v14
    v_and_b32 v8, 7, v0
    v_xor_b32 v8, v8, v14
    v_lshlrev_b32 v8, 4, v8
    v_lshl_add_u32 v8, v13, 10, v8
    s_waitcnt lgkmcnt(0)
    s_add_u32 s47, s47, 0x9e3779b1
    v_mov_b32 v11, s47
    s_waitcnt vmcnt(6)
    s_barrier
    s_add_u32 s70, s54, 3
    s_and_b32 s70, s70, 7
    s_mul_i32 s46, s70, 229376
    s_add_u32 m0, s62, 92160
    s_add_u32 s46, s46, s71
    buffer_load_dwordx4 v1, s[20:23], s46 offen sc1 lds
    v_xor_b32 v6, 64, v8
    v_lshrrev_b32 v13, 4, v0
    v_lshlrev_b32 v9, 10, v13
    v_bfe_u32 v13, v0, 2, 2
    v_lshl_add_u32 v9, v13, 7, v9
    v_bfe_u32 v13, v0, 3, 2
    v_lshl_add_u32 v9, v13, 5, v9
    v_and_b32 v13, 3, v0
    s_add_u32 m0, s62, 94208
    s_lshl_b32 s70, s70, 7
    buffer_load_dwordx4 v1, s[24:27], s46 offen sc1 lds
    v_lshl_add_u32 v9, v13, 3, v9
    s_add_u32 s65, s16, 101376
    v_add_u32 v9, s65, v9
    v_xor_b32 v10, 32, v9
    v_and_b32 v13, 15, v0
    v_lshlrev_b32 v13, 7, v13
    s_lshl_b32 s35, s0, 13
    s_lshl_b32 s65, s48, 11
    s_add_u32 m0, s62, 93184
    s_add_u32 s46, s46, 28672
    buffer_load_dwordx4 v2, s[20:23], s46 offen sc1 lds
    s_add_u32 s35, s35, s65
    s_add_u32 m0, s62, 95232
    s_add_u32 s70, s70, s69
    buffer_load_dwordx4 v2, s[24:27], s46 offen sc1 lds
    s_add_u32 m0, s61, 108544
    s_add_u32 s46, s70, 32768
    buffer_load_dwordx4 v3, s[4:7], s70 offen sc1 lds
    s_add_u32 m0, s61, 112640
    s_nop 0
    buffer_load_dwordx4 v3, s[4:7], s46 offen sc1 lds
    s_add_u32 s45, s3, 1
    s_and_b32 s45, s45, 3
    s_lshl_b32 s45, s45, 6
    s_add_u32 s45, s45, s52
    s_lshl_b32 s45, s45, 10
    s_add_u32 m0, s64, 0
    s_add_u32 s45, s45, s63
    buffer_load_dwordx4 v4, s[4:7], s45 offen sc1 lds
    s_add_u32 m0, s64, 1056
    s_add_u32 s45, s45, 1024
    buffer_load_dwordx4 v4, s[4:7], s45 offen sc1 lds
    s_waitcnt vmcnt(8)
    s_barrier
    s_add_u32 s70, s54, 4
    s_and_b32 s70, s70, 7
    s_mul_i32 s46, s70, 229376
    s_add_u32 m0, s62, 116736
    s_add_u32 s46, s46, s71
    buffer_load_dwordx4 v1, s[20:23], s46 offen sc1 lds
    s_add_u32 m0, s62, 118784
    s_lshl_b32 s70, s70, 7
    buffer_load_dwordx4 v1, s[24:27], s46 offen sc1 lds
    s_add_u32 m0, s62, 117760
    s_add_u32 s46, s46, 28672
    buffer_load_dwordx4 v2, s[20:23], s46 offen sc1 lds
    s_add_u32 m0, s62, 119808
    s_add_u32 s70, s70, s69
    buffer_load_dwordx4 v2, s[24:27], s46 offen sc1 lds
    s_add_u32 m0, s61, 133120
    s_add_u32 s46, s70, 32768
    buffer_load_dwordx4 v3, s[4:7], s70 offen sc1 lds
    s_add_u32 m0, s61, 137216
    s_nop 0
    buffer_load_dwordx4 v3, s[4:7], s46 offen sc1 lds
    s_add_u32 m0, s64, 2112
    s_add_u32 s45, s45, 1024
    buffer_load_dwordx4 v4, s[4:7], s45 offen sc1 lds
    s_add_u32 m0, s64, 3168
    s_add_u32 s45, s45, 1024
    buffer_load_dwordx4 v4, s[4:7], s45 offen sc1 lds
    s_waitcnt vmcnt(10)
    s_barrier
    s_add_u32 s70, s54, 5
    s_and_b32 s70, s70, 7
    s_mul_i32 s46, s70, 229376
    s_add_u32 m0, s62, 67584
    s_add_u32 s46, s46, s71
    buffer_load_dwordx4 v1, s[20:23], s46 offen sc1 lds
    s_add_u32 m0, s62, 69632
    s_lshl_b32 s70, s70, 7
    buffer_load_dwordx4 v1, s[24:27], s46 offen sc1 lds
    s_add_u32 m0, s62, 68608
    s_add_u32 s46, s46, 28672
    buffer_load_dwordx4 v2, s[20:23], s46 offen sc1 lds
    s_add_u32 m0, s62, 70656
    s_add_u32 s70, s70, s69
    buffer_load_dwordx4 v2, s[24:27], s46 offen sc1 lds
    s_add_u32 m0, s61, 83968
    s_add_u32 s46, s70, 32768
    buffer_load_dwordx4 v3, s[4:7], s70 offen sc1 lds
    s_add_u32 m0, s61, 88064
    s_nop 0
    buffer_load_dwordx4 v3, s[4:7], s46 offen sc1 lds
    s_add_u32 m0, s64, 4224
    s_add_u32 s45, s45, 1024
    buffer_load_dwordx4 v4, s[4:7], s45 offen sc1 lds
    s_add_u32 m0, s64, 5280
    s_add_u32 s45, s45, 1024
    buffer_load_dwordx4 v4, s[4:7], s45 offen sc1 lds
    s_waitcnt vmcnt(10)
    s_barrier
    s_add_u32 s70, s54, 6
    s_and_b32 s70, s70, 7
    s_mul_i32 s46, s70, 229376
    s_add_u32 m0, s62, 92160
    s_add_u32 s46, s46, s71
    buffer_load_dwordx4 v1, s[20:23], s46 offen sc1 lds
    s_add_u32 m0, s62, 94208
    s_lshl_b32 s70, s70, 7
    buffer_load_dwordx4 v1, s[24:27], s46 offen sc1 lds
    s_add_u32 m0, s62, 93184
    s_add_u32 s46, s46, 28672
    buffer_load_dwordx4 v2, s[20:23], s46 offen sc1 lds
    s_add_u32 m0, s62, 95232
    s_add_u32 s70, s70, s69
    buffer_load_dwordx4 v2, s[24:27], s46 offen sc1 lds
    s_add_u32 m0, s61, 108544
    s_add_u32 s46, s70, 32768
    buffer_load_dwordx4 v3, s[4:7], s70 offen sc1 lds
    s_add_u32 m0, s61, 112640
    s_nop 0
    buffer_load_dwordx4 v3, s[4:7], s46 offen sc1 lds
    s_add_u32 m0, s64, 6336
    s_add_u32 s45, s45, 1024
    buffer_load_dwordx4 v4, s[4:7], s45 offen sc1 lds
    s_add_u32 m0, s64, 7392
    s_add_u32 s45, s45, 1024
    buffer_load_dwordx4 v4, s[4:7], s45 offen sc1 lds
    s_waitcnt vmcnt(10)
    s_barrier
    s_add_u32 s70, s54, 7
    s_and_b32 s70, s70, 7
    s_mul_i32 s46, s70, 229376
    s_add_u32 m0, s62, 116736
    s_add_u32 s46, s46, s71
    buffer_load_dwordx4 v1, s[20:23], s46 offen sc1 lds
    s_add_u32 m0, s62, 118784
    s_lshl_b32 s70, s70, 7
    buffer_load_dwordx4 v1, s[24:27], s46 offen sc1 lds
    s_add_u32 m0, s62, 117760
    s_add_u32 s46, s46, 28672
    buffer_load_dwordx4 v2, s[20:23], s46 offen sc1 lds
    s_add_u32 m0, s62, 119808
    s_add_u32 s70, s70, s69
    buffer_load_dwordx4 v2, s[24:27], s46 offen sc1 lds
    s_add_u32 m0, s61, 133120
    s_add_u32 s46, s70, 32768
    buffer_load_dwordx4 v3, s[4:7], s70 offen sc1 lds
    s_add_u32 m0, s61, 137216
    s_nop 0
    buffer_load_dwordx4 v3, s[4:7], s46 offen sc1 lds
    s_add_u32 s45, s3, 1
    s_and_b32 s45, s45, 3
    s_lshl_b32 s45, s45, 6
    s_add_u32 s45, s45, s52
    s_add_u32 s45, s45, 32
    s_lshl_b32 s45, s45, 10
    s_add_u32 m0, s64, 33792
    s_add_u32 s45, s45, s63
    buffer_load_dwordx4 v4, s[4:7], s45 offen sc1 lds
    s_add_u32 m0, s64, 34848
    s_add_u32 s45, s45, 1024
    buffer_load_dwordx4 v4, s[4:7], s45 offen sc1 lds
    s_add_u32 s17, s3, s48
    s_and_b32 s17, s17, 3
    s_lshl_b32 s17, s17, 6
    s_add_u32 s17, s17, s52
    s_lshl_b32 s17, s17, 4
    s_add_u32 s17, s17, 32768
    s_add_u32 s65, s61, 159744
    v_add_u32 v16, s65, v5
    s_add_u32 m0, s61, 159744
    s_nop 0
    buffer_load_dwordx4 v5, s[8:11], s17 offen sc1 lds
    s_waitcnt vmcnt(11)
    s_barrier
    s_add_u32 m0, s64, 35904
    s_add_u32 s45, s45, 1024
    buffer_load_dwordx4 v4, s[4:7], s45 offen sc1 lds
    s_add_u32 m0, s64, 36960
    s_add_u32 s45, s45, 1024
    buffer_load_dwordx4 v4, s[4:7], s45 offen sc1 lds
    s_add_u32 m0, s64, 38016
    s_add_u32 s45, s45, 1024
    buffer_load_dwordx4 v4, s[4:7], s45 offen sc1 lds
    s_add_u32 m0, s64, 39072
    s_add_u32 s45, s45, 1024
    buffer_load_dwordx4 v4, s[4:7], s45 offen sc1 lds
    s_waitcnt vmcnt(7)
    s_barrier
    s_add_u32 m0, s64, 40128
    s_add_u32 s45, s45, 1024
    buffer_load_dwordx4 v4, s[4:7], s45 offen sc1 lds
    s_add_u32 m0, s64, 41184
    s_add_u32 s45, s45, 1024
    buffer_load_dwordx4 v4, s[4:7], s45 offen sc1 lds
    s_and_b32 s65, s48, 1
    s_lshl_b32 s65, s65, 11
    v_add_u32 v13, s65, v5
    v_subrev_u32 v14, 8, v13
    v_add_u32 v15, 1016, v13
    s_lshr_b32 s65, s48, 1
    s_lshl_b32 s66, s0, 1
    s_add_u32 s65, s65, s66
    s_lshl_b32 s65, s65, 12
    buffer_load_dwordx4 v[66:69], v13, s[40:43], s65 offen
    buffer_load_dwordx2 v[64:65], v14, s[40:43], s65 offen
    buffer_load_dwordx4 v[72:75], v13, s[40:43], s65 offen offset:1024
    buffer_load_dwordx2 v[70:71], v15, s[40:43], s65 offen
    v_xor_b32 v2, 64, v9
    v_xor_b32 v3, 64, v10
    s_waitcnt vmcnt(10)
    ds_read_b32 v22, v16
    s_waitcnt lgkmcnt(0)
    v_cmp_ne_u32 vcc, s47, v22
    s_cbranch_vccz L_ok_15
    s_mov_b32 s70, 0
L_poll_16:
    s_add_u32 m0, s61, 159744
    s_nop 0
    buffer_load_dwordx4 v5, s[8:11], s17 offen sc1 lds
    s_waitcnt vmcnt(0)
    ds_read_b32 v22, v16
    s_waitcnt lgkmcnt(0)
    s_waitcnt vmcnt(0)
    v_cmp_ne_u32 vcc, s47, v22
    s_add_u32 s70, s70, 1
    s_cmp_gt_u32 s70, 40000
    s_cbranch_scc1 L_ok_15
    s_cbranch_vccnz L_poll_16
L_ok_15:
    s_add_u32 s45, s3, 2
    s_and_b32 s45, s45, 3
    s_lshl_b32 s45, s45, 6
    s_add_u32 s45, s45, s52
    s_lshl_b32 s45, s45, 10
    s_add_u32 m0, s64, 67584
    s_add_u32 s45, s45, s63
    buffer_load_dwordx4 v4, s[4:7], s45 offen sc1 lds
    s_add_u32 m0, s64, 68640
    s_add_u32 s45, s45, 1024
    buffer_load_dwordx4 v4, s[4:7], s45 offen sc1 lds
    s_add_u32 m0, s64, 69696
    s_add_u32 s45, s45, 1024
    buffer_load_dwordx4 v4, s[4:7], s45 offen sc1 lds
    s_add_u32 m0, s64, 70752
    s_add_u32 s45, s45, 1024
    buffer_load_dwordx4 v4, s[4:7], s45 offen sc1 lds
    s_barrier
    s_add_u32 m0, s16, 109568
    s_add_u32 s28, s28, 8192
    buffer_load_dwordx4 v8, s[12:15], s28 offen sc1 lds
    s_add_u32 m0, s64, 71808
    s_add_u32 s45, s45, 1024
    buffer_load_dwordx4 v4, s[4:7], s45 offen sc1 lds
    s_add_u32 m0, s16, 110592
    s_add_u32 s28, s28, 8192
    buffer_load_dwordx4 v6, s[12:15], s28 offen sc1 lds
    s_add_u32 m0, s64, 72864
    s_add_u32 s45, s45, 1024
    buffer_load_dwordx4 v4, s[4:7], s45 offen sc1 lds
    s_add_u32 m0, s16, 111616
    s_add_u32 s28, s28, 8192
    buffer_load_dwordx4 v8, s[12:15], s28 offen sc1 lds
    s_add_u32 m0, s16, 112640
    s_add_u32 s28, s28, 8192
    buffer_load_dwordx4 v6, s[12:15], s28 offen sc1 lds
    s_add_u32 m0, s16, 105472
    s_add_u32 s28, s28, 8192
    buffer_load_dwordx4 v8, s[12:15], s28 offen sc1 lds
    s_add_u32 m0, s16, 106496
    s_add_u32 s28, s28, 8192
    buffer_load_dwordx4 v6, s[12:15], s28 offen sc1 lds
    s_add_u32 m0, s16, 107520
    s_add_u32 s28, s28, 8192
    buffer_load_dwordx4 v8, s[12:15], s28 offen sc1 lds
    s_add_u32 m0, s16, 108544
L_stub_GB_1_0:
    s_cbranch_execz L_warm
    s_add_u32 s28, s28, 8192
    buffer_load_dwordx4 v6, s[12:15], s28 offen sc1 lds
    s_add_u32 m0, s16, 101376
    s_add_u32 s29, s29, 8192
    buffer_load_dwordx4 v8, s[12:15], s29 offen sc1 lds
    s_add_u32 m0, s64, 73920
    s_add_u32 s45, s45, 1024
    buffer_load_dwordx4 v4, s[4:7], s45 offen sc1 lds
    s_add_u32 m0, s64, 74976
    s_add_u32 s45, s45, 1024
    buffer_load_dwordx4 v4, s[4:7], s45 offen sc1 lds
    s_waitcnt vmcnt(21)
    s_barrier
    s_add_u32 m0, s16, 102400
    s_add_u32 s29, s29, 8192
    buffer_load_dwordx4 v6, s[12:15], s29 offen sc1 lds
    s_add_u32 s45, s3, 2
    s_and_b32 s45, s45, 3
    s_lshl_b32 s45, s45, 6
    s_add_u32 s45, s45, s52
    s_add_u32 s45, s45, 32
    s_lshl_b32 s45, s45, 10
    s_add_u32 m0, s64, 0
    s_add_u32 s45, s45, s63
    buffer_load_dwordx4 v4, s[4:7], s45 offen sc1 lds
    s_add_u32 m0, s64, 1056
    s_add_u32 s45, s45, 1024
    buffer_load_dwordx4 v4, s[4:7], s45 offen sc1 lds
    s_add_u32 m0, s16, 103424
    s_add_u32 s29, s29, 8192
    buffer_load_dwordx4 v8, s[12:15], s29 offen sc1 lds
    s_add_u32 m0, s64, 2112
    s_add_u32 s45, s45, 1024
    buffer_load_dwordx4 v4, s[4:7], s45 offen sc1 lds
    s_add_u32 m0, s64, 3168
    s_add_u32 s45, s45, 1024
    buffer_load_dwordx4 v4, s[4:7], s45 offen sc1 lds
    s_add_u32 m0, s16, 104448
    s_add_u32 s29, s29, 8192
    buffer_load_dwordx4 v6, s[12:15], s29 offen sc1 lds
    s_add_u32 m0, s64, 4224
    s_add_u32 s45, s45, 1024
    buffer_load_dwordx4 v4, s[4:7], s45 offen sc1 lds
    s_waitcnt vmcnt(15)
    ds_read_b64_tr_b16 v[128:129], v9 offset:8192
    ds_read_b64_tr_b16 v[130:131], v9 offset:8704
    ds_read_b64_tr_b16 v[132:133], v10 offset:8192
    ds_read_b64_tr_b16 v[134:135], v10 offset:8704
    ds_read_b64_tr_b16 v[136:137], v2 offset:8192
    ds_read_b64_tr_b16 v[138:139], v2 offset:8704
    ds_read_b64_tr_b16 v[140:141], v3 offset:8192
    ds_read_b64_tr_b16 v[142:143], v3 offset:8704
    s_add_u32 m0, s64, 5280
    s_add_u32 s45, s45, 1024
    buffer_load_dwordx4 v4, s[4:7], s45 offen sc1 lds
    s_add_u32 m0, s64, 6336
    s_add_u32 s45, s45, 1024
    buffer_load_dwordx4 v4, s[4:7], s45 offen sc1 lds
    s_waitcnt lgkmcnt(0)
    s_add_u32 m0, s16, 109568
    s_add_u32 s29, s29, 8192
    buffer_load_dwordx4 v8, s[12:15], s29 offen sc1 lds
    s_add_u32 m0, s64, 7392
    s_add_u32 s45, s45, 1024
    buffer_load_dwordx4 v4, s[4:7], s45 offen sc1 lds
    s_waitcnt vmcnt(12)
    s_barrier
    s_cmp_lg_u32 s48, 0
    s_cbranch_scc1 L_nopub_17
    s_add_u32 s65, s3, 0
    s_and_b32 s65, s65, 3
    s_lshl_b32 s65, s65, 6
    s_add_u32 s65, s65, s52
    s_mul_i32 s65, s65, 112
    s_add_u32 s65, s65, s44
    buffer_store_dword v11, v7, s[8:11], s65 offen sc1
L_nopub_17:
    s_add_u32 m0, s16, 110592
    s_add_u32 s29, s29, 8192
    buffer_load_dwordx4 v6, s[12:15], s29 offen sc1 lds
    s_add_u32 s45, s3, 3
    s_and_b32 s45, s45, 3
    s_lshl_b32 s45, s45, 6
    s_add_u32 s45, s45, s52
    s_lshl_b32 s45, s45, 10
    s_add_u32 m0, s64, 33792
    s_add_u32 s45, s45, s63
    buffer_load_dwordx4 v4, s[4:7], s45 offen sc1 lds
    s_add_u32 m0, s64, 34848
    s_add_u32 s45, s45, 1024
    buffer_load_dwordx4 v4, s[4:7], s45 offen sc1 lds
    s_add_u32 m0, s16, 111616
    s_add_u32 s29, s29, 8192
    buffer_load_dwordx4 v8, s[12:15], s29 offen sc1 lds
    s_add_u32 m0, s64, 35904
    s_add_u32 s45, s45, 1024
    buffer_load_dwordx4 v4, s[4:7], s45 offen sc1 lds
    s_add_u32 m0, s16, 112640
    s_add_u32 s29, s29, 8192
    buffer_load_dwordx4 v6, s[12:15], s29 offen sc1 lds
    s_add_u32 m0, s64, 36960
    s_add_u32 s45, s45, 1024
    buffer_load_dwordx4 v4, s[4:7], s45 offen sc1 lds
    ds_read_b64_tr_b16 v[144:145], v9 offset:4096
    ds_read_b64_tr_b16 v[146:147], v9 offset:4608
    ds_read_b64_tr_b16 v[148:149], v10 offset:4096
    ds_read_b64_tr_b16 v[150:151], v10 offset:4608
    ds_read_b64_tr_b16 v[152:153], v2 offset:4096
    ds_read_b64_tr_b16 v[154:155], v2 offset:4608
    ds_read_b64_tr_b16 v[156:157], v3 offset:4096
    ds_read_b64_tr_b16 v[158:159], v3 offset:4608
    s_add_u32 m0, s64, 38016
    s_add_u32 s45, s45, 1024
    buffer_load_dwordx4 v4, s[4:7], s45 offen sc1 lds
    s_add_u32 m0, s64, 39072
    s_add_u32 s45, s45, 1024
    buffer_load_dwordx4 v4, s[4:7], s45 offen sc1 lds
    s_waitcnt lgkmcnt(0)
    s_add_u32 m0, s16, 105472
    s_add_u32 s30, s30, 8192
    buffer_load_dwordx4 v8, s[12:15], s30 offen sc1 lds
    s_add_u32 m0, s16, 106496
    s_add_u32 s30, s30, 8192
    buffer_load_dwordx4 v6, s[12:15], s30 offen sc1 lds
    s_add_u32 m0, s64, 40128
    s_add_u32 s45, s45, 1024
    buffer_load_dwordx4 v4, s[4:7], s45 offen sc1 lds
    s_add_u32 m0, s64, 41184
    s_add_u32 s45, s45, 1024
    buffer_load_dwordx4 v4, s[4:7], s45 offen sc1 lds
    s_waitcnt vmcnt(13)
    s_barrier
    s_cmp_lg_u32 s48, 0
    s_cbranch_scc1 L_nopub_18
    s_add_u32 s65, s3, 0
    s_and_b32 s65, s65, 3
    s_lshl_b32 s65, s65, 6
    s_add_u32 s65, s65, s52
    s_add_u32 s65, s65, 32
    s_mul_i32 s65, s65, 112
    s_add_u32 s65, s65, s44
    buffer_store_dword v11, v7, s[8:11], s65 offen sc1
L_nopub_18:
    s_add_u32 m0, s16, 107520
    s_add_u32 s30, s30, 8192
    buffer_load_dwordx4 v8, s[12:15], s30 offen sc1 lds
    s_add_u32 s45, s3, 3
    s_and_b32 s45, s45, 3
    s_lshl_b32 s45, s45, 6
    s_add_u32 s45, s45, s52
    s_add_u32 s45, s45, 32
    s_lshl_b32 s45, s45, 10
    s_add_u32 m0, s64, 67584
    s_add_u32 s45, s45, s63
    buffer_load_dwordx4 v4, s[4:7], s45 offen sc1 lds
    s_add_u32 m0, s64, 68640
    s_add_u32 s45, s45, 1024
    buffer_load_dwordx4 v4, s[4:7], s45 offen sc1 lds
    s_add_u32 m0, s16, 108544
    s_add_u32 s30, s30, 8192
    buffer_load_dwordx4 v6, s[12:15], s30 offen sc1 lds
    s_add_u32 m0, s64, 69696
    s_add_u32 s45, s45, 1024
    buffer_load_dwordx4 v4, s[4:7], s45 offen sc1 lds
    ds_read_b64_tr_b16 v[160:161], v9 offset:0
    ds_read_b64_tr_b16 v[162:163], v9 offset:512
    ds_read_b64_tr_b16 v[164:165], v10 offset:0
    ds_read_b64_tr_b16 v[166:167], v10 offset:512
    ds_read_b64_tr_b16 v[168:169], v2 offset:0
    ds_read_b64_tr_b16 v[170:171], v2 offset:512
    ds_read_b64_tr_b16 v[172:173], v3 offset:0
    ds_read_b64_tr_b16 v[174:175], v3 offset:512
    s_add_u32 m0, s64, 70752
    s_add_u32 s45, s45, 1024
    buffer_load_dwordx4 v4, s[4:7], s45 offen sc1 lds
    s_add_u32 m0, s64, 71808
    s_add_u32 s45, s45, 1024
    buffer_load_dwordx4 v4, s[4:7], s45 offen sc1 lds
    s_waitcnt lgkmcnt(0)
    s_add_u32 m0, s16, 101376
    s_add_u32 s30, s30, 8192
    buffer_load_dwordx4 v8, s[12:15], s30 offen sc1 lds
    s_add_u32 m0, s64, 72864
    s_add_u32 s45, s45, 1024
    buffer_load_dwordx4 v4, s[4:7], s45 offen sc1 lds
    s_add_u32 m0, s16, 102400
    s_add_u32 s30, s30, 8192
    buffer_load_dwordx4 v6, s[12:15], s30 offen sc1 lds
    s_add_u32 m0, s16, 103424
    s_add_u32 s30, s30, 8192
    buffer_load_dwordx4 v8, s[12:15], s30 offen sc1 lds
    s_add_u32 m0, s64, 73920
    s_add_u32 s45, s45, 1024
    buffer_load_dwordx4 v4, s[4:7], s45 offen sc1 lds
    s_add_u32 m0, s64, 74976
    s_add_u32 s45, s45, 1024
    buffer_load_dwordx4 v4, s[4:7], s45 offen sc1 lds
    s_lshr_b32 s65, s48, 1
    s_mul_i32 s65, s65, 5120
    s_add_u32 m0, s65, 154624
    v_mov_b32 v16, 0x40000000
    buffer_load_dwordx4 v16, s[40:43], 0 offen lds
    s_waitcnt vmcnt(14)
    s_barrier
    s_cmp_lg_u32 s48, 0
    s_cbranch_scc1 L_nopub_19
    s_add_u32 s65, s3, 1
    s_and_b32 s65, s65, 3
    s_lshl_b32 s65, s65, 6
    s_add_u32 s65, s65, s52
    s_mul_i32 s65, s65, 112
    s_add_u32 s65, s65, s44
    buffer_store_dword v11, v7, s[8:11], s65 offen sc1
L_nopub_19:
    s_lshr_b32 s65, s0, 5
    s_lshl_b32 s65, s65, 12
    s_andn2_b32 s66, 1, s48
    s_lshl_b32 s66, s66, 11
    s_add_u32 s65, s65, s66
    s_add_u32 s65, s65, 65536
    v_and_b32 v21, 15, v0
    v_lshlrev_b32 v21, 7, v21
    v_add_u32 v21, s65, v21
    buffer_load_dword v22, v21, s[8:11], 0 offen sc1
    s_add_u32 m0, s16, 104448
    s_add_u32 s30, s30, 8192
    buffer_load_dwordx4 v6, s[12:15], s30 offen sc1 lds
    s_lshl_b32 s35, s0, 13
    s_lshl_b32 s36, s48, 11
    s_add_u32 s35, s35, s36
    s_lshr_b32 s65, s48, 1
    s_mul_i32 s65, s65, 12544
    s_add_u32 s36, s36, s65
    s_add_u32 m0, s36, 32
    s_sub_u32 s65, s35, 0
    buffer_load_dwordx4 v5, s[40:43], s65 offen offset:0 lds
    ds_read_b64_tr_b16 v[176:177], v9 offset:8192
    ds_read_b64_tr_b16 v[178:179], v9 offset:8704
    ds_read_b64_tr_b16 v[180:181], v10 offset:8192
    ds_read_b64_tr_b16 v[182:183], v10 offset:8704
    ds_read_b64_tr_b16 v[184:185], v2 offset:8192
    ds_read_b64_tr_b16 v[186:187], v2 offset:8704
    ds_read_b64_tr_b16 v[188:189], v3 offset:8192
    ds_read_b64_tr_b16 v[190:191], v3 offset:8704
    s_add_u32 m0, s36, 8352
    s_sub_u32 s65, s35, 4
    buffer_load_dwordx4 v5, s[40:43], s65 offen offset:0 lds
    s_add_u32 m0, s36, 32
    s_sub_u32 s65, s35, 0
    buffer_load_dwordx4 v5, s[40:43], s65 offen offset:1024 lds
    s_waitcnt lgkmcnt(0)
    s_add_u32 m0, s16, 109568
    s_add_u32 s31, s31, 8192
    buffer_load_dwordx4 v8, s[12:15], s31 offen sc1 lds
    s_add_u32 m0, s16, 110592
    s_add_u32 s31, s31, 8192
    buffer_load_dwordx4 v6, s[12:15], s31 offen sc1 lds
    s_add_u32 m0, s16, 111616
    s_add_u32 s31, s31, 8192
    buffer_load_dwordx4 v8, s[12:15], s31 offen sc1 lds
    s_add_u32 m0, s16, 112640
    s_add_u32 s31, s31, 8192
    buffer_load_dwordx4 v6, s[12:15], s31 offen sc1 lds
    s_add_u32 m0, s36, 8352
    s_sub_u32 s65, s35, 4
    buffer_load_dwordx4 v5, s[40:43], s65 offen offset:1024 lds
    s_waitcnt vmcnt(9)
    v_cmp_ne_u32 vcc, s47, v22
    s_cbranch_vccz L_ok_20
    s_mov_b32 s70, 0
L_poll_21:
    buffer_load_dword v22, v21, s[8:11], 0 offen sc1
    s_waitcnt vmcnt(0)
    v_cmp_ne_u32 vcc, s47, v22
    s_add_u32 s70, s70, 1
    s_cmp_gt_u32 s70, 40000
    s_cbranch_scc1 L_ok_20
    s_cbranch_vccnz L_poll_21
L_ok_20:
    s_lshl_b32 s65, s0, 13
    s_lshl_b32 s66, s48, 11
    s_add_u32 s65, s65, s66
    s_add_u32 s65, s65, 1048576
    s_lshr_b32 s67, s48, 1
    s_lshl_b32 s67, s67, 10
    s_add_u32 s66, s66, s67
    s_add_u32 m0, s66, 150528
    s_nop 0
    buffer_load_dwordx4 v5, s[8:11], s65 offen offset:0 sc1 lds
    buffer_load_dwordx4 v5, s[8:11], s65 offen offset:1024 sc1 lds
    s_lshr_b32 s65, s48, 1
    s_mul_i32 s65, s65, 16640
    s_add_u32 s65, s65, 32
    v_add_u32 v13, s65, v13
    v_alignbyte_b32 v76, v66, v65, 2
    v_alignbyte_b32 v77, v67, v66, 2
    v_alignbyte_b32 v78, v68, v67, 2
    v_alignbyte_b32 v79, v69, v68, 2
    v_alignbyte_b32 v84, v65, v64, 2
    v_alignbyte_b32 v85, v66, v65, 2
    v_alignbyte_b32 v86, v67, v66, 2
    v_alignbyte_b32 v87, v68, v67, 2
    v_alignbyte_b32 v80, v72, v71, 2
    v_alignbyte_b32 v81, v73, v72, 2
    v_alignbyte_b32 v82, v74, v73, 2
    v_alignbyte_b32 v83, v75, v74, 2
    v_alignbyte_b32 v88, v71, v70, 2
    v_alignbyte_b32 v89, v72, v71, 2
    v_alignbyte_b32 v90, v73, v72, 2
    v_alignbyte_b32 v91, v74, v73, 2
    s_mul_i32 s46, s55, 7168
    s_add_u32 s46, s46, 262144
    s_lshl_b32 s65, s57, 7
    s_add_u32 s65, s65, s46
    s_load_dword s20, s[8:9], s65 glc
    s_lshl_b32 s65, s58, 7
    s_add_u32 s65, s65, s46
    s_load_dword s21, s[8:9], s65 glc
    s_lshl_b32 s65, s59, 7
    s_add_u32 s65, s65, s46
    s_load_dword s22, s[8:9], s65 glc
    s_barrier
    s_cmp_lg_u32 s48, 0
    s_cbranch_scc1 L_nopub_22
    s_add_u32 s65, s3, 1
    s_and_b32 s65, s65, 3
    s_lshl_b32 s65, s65, 6
    s_add_u32 s65, s65, s52
    s_add_u32 s65, s65, 32
    s_mul_i32 s65, s65, 112
    s_add_u32 s65, s65, s44
    buffer_store_dword v11, v7, s[8:11], s65 offen sc1
    s_add_u32 s65, s3, 2
    s_and_b32 s65, s65, 3
    s_lshl_b32 s65, s65, 6
    s_add_u32 s65, s65, s52
    s_mul_i32 s65, s65, 112
    s_add_u32 s65, s65, s44
    buffer_store_dword v11, v7, s[8:11], s65 offen sc1
L_nopub_22:
    s_add_u32 m0, s63, 33792
    s_add_u32 s32, s32, 8192
    buffer_load_dwordx4 v8, s[12:15], s32 offen sc1 lds
    s_add_u32 m0, s63, 34816
    s_add_u32 s32, s32, 8192
    buffer_load_dwordx4 v6, s[12:15], s32 offen sc1 lds
    s_mul_i32 s1, s55, 229376
    s_add_u32 s1, s1, 5242880
    v_and_b32 v4, 48, v0
    v_add_lshl_u32 v4, v4, v0, 4
    s_mov_b32 s70, 0
L_schk_23:
    s_waitcnt lgkmcnt(0)
    s_cmp_lg_u32 s20, s47
    s_cbranch_scc1 L_sp_24
    s_cmp_lg_u32 s21, s47
    s_cbranch_scc1 L_sp_24
    s_cmp_eq_u32 s22, s47
    s_cbranch_scc1 L_ok_25
L_sp_24:
    s_add_u32 s70, s70, 1
    s_cmp_gt_u32 s70, 40000
    s_cbranch_scc1 L_ok_25
    s_lshl_b32 s65, s57, 7
    s_add_u32 s65, s65, s46
    s_load_dword s20, s[8:9], s65 glc
    s_lshl_b32 s65, s58, 7
    s_add_u32 s65, s65, s46
    s_load_dword s21, s[8:9], s65 glc
    s_lshl_b32 s65, s59, 7
    s_add_u32 s65, s65, s46
    s_load_dword s22, s[8:9], s65 glc
    s_branch L_schk_23
L_ok_25:
    s_lshl_b32 s65, s57, 12
    s_add_u32 s67, s65, s1
    buffer_load_dwordx4 v[24:27], v4, s[8:11], s67 offen offset:0 sc1
    buffer_load_dwordx4 v[28:31], v4, s[8:11], s67 offen offset:2048 sc1
    buffer_load_dwordx4 v[32:35], v4, s[8:11], s67 offen offset:256 sc1
    buffer_load_dwordx4 v[36:39], v4, s[8:11], s67 offen offset:2304 sc1
    s_lshl_b32 s65, s58, 12
    s_add_u32 s67, s65, s1
    buffer_load_dwordx4 v[40:43], v4, s[8:11], s67 offen offset:0 sc1
    buffer_load_dwordx4 v[44:47], v4, s[8:11], s67 offen offset:2048 sc1
    buffer_load_dwordx4 v[48:51], v4, s[8:11], s67 offen offset:256 sc1
    buffer_load_dwordx4 v[52:55], v4, s[8:11], s67 offen offset:2304 sc1
    s_waitcnt vmcnt(8)
    ds_write_b128 v13, v[76:79] offset:4160
    s_lshl_b32 s65, s59, 12
    s_add_u32 s67, s65, s1
    buffer_load_dwordx4 v[56:59], v4, s[8:11], s67 offen offset:0 sc1
    ds_write_b128 v13, v[84:87] offset:12480
    buffer_load_dwordx4 v[60:63], v4, s[8:11], s67 offen offset:2048 sc1
    ds_write_b128 v13, v[80:83] offset:5184
    buffer_load_dwordx4 v[96:99], v4, s[8:11], s67 offen offset:256 sc1
    ds_write_b128 v13, v[88:91] offset:13504
    buffer_load_dwordx4 v[100:103], v4, s[8:11], s67 offen offset:2304 sc1
    s_waitcnt lgkmcnt(0)
    s_barrier
    s_cmp_lg_u32 s48, 0
    s_cbranch_scc1 L_nopub_26
    s_add_u32 s65, s3, 2
    s_and_b32 s65, s65, 3
    s_lshl_b32 s65, s65, 6
    s_add_u32 s65, s65, s52
    s_add_u32 s65, s65, 32
    s_mul_i32 s65, s65, 112
    s_add_u32 s65, s65, s44
    buffer_store_dword v11, v7, s[8:11], s65 offen sc1
L_nopub_26:
    ds_read_b64_tr_b16 v[192:193], v9 offset:4096
    ds_read_b64_tr_b16 v[194:195], v9 offset:4608
    ds_read_b64_tr_b16 v[196:197], v10 offset:4096
    ds_read_b64_tr_b16 v[198:199], v10 offset:4608
    ds_read_b64_tr_b16 v[200:201], v2 offset:4096
    ds_read_b64_tr_b16 v[202:203], v2 offset:4608
    ds_read_b64_tr_b16 v[204:205], v3 offset:4096
    ds_read_b64_tr_b16 v[206:207], v3 offset:4608
    s_add_u32 m0, s63, 35840
    s_add_u32 s32, s32, 8192
    buffer_load_dwordx4 v8, s[12:15], s32 offen sc1 lds
    s_add_u32 m0, s63, 36864
    s_add_u32 s32, s32, 8192
    buffer_load_dwordx4 v6, s[12:15], s32 offen sc1 lds
    s_waitcnt lgkmcnt(0)
    s_add_u32 m0, s16, 105472
    s_add_u32 s31, s31, 8192
    buffer_load_dwordx4 v8, s[12:15], s31 offen sc1 lds
    s_add_u32 m0, s63, 37888
    s_add_u32 s32, s32, 8192
    buffer_load_dwordx4 v8, s[12:15], s32 offen sc1 lds
    s_add_u32 m0, s16, 106496
    s_add_u32 s31, s31, 8192
    buffer_load_dwordx4 v6, s[12:15], s31 offen sc1 lds
    s_add_u32 m0, s63, 38912
    s_add_u32 s32, s32, 8192
    buffer_load_dwordx4 v6, s[12:15], s32 offen sc1 lds
    s_add_u32 m0, s16, 107520
    s_add_u32 s31, s31, 8192
    buffer_load_dwordx4 v8, s[12:15], s31 offen sc1 lds
    s_add_u32 m0, s63, 39936
    s_add_u32 s32, s32, 8192
    buffer_load_dwordx4 v8, s[12:15], s32 offen sc1 lds
    s_add_u32 m0, s16, 108544
    s_add_u32 s31, s31, 8192
    buffer_load_dwordx4 v6, s[12:15], s31 offen sc1 lds
    s_add_u32 m0, s63, 40960
    s_add_u32 s32, s32, 8192
    buffer_load_dwordx4 v6, s[12:15], s32 offen sc1 lds
    ds_read_b64_tr_b16 v[208:209], v9 offset:0
    ds_read_b64_tr_b16 v[210:211], v9 offset:512
    ds_read_b64_tr_b16 v[212:213], v10 offset:0
    ds_read_b64_tr_b16 v[214:215], v10 offset:512
    ds_read_b64_tr_b16 v[216:217], v2 offset:0
    ds_read_b64_tr_b16 v[218:219], v2 offset:512
    ds_read_b64_tr_b16 v[220:221], v3 offset:0
    ds_read_b64_tr_b16 v[222:223], v3 offset:512
    s_add_u32 m0, s63, 67584
    s_add_u32 s33, s33, 8192
    buffer_load_dwordx4 v8, s[12:15], s33 offen sc1 lds
    s_add_u32 m0, s63, 68608
    s_add_u32 s33, s33, 8192
    buffer_load_dwordx4 v6, s[12:15], s33 offen sc1 lds
    s_waitcnt lgkmcnt(0)
    s_add_u32 m0, s63, 69632
    s_add_u32 s33, s33, 8192
    buffer_load_dwordx4 v8, s[12:15], s33 offen sc1 lds
    ds_read_b64_tr_b16 v[224:225], v9 offset:8192
    ds_read_b64_tr_b16 v[226:227], v9 offset:8704
    ds_read_b64_tr_b16 v[228:229], v10 offset:8192
    ds_read_b64_tr_b16 v[230:231], v10 offset:8704
    ds_read_b64_tr_b16 v[232:233], v2 offset:8192
    ds_read_b64_tr_b16 v[234:235], v2 offset:8704
    ds_read_b64_tr_b16 v[236:237], v3 offset:8192
    ds_read_b64_tr_b16 v[238:239], v3 offset:8704
    s_add_u32 m0, s63, 70656
    s_add_u32 s33, s33, 8192
    buffer_load_dwordx4 v6, s[12:15], s33 offen sc1 lds
    s_add_u32 m0, s63, 71680
    s_add_u32 s33, s33, 8192
    buffer_load_dwordx4 v8, s[12:15], s33 offen sc1 lds
    s_waitcnt lgkmcnt(0)
    s_add_u32 m0, s63, 72704
    s_add_u32 s33, s33, 8192
    buffer_load_dwordx4 v6, s[12:15], s33 offen sc1 lds
    s_waitcnt vmcnt(7)
    ds_read_b64_tr_b16 v[240:241], v9 offset:4096
    ds_read_b64_tr_b16 v[242:243], v9 offset:4608
    ds_read_b64_tr_b16 v[244:245], v10 offset:4096
    ds_read_b64_tr_b16 v[246:247], v10 offset:4608
    ds_read_b64_tr_b16 v[248:249], v2 offset:4096
    ds_read_b64_tr_b16 v[250:251], v2 offset:4608
    ds_read_b64_tr_b16 v[252:253], v3 offset:4096
    ds_read_b64_tr_b16 v[254:255], v3 offset:4608
    s_add_u32 m0, s63, 73728
    s_add_u32 s33, s33, 8192
    buffer_load_dwordx4 v8, s[12:15], s33 offen sc1 lds
    s_add_u32 m0, s63, 74752
    s_add_u32 s33, s33, 8192
    buffer_load_dwordx4 v6, s[12:15], s33 offen sc1 lds
    s_waitcnt lgkmcnt(0)
    s_lshl_b32 s65, s60, 7
    s_add_u32 s65, s65, s46
    s_load_dword s20, s[8:9], s65 glc
    s_lshl_b32 s65, s57, 7
    s_add_u32 s65, s65, s46
    s_add_u32 s65, s65, 3584
    s_load_dword s21, s[8:9], s65 glc
    s_lshl_b32 s65, s58, 7
    s_add_u32 s65, s65, s46
    s_add_u32 s65, s65, 3584
    s_load_dword s22, s[8:9], s65 glc
    s_lshl_b32 s65, s59, 7
    s_add_u32 s65, s65, s46
    s_add_u32 s65, s65, 3584
    s_load_dword s23, s[8:9], s65 glc
    s_lshl_b32 s65, s37, 7
    s_add_u32 s65, s65, s46
    s_load_dword s24, s[8:9], s65 glc
    s_lshl_b32 s65, s60, 7
    s_add_u32 s65, s65, s46
    s_add_u32 s65, s65, 3584
    s_load_dword s25, s[8:9], s65 glc
    s_lshl_b32 s65, s37, 7
    s_add_u32 s65, s65, s46
    s_add_u32 s65, s65, 3584
    s_load_dword s26, s[8:9], s65 glc
    s_add_u32 m0, s16, 101376
    s_add_u32 s34, s34, 8192
    buffer_load_dwordx4 v8, s[12:15], s34 offen sc1 lds
    s_add_u32 m0, s16, 102400
    s_add_u32 s34, s34, 8192
    buffer_load_dwordx4 v6, s[12:15], s34 offen sc1 lds
    s_add_u32 m0, s16, 103424
    s_add_u32 s34, s34, 8192
    buffer_load_dwordx4 v8, s[12:15], s34 offen sc1 lds
    s_add_u32 m0, s16, 104448
    s_add_u32 s34, s34, 8192
    buffer_load_dwordx4 v6, s[12:15], s34 offen sc1 lds
    s_add_u32 m0, s16, 105472
    s_add_u32 s34, s34, 8192
    buffer_load_dwordx4 v8, s[12:15], s34 offen sc1 lds
    s_add_u32 m0, s16, 106496
    s_add_u32 s34, s34, 8192
    buffer_load_dwordx4 v6, s[12:15], s34 offen sc1 lds
    s_add_u32 m0, s16, 107520
    s_add_u32 s34, s34, 8192
    buffer_load_dwordx4 v8, s[12:15], s34 offen sc1 lds
    s_add_u32 m0, s16, 108544
    s_add_u32 s34, s34, 8192
    buffer_load_dwordx4 v6, s[12:15], s34 offen sc1 lds
    s_mov_b32 s70, 0
L_schk_27:
    s_waitcnt lgkmcnt(0)
    s_cmp_lg_u32 s20, s47
    s_cbranch_scc1 L_sp_28
    s_cmp_lg_u32 s21, s47
    s_cbranch_scc1 L_sp_28
    s_cmp_lg_u32 s22, s47
    s_cbranch_scc1 L_sp_28
    s_cmp_lg_u32 s23, s47
    s_cbranch_scc1 L_sp_28
    s_cmp_lg_u32 s24, s47
    s_cbranch_scc1 L_sp_28
    s_cmp_lg_u32 s25, s47
    s_cbranch_scc1 L_sp_28
    s_cmp_eq_u32 s26, s47
    s_cbranch_scc1 L_ok_29
L_sp_28:
    s_add_u32 s70, s70, 1
    s_cmp_gt_u32 s70, 40000
    s_cbranch_scc1 L_ok_29
    s_lshl_b32 s65, s60, 7
    s_add_u32 s65, s65, s46
    s_load_dword s20, s[8:9], s65 glc
    s_lshl_b32 s65, s57, 7
    s_add_u32 s65, s65, s46
    s_add_u32 s65, s65, 3584
    s_load_dword s21, s[8:9], s65 glc
    s_lshl_b32 s65, s58, 7
    s_add_u32 s65, s65, s46
    s_add_u32 s65, s65, 3584
    s_load_dword s22, s[8:9], s65 glc
    s_lshl_b32 s65, s59, 7
    s_add_u32 s65, s65, s46
    s_add_u32 s65, s65, 3584
    s_load_dword s23, s[8:9], s65 glc
    s_lshl_b32 s65, s37, 7
    s_add_u32 s65, s65, s46
    s_load_dword s24, s[8:9], s65 glc
    s_lshl_b32 s65, s60, 7
    s_add_u32 s65, s65, s46
    s_add_u32 s65, s65, 3584
    s_load_dword s25, s[8:9], s65 glc
    s_lshl_b32 s65, s37, 7
    s_add_u32 s65, s65, s46
    s_add_u32 s65, s65, 3584
    s_load_dword s26, s[8:9], s65 glc
    s_branch L_schk_27
L_ok_29:
    s_lshl_b32 s65, s60, 12
    s_add_u32 s67, s65, s1
    buffer_load_dwordx4 v[104:107], v4, s[8:11], s67 offen offset:0 sc1
    buffer_load_dwordx4 v[108:111], v4, s[8:11], s67 offen offset:2048 sc1
    buffer_load_dwordx4 v[112:115], v4, s[8:11], s67 offen offset:256 sc1
    buffer_load_dwordx4 v[116:119], v4, s[8:11], s67 offen offset:2304 sc1
    s_lshl_b32 s65, s57, 12
    s_add_u32 s67, s65, s1
    s_add_u32 s67, s67, 114688
    buffer_load_dwordx4 v[120:123], v4, s[8:11], s67 offen offset:0 sc1
    buffer_load_dwordx4 v[124:127], v4, s[8:11], s67 offen offset:2048 sc1
    buffer_load_dwordx4 v[12:15], v4, s[8:11], s67 offen offset:256 sc1
    buffer_load_dwordx4 v[16:19], v4, s[8:11], s67 offen offset:2304 sc1
    v_and_b32 v20, 15, v0
    v_lshlrev_b32 v20, 8, v20
    v_add_u32 v20, s63, v20
    v_lshrrev_b32 v21, 4, v0
    v_and_b32 v22, 7, v0
    v_xor_b32 v21, v21, v22
    v_lshl_add_u32 v7, v21, 4, v20
    v_add_u32 v7, 33792, v7
    v_xor_b32 v11, 64, v7
    s_lshl_b32 s65, s48, 2
    s_add_u32 s65, s65, 155136
    v_mov_b32 v0, s65
    v_mov_b32 v5, 1
    s_setprio 1
    v_mfma_f32_16x16x32_bf16 v[64:67], v[128:131], v[24:27], 0
    v_mfma_f32_16x16x32_bf16 v[64:67], v[144:147], v[28:31], v[64:67]
    v_mfma_f32_16x16x32_bf16 v[68:71], v[148:151], v[28:31], 0
    v_mfma_f32_16x16x32_bf16 v[68:71], v[132:135], v[24:27], v[68:71]
    v_mfma_f32_16x16x32_bf16 v[72:75], v[136:139], v[24:27], 0
    v_mfma_f32_16x16x32_bf16 v[72:75], v[152:155], v[28:31], v[72:75]
L_stub_GB_2_0:
    s_cbranch_execz L_warm
    v_mfma_f32_16x16x32_bf16 v[76:79], v[156:159], v[28:31], 0
    v_mfma_f32_16x16x32_bf16 v[76:79], v[140:143], v[24:27], v[76:79]
    v_mfma_f32_16x16x32_bf16 v[80:83], v[128:131], v[32:35], 0
    v_mfma_f32_16x16x32_bf16 v[80:83], v[144:147], v[36:39], v[80:83]
    v_mfma_f32_16x16x32_bf16 v[84:87], v[148:151], v[36:39], 0
    v_mfma_f32_16x16x32_bf16 v[84:87], v[132:135], v[32:35], v[84:87]
    v_mfma_f32_16x16x32_bf16 v[88:91], v[136:139], v[32:35], 0
    v_mfma_f32_16x16x32_bf16 v[88:91], v[152:155], v[36:39], v[88:91]
    v_mfma_f32_16x16x32_bf16 v[92:95], v[156:159], v[36:39], 0
    v_mfma_f32_16x16x32_bf16 v[92:95], v[140:143], v[32:35], v[92:95]
    v_mfma_f32_16x16x32_bf16 v[64:67], v[160:163], v[40:43], v[64:67]
    s_lshl_b32 s65, s38, 7
    s_add_u32 s65, s65, s46
    s_load_dwordx4 s[20:23], s[8:9], s65 glc
    s_lshl_b32 s65, s39, 7
    s_add_u32 s65, s65, s46
    s_load_dwordx4 s[24:27], s[8:9], s65 glc
    v_mfma_f32_16x16x32_bf16 v[64:67], v[176:179], v[44:47], v[64:67]
    v_mfma_f32_16x16x32_bf16 v[68:71], v[180:183], v[44:47], v[68:71]
    v_mfma_f32_16x16x32_bf16 v[68:71], v[164:167], v[40:43], v[68:71]
    v_mfma_f32_16x16x32_bf16 v[72:75], v[168:171], v[40:43], v[72:75]
    v_mfma_f32_16x16x32_bf16 v[72:75], v[184:187], v[44:47], v[72:75]
    v_mfma_f32_16x16x32_bf16 v[76:79], v[188:191], v[44:47], v[76:79]
    v_mfma_f32_16x16x32_bf16 v[76:79], v[172:175], v[40:43], v[76:79]
    v_mfma_f32_16x16x32_bf16 v[80:83], v[160:163], v[48:51], v[80:83]
    s_lshl_b32 s65, s58, 12
    s_add_u32 s67, s65, s1
    s_add_u32 s67, s67, 114688
    buffer_load_dwordx4 v[24:27], v4, s[8:11], s67 offen offset:0 sc1
    v_mfma_f32_16x16x32_bf16 v[80:83], v[176:179], v[52:55], v[80:83]
    buffer_load_dwordx4 v[28:31], v4, s[8:11], s67 offen offset:2048 sc1
    v_mfma_f32_16x16x32_bf16 v[84:87], v[180:183], v[52:55], v[84:87]
    v_mfma_f32_16x16x32_bf16 v[84:87], v[164:167], v[48:51], v[84:87]
    v_mfma_f32_16x16x32_bf16 v[88:91], v[168:171], v[48:51], v[88:91]
    v_mfma_f32_16x16x32_bf16 v[88:91], v[184:187], v[52:55], v[88:91]
    v_mfma_f32_16x16x32_bf16 v[92:95], v[188:191], v[52:55], v[92:95]
    v_mfma_f32_16x16x32_bf16 v[92:95], v[172:175], v[48:51], v[92:95]
    v_mfma_f32_16x16x32_bf16 v[64:67], v[192:195], v[56:59], v[64:67]
    buffer_load_dwordx4 v[32:35], v4, s[8:11], s67 offen offset:256 sc1
    v_mfma_f32_16x16x32_bf16 v[64:67], v[208:211], v[60:63], v[64:67]
    buffer_load_dwordx4 v[36:39], v4, s[8:11], s67 offen offset:2304 sc1
    v_mfma_f32_16x16x32_bf16 v[68:71], v[212:215], v[60:63], v[68:71]
    v_mfma_f32_16x16x32_bf16 v[68:71], v[196:199], v[56:59], v[68:71]
    v_mfma_f32_16x16x32_bf16 v[72:75], v[200:203], v[56:59], v[72:75]
    v_mfma_f32_16x16x32_bf16 v[72:75], v[216:219], v[60:63], v[72:75]
    v_mfma_f32_16x16x32_bf16 v[76:79], v[220:223], v[60:63], v[76:79]
    v_mfma_f32_16x16x32_bf16 v[76:79], v[204:207], v[56:59], v[76:79]
    v_mfma_f32_16x16x32_bf16 v[80:83], v[192:195], v[96:99], v[80:83]
    s_lshl_b32 s65, s59, 12
    s_add_u32 s67, s65, s1
    s_add_u32 s67, s67, 114688
    buffer_load_dwordx4 v[40:43], v4, s[8:11], s67 offen offset:0 sc1
    v_mfma_f32_16x16x32_bf16 v[80:83], v[208:211], v[100:103], v[80:83]
    buffer_load_dwordx4 v[44:47], v4, s[8:11], s67 offen offset:2048 sc1
    v_mfma_f32_16x16x32_bf16 v[84:87], v[212:215], v[100:103], v[84:87]
    v_mfma_f32_16x16x32_bf16 v[84:87], v[196:199], v[96:99], v[84:87]
    v_mfma_f32_16x16x32_bf16 v[88:91], v[200:203], v[96:99], v[88:91]
    v_mfma_f32_16x16x32_bf16 v[88:91], v[216:219], v[100:103], v[88:91]
    v_mfma_f32_16x16x32_bf16 v[92:95], v[220:223], v[100:103], v[92:95]
    v_mfma_f32_16x16x32_bf16 v[92:95], v[204:207], v[96:99], v[92:95]
    s_waitcnt vmcnt(12)
    v_mfma_f32_16x16x32_bf16 v[64:67], v[224:227], v[104:107], v[64:67]
    buffer_load_dwordx4 v[48:51], v4, s[8:11], s67 offen offset:256 sc1
    v_mfma_f32_16x16x32_bf16 v[64:67], v[240:243], v[108:111], v[64:67]
    buffer_load_dwordx4 v[52:55], v4, s[8:11], s67 offen offset:2304 sc1
    v_mfma_f32_16x16x32_bf16 v[68:71], v[244:247], v[108:111], v[68:71]
    v_mfma_f32_16x16x32_bf16 v[68:71], v[228:231], v[104:107], v[68:71]
    v_mfma_f32_16x16x32_bf16 v[72:75], v[232:235], v[104:107], v[72:75]
    v_mfma_f32_16x16x32_bf16 v[72:75], v[248:251], v[108:111], v[72:75]
    v_mfma_f32_16x16x32_bf16 v[76:79], v[252:255], v[108:111], v[76:79]
    v_mfma_f32_16x16x32_bf16 v[76:79], v[236:239], v[104:107], v[76:79]
    s_waitcnt vmcnt(12)
    v_mfma_f32_16x16x32_bf16 v[80:83], v[224:227], v[112:115], v[80:83]
    s_lshl_b32 s65, s37, 12
    s_add_u32 s67, s65, s1
    buffer_load_dwordx4 v[56:59], v4, s[8:11], s67 offen offset:0 sc1
    v_mfma_f32_16x16x32_bf16 v[80:83], v[240:243], v[116:119], v[80:83]
    buffer_load_dwordx4 v[60:63], v4, s[8:11], s67 offen offset:2048 sc1
    v_mfma_f32_16x16x32_bf16 v[84:87], v[244:247], v[116:119], v[84:87]
    v_mfma_f32_16x16x32_bf16 v[84:87], v[228:231], v[112:115], v[84:87]
    v_mfma_f32_16x16x32_bf16 v[88:91], v[232:235], v[112:115], v[88:91]
    v_mfma_f32_16x16x32_bf16 v[88:91], v[248:251], v[116:119], v[88:91]
    v_mfma_f32_16x16x32_bf16 v[92:95], v[252:255], v[116:119], v[92:95]
    v_mfma_f32_16x16x32_bf16 v[92:95], v[236:239], v[112:115], v[92:95]
    s_waitcnt vmcnt(12)
    v_mfma_f32_16x16x32_bf16 v[96:99], v[128:131], v[120:123], 0
    v_mfma_f32_16x16x32_bf16 v[96:99], v[144:147], v[124:127], v[96:99]
    v_mfma_f32_16x16x32_bf16 v[100:103], v[148:151], v[124:127], 0
    v_mfma_f32_16x16x32_bf16 v[100:103], v[132:135], v[120:123], v[100:103]
    v_mfma_f32_16x16x32_bf16 v[104:107], v[136:139], v[120:123], 0
    v_mfma_f32_16x16x32_bf16 v[104:107], v[152:155], v[124:127], v[104:107]
    v_mfma_f32_16x16x32_bf16 v[108:111], v[156:159], v[124:127], 0
    v_mfma_f32_16x16x32_bf16 v[108:111], v[140:143], v[120:123], v[108:111]
    s_waitcnt vmcnt(10)
    v_mfma_f32_16x16x32_bf16 v[112:115], v[128:131], v[12:15], 0
    s_mov_b32 s70, 0
L_schk_30:
    s_waitcnt lgkmcnt(0)
    s_cmp_lg_u32 s20, s47
    s_cbranch_scc1 L_sp_31
    s_cmp_lg_u32 s21, s47
    s_cbranch_scc1 L_sp_31
    s_cmp_lg_u32 s22, s47
    s_cbranch_scc1 L_sp_31
    s_cmp_lg_u32 s23, s47
    s_cbranch_scc1 L_sp_31
    s_cmp_lg_u32 s24, s47
    s_cbranch_scc1 L_sp_31
    s_cmp_lg_u32 s25, s47
    s_cbranch_scc1 L_sp_31
    s_cmp_lg_u32 s26, s47
    s_cbranch_scc1 L_sp_31
    s_cmp_eq_u32 s27, s47
    s_cbranch_scc1 L_ok_32
L_sp_31:
    s_add_u32 s70, s70, 1
    s_cmp_gt_u32 s70, 40000
    s_cbranch_scc1 L_ok_32
    s_lshl_b32 s65, s38, 7
    s_add_u32 s65, s65, s46
    s_load_dwordx4 s[20:23], s[8:9], s65 glc
    s_lshl_b32 s65, s39, 7
    s_add_u32 s65, s65, s46
    s_load_dwordx4 s[24:27], s[8:9], s65 glc
    s_branch L_schk_30
L_ok_32:
    v_mfma_f32_16x16x32_bf16 v[112:115], v[144:147], v[16:19], v[112:115]
    v_mfma_f32_16x16x32_bf16 v[116:119], v[148:151], v[16:19], 0
    v_mfma_f32_16x16x32_bf16 v[116:119], v[132:135], v[12:15], v[116:119]
    v_mfma_f32_16x16x32_bf16 v[120:123], v[136:139], v[12:15], 0
    v_mfma_f32_16x16x32_bf16 v[120:123], v[152:155], v[16:19], v[120:123]
    v_mfma_f32_16x16x32_bf16 v[124:127], v[156:159], v[16:19], 0
    v_mfma_f32_16x16x32_bf16 v[124:127], v[140:143], v[12:15], v[124:127]
    s_waitcnt vmcnt(8)
    v_mfma_f32_16x16x32_bf16 v[96:99], v[160:163], v[24:27], v[96:99]
    buffer_load_dwordx4 v[12:15], v4, s[8:11], s67 offen offset:256 sc1
    buffer_load_dwordx4 v[16:19], v4, s[8:11], s67 offen offset:2304 sc1
    s_lshl_b32 s65, s38, 7
    s_add_u32 s65, s65, s46
    s_add_u32 s65, s65, 3584
    s_load_dwordx4 s[20:23], s[8:9], s65 glc
    s_lshl_b32 s65, s39, 7
    s_add_u32 s65, s65, s46
    s_add_u32 s65, s65, 3584
    s_load_dwordx4 s[24:27], s[8:9], s65 glc
    v_mfma_f32_16x16x32_bf16 v[96:99], v[176:179], v[28:31], v[96:99]
    s_add_u32 s66, s62, 67584
    v_subrev_u32 v9, s66, v9
    v_subrev_u32 v10, s66, v10
    v_mfma_f32_16x16x32_bf16 v[100:103], v[180:183], v[28:31], v[100:103]
    v_subrev_u32 v2, s66, v2
    v_subrev_u32 v3, s66, v3
    ds_read_b64_tr_b16 v[128:129], v9 offset:0
    v_mfma_f32_16x16x32_bf16 v[100:103], v[164:167], v[24:27], v[100:103]
    ds_read_b64_tr_b16 v[130:131], v9 offset:512
    ds_read_b64_tr_b16 v[132:133], v10 offset:0
    ds_read_b64_tr_b16 v[134:135], v10 offset:512
    v_mfma_f32_16x16x32_bf16 v[104:107], v[168:171], v[24:27], v[104:107]
    ds_read_b64_tr_b16 v[136:137], v2 offset:0
    ds_read_b64_tr_b16 v[138:139], v2 offset:512
    ds_read_b64_tr_b16 v[140:141], v3 offset:0
    v_mfma_f32_16x16x32_bf16 v[104:107], v[184:187], v[28:31], v[104:107]
    ds_read_b64_tr_b16 v[142:143], v3 offset:512
    ds_write_b32 v0, v5 offset:16
    v_mfma_f32_16x16x32_bf16 v[108:111], v[188:191], v[28:31], v[108:111]
    v_mfma_f32_16x16x32_bf16 v[108:111], v[172:175], v[24:27], v[108:111]
    s_waitcnt vmcnt(8)
    v_mfma_f32_16x16x32_bf16 v[112:115], v[160:163], v[32:35], v[112:115]
    s_lshl_b32 s65, s38, 12
    s_add_u32 s67, s65, s1
    buffer_load_dwordx4 v[24:27], v4, s[8:11], s67 offen offset:0 sc1
    buffer_load_dwordx4 v[28:31], v4, s[8:11], s67 offen offset:2048 sc1
    v_mfma_f32_16x16x32_bf16 v[112:115], v[176:179], v[36:39], v[112:115]
    ds_read_b64_tr_b16 v[144:145], v9 offset:4096
    ds_read_b64_tr_b16 v[146:147], v9 offset:4608
    v_mfma_f32_16x16x32_bf16 v[116:119], v[180:183], v[36:39], v[116:119]
    ds_read_b64_tr_b16 v[148:149], v10 offset:4096
    ds_read_b64_tr_b16 v[150:151], v10 offset:4608
    v_mfma_f32_16x16x32_bf16 v[116:119], v[164:167], v[32:35], v[116:119]
    ds_read_b64_tr_b16 v[152:153], v2 offset:4096
    ds_read_b64_tr_b16 v[154:155], v2 offset:4608
    v_mfma_f32_16x16x32_bf16 v[120:123], v[168:171], v[32:35], v[120:123]
    s_waitcnt lgkmcnt(11)
    ds_read_b64_tr_b16 v[156:157], v3 offset:4096
    ds_read_b64_tr_b16 v[158:159], v3 offset:4608
    v_mfma_f32_16x16x32_bf16 v[120:123], v[184:187], v[36:39], v[120:123]
    v_mfma_f32_16x16x32_bf16 v[124:127], v[188:191], v[36:39], v[124:127]
    v_mfma_f32_16x16x32_bf16 v[124:127], v[172:175], v[32:35], v[124:127]
    s_waitcnt vmcnt(8)
    v_mfma_f32_16x16x32_bf16 v[96:99], v[192:195], v[40:43], v[96:99]
    buffer_load_dwordx4 v[32:35], v4, s[8:11], s67 offen offset:256 sc1
    buffer_load_dwordx4 v[36:39], v4, s[8:11], s67 offen offset:2304 sc1
    v_mfma_f32_16x16x32_bf16 v[96:99], v[208:211], v[44:47], v[96:99]
    ds_read_b64_tr_b16 v[160:161], v9 offset:33792
    ds_read_b64_tr_b16 v[162:163], v9 offset:34304
    v_mfma_f32_16x16x32_bf16 v[100:103], v[212:215], v[44:47], v[100:103]
    s_waitcnt lgkmcnt(11)
    ds_read_b64_tr_b16 v[164:165], v10 offset:33792
    ds_read_b64_tr_b16 v[166:167], v10 offset:34304
    v_mfma_f32_16x16x32_bf16 v[100:103], v[196:199], v[40:43], v[100:103]
    ds_read_b64_tr_b16 v[168:169], v2 offset:33792
    ds_read_b64_tr_b16 v[170:171], v2 offset:34304
    v_mfma_f32_16x16x32_bf16 v[104:107], v[200:203], v[40:43], v[104:107]
    s_waitcnt lgkmcnt(11)
    ds_read_b64_tr_b16 v[172:173], v3 offset:33792
    ds_read_b64_tr_b16 v[174:175], v3 offset:34304
    v_mfma_f32_16x16x32_bf16 v[104:107], v[216:219], v[44:47], v[104:107]
    v_mfma_f32_16x16x32_bf16 v[108:111], v[220:223], v[44:47], v[108:111]
    v_mfma_f32_16x16x32_bf16 v[108:111], v[204:207], v[40:43], v[108:111]
    s_waitcnt vmcnt(8)
    v_mfma_f32_16x16x32_bf16 v[112:115], v[192:195], v[48:51], v[112:115]
    s_lshl_b32 s65, s39, 12
    s_add_u32 s67, s65, s1
    buffer_load_dwordx4 v[40:43], v4, s[8:11], s67 offen offset:0 sc1
    buffer_load_dwordx4 v[44:47], v4, s[8:11], s67 offen offset:2048 sc1
    v_mfma_f32_16x16x32_bf16 v[112:115], v[208:211], v[52:55], v[112:115]
    ds_read_b64_tr_b16 v[176:177], v9 offset:37888
    ds_read_b64_tr_b16 v[178:179], v9 offset:38400
    v_mfma_f32_16x16x32_bf16 v[116:119], v[212:215], v[52:55], v[116:119]
    s_waitcnt lgkmcnt(11)
    ds_read_b64_tr_b16 v[180:181], v10 offset:37888
    ds_read_b64_tr_b16 v[182:183], v10 offset:38400
    v_mfma_f32_16x16x32_bf16 v[116:119], v[196:199], v[48:51], v[116:119]
    ds_read_b64_tr_b16 v[184:185], v2 offset:37888
    ds_read_b64_tr_b16 v[186:187], v2 offset:38400
    v_mfma_f32_16x16x32_bf16 v[120:123], v[200:203], v[48:51], v[120:123]
    s_waitcnt lgkmcnt(11)
    ds_read_b64_tr_b16 v[188:189], v3 offset:37888
    ds_read_b64_tr_b16 v[190:191], v3 offset:38400
    v_mfma_f32_16x16x32_bf16 v[120:123], v[216:219], v[52:55], v[120:123]
    v_mfma_f32_16x16x32_bf16 v[124:127], v[220:223], v[52:55], v[124:127]
    v_mfma_f32_16x16x32_bf16 v[124:127], v[204:207], v[48:51], v[124:127]
    s_waitcnt vmcnt(8)
    v_mfma_f32_16x16x32_bf16 v[64:67], v[128:131], v[56:59], v[64:67]
    buffer_load_dwordx4 v[48:51], v4, s[8:11], s67 offen offset:256 sc1
    buffer_load_dwordx4 v[52:55], v4, s[8:11], s67 offen offset:2304 sc1
    v_mfma_f32_16x16x32_bf16 v[64:67], v[144:147], v[60:63], v[64:67]
    v_add_u32 v9, s66, v9
    v_add_u32 v10, s66, v10
    v_mfma_f32_16x16x32_bf16 v[68:71], v[148:151], v[60:63], v[68:71]
    v_add_u32 v2, s66, v2
    v_add_u32 v3, s66, v3
    v_mfma_f32_16x16x32_bf16 v[68:71], v[132:135], v[56:59], v[68:71]
    ds_read_b64_tr_b16 v[192:193], v9 offset:0
    ds_read_b64_tr_b16 v[194:195], v9 offset:512
    v_mfma_f32_16x16x32_bf16 v[72:75], v[136:139], v[56:59], v[72:75]
    s_waitcnt lgkmcnt(11)
    ds_read_b64_tr_b16 v[196:197], v10 offset:0
    ds_read_b64_tr_b16 v[198:199], v10 offset:512
    v_mfma_f32_16x16x32_bf16 v[72:75], v[152:155], v[60:63], v[72:75]
    ds_read_b64_tr_b16 v[200:201], v2 offset:0
    ds_read_b64_tr_b16 v[202:203], v2 offset:512
    v_mfma_f32_16x16x32_bf16 v[76:79], v[156:159], v[60:63], v[76:79]
    s_waitcnt lgkmcnt(11)
    ds_read_b64_tr_b16 v[204:205], v3 offset:0
    ds_read_b64_tr_b16 v[206:207], v3 offset:512
    v_mfma_f32_16x16x32_bf16 v[76:79], v[140:143], v[56:59], v[76:79]
    s_waitcnt vmcnt(8)
    v_mfma_f32_16x16x32_bf16 v[80:83], v[128:131], v[12:15], v[80:83]
    s_lshl_b32 s65, s60, 12
    s_add_u32 s67, s65, s1
    s_add_u32 s67, s67, 114688
    buffer_load_dwordx4 v[56:59], v4, s[8:11], s67 offen offset:0 sc1
    buffer_load_dwordx4 v[60:63], v4, s[8:11], s67 offen offset:2048 sc1
    v_mfma_f32_16x16x32_bf16 v[80:83], v[144:147], v[16:19], v[80:83]
    ds_read_b64_tr_b16 v[208:209], v9 offset:4096
    ds_read_b64_tr_b16 v[210:211], v9 offset:4608
    v_mfma_f32_16x16x32_bf16 v[84:87], v[148:151], v[16:19], v[84:87]
    s_waitcnt lgkmcnt(11)
    ds_read_b64_tr_b16 v[212:213], v10 offset:4096
    ds_read_b64_tr_b16 v[214:215], v10 offset:4608
    v_mfma_f32_16x16x32_bf16 v[84:87], v[132:135], v[12:15], v[84:87]
    ds_read_b64_tr_b16 v[216:217], v2 offset:4096
    ds_read_b64_tr_b16 v[218:219], v2 offset:4608
    v_mfma_f32_16x16x32_bf16 v[88:91], v[136:139], v[12:15], v[88:91]
    s_waitcnt lgkmcnt(11)
    ds_read_b64_tr_b16 v[220:221], v3 offset:4096
    ds_read_b64_tr_b16 v[222:223], v3 offset:4608
    v_mfma_f32_16x16x32_bf16 v[88:91], v[152:155], v[16:19], v[88:91]
    v_mfma_f32_16x16x32_bf16 v[92:95], v[156:159], v[16:19], v[92:95]
    v_mfma_f32_16x16x32_bf16 v[92:95], v[140:143], v[12:15], v[92:95]
    s_waitcnt vmcnt(8)
    v_mfma_f32_16x16x32_bf16 v[64:67], v[160:163], v[24:27], v[64:67]
    buffer_load_dwordx4 v[12:15], v4, s[8:11], s67 offen offset:256 sc1
    v_mfma_f32_16x16x32_bf16 v[64:67], v[176:179], v[28:31], v[64:67]
    buffer_load_dwordx4 v[16:19], v4, s[8:11], s67 offen offset:2304 sc1
    v_mfma_f32_16x16x32_bf16 v[68:71], v[180:183], v[28:31], v[68:71]
    v_mfma_f32_16x16x32_bf16 v[68:71], v[164:167], v[24:27], v[68:71]
    v_mfma_f32_16x16x32_bf16 v[72:75], v[168:171], v[24:27], v[72:75]
    v_mfma_f32_16x16x32_bf16 v[72:75], v[184:187], v[28:31], v[72:75]
    v_mfma_f32_16x16x32_bf16 v[76:79], v[188:191], v[28:31], v[76:79]
    v_mfma_f32_16x16x32_bf16 v[76:79], v[172:175], v[24:27], v[76:79]
    s_waitcnt vmcnt(8)
    v_mfma_f32_16x16x32_bf16 v[80:83], v[160:163], v[32:35], v[80:83]
    s_lshl_b32 s65, s37, 12
    s_add_u32 s67, s65, s1
    s_add_u32 s67, s67, 114688
    buffer_load_dwordx4 v[24:27], v4, s[8:11], s67 offen offset:0 sc1
    v_mfma_f32_16x16x32_bf16 v[80:83], v[176:179], v[36:39], v[80:83]
    buffer_load_dwordx4 v[28:31], v4, s[8:11], s67 offen offset:2048 sc1
    v_mfma_f32_16x16x32_bf16 v[84:87], v[180:183], v[36:39], v[84:87]
    v_mfma_f32_16x16x32_bf16 v[84:87], v[164:167], v[32:35], v[84:87]
    v_mfma_f32_16x16x32_bf16 v[88:91], v[168:171], v[32:35], v[88:91]
    v_mfma_f32_16x16x32_bf16 v[88:91], v[184:187], v[36:39], v[88:91]
    v_mfma_f32_16x16x32_bf16 v[92:95], v[188:191], v[36:39], v[92:95]
    v_mfma_f32_16x16x32_bf16 v[92:95], v[172:175], v[32:35], v[92:95]
    s_waitcnt vmcnt(8) lgkmcnt(0)
    v_mfma_f32_16x16x32_bf16 v[64:67], v[192:195], v[40:43], v[64:67]
    buffer_load_dwordx4 v[32:35], v4, s[8:11], s67 offen offset:256 sc1
    v_mfma_f32_16x16x32_bf16 v[64:67], v[208:211], v[44:47], v[64:67]
    buffer_load_dwordx4 v[36:39], v4, s[8:11], s67 offen offset:2304 sc1
    v_mfma_f32_16x16x32_bf16 v[68:71], v[212:215], v[44:47], v[68:71]
    v_mfma_f32_16x16x32_bf16 v[68:71], v[196:199], v[40:43], v[68:71]
    v_mfma_f32_16x16x32_bf16 v[72:75], v[200:203], v[40:43], v[72:75]
    v_mfma_f32_16x16x32_bf16 v[72:75], v[216:219], v[44:47], v[72:75]
    v_mfma_f32_16x16x32_bf16 v[76:79], v[220:223], v[44:47], v[76:79]
    v_mfma_f32_16x16x32_bf16 v[76:79], v[204:207], v[40:43], v[76:79]
    s_waitcnt vmcnt(8)
    v_mfma_f32_16x16x32_bf16 v[80:83], v[192:195], v[48:51], v[80:83]
    s_mov_b32 s70, 0
L_schk_33:
    s_waitcnt lgkmcnt(0)
    s_cmp_lg_u32 s20, s47
    s_cbranch_scc1 L_sp_34
    s_cmp_lg_u32 s21, s47
    s_cbranch_scc1 L_sp_34
    s_cmp_lg_u32 s22, s47
    s_cbranch_scc1 L_sp_34
    s_cmp_lg_u32 s23, s47
    s_cbranch_scc1 L_sp_34
    s_cmp_lg_u32 s24, s47
    s_cbranch_scc1 L_sp_34
    s_cmp_lg_u32 s25, s47
    s_cbranch_scc1 L_sp_34
    s_cmp_lg_u32 s26, s47
    s_cbranch_scc1 L_sp_34
    s_cmp_eq_u32 s27, s47
    s_cbranch_scc1 L_ok_35
L_sp_34:
    s_add_u32 s70, s70, 1
    s_cmp_gt_u32 s70, 40000
    s_cbranch_scc1 L_ok_35
    s_lshl_b32 s65, s38, 7
    s_add_u32 s65, s65, s46
    s_add_u32 s65, s65, 3584
    s_load_dwordx4 s[20:23], s[8:9], s65 glc
    s_lshl_b32 s65, s39, 7
    s_add_u32 s65, s65, s46
    s_add_u32 s65, s65, 3584
    s_load_dwordx4 s[24:27], s[8:9], s65 glc
    s_branch L_schk_33
L_ok_35:
    v_mfma_f32_16x16x32_bf16 v[80:83], v[208:211], v[52:55], v[80:83]
    s_lshl_b32 s65, s38, 12
    s_add_u32 s67, s65, s1
    s_add_u32 s67, s67, 114688
    buffer_load_dwordx4 v[40:43], v4, s[8:11], s67 offen offset:0 sc1
    v_mfma_f32_16x16x32_bf16 v[84:87], v[212:215], v[52:55], v[84:87]
    buffer_load_dwordx4 v[44:47], v4, s[8:11], s67 offen offset:2048 sc1
    v_mfma_f32_16x16x32_bf16 v[84:87], v[196:199], v[48:51], v[84:87]
    v_mfma_f32_16x16x32_bf16 v[88:91], v[200:203], v[48:51], v[88:91]
    v_mfma_f32_16x16x32_bf16 v[88:91], v[216:219], v[52:55], v[88:91]
    v_mfma_f32_16x16x32_bf16 v[92:95], v[220:223], v[52:55], v[92:95]
    v_mfma_f32_16x16x32_bf16 v[92:95], v[204:207], v[48:51], v[92:95]
    s_waitcnt vmcnt(8)
    v_mfma_f32_16x16x32_bf16 v[96:99], v[224:227], v[56:59], v[96:99]
    s_lshl_b32 s65, s39, 12
    s_add_u32 s67, s65, s1
    s_add_u32 s67, s67, 114688
    buffer_load_dwordx4 v[48:51], v4, s[8:11], s67 offen offset:0 sc1
    v_mfma_f32_16x16x32_bf16 v[96:99], v[240:243], v[60:63], v[96:99]
    buffer_load_dwordx4 v[52:55], v4, s[8:11], s67 offen offset:2048 sc1
    v_mfma_f32_16x16x32_bf16 v[100:103], v[244:247], v[60:63], v[100:103]
    v_mfma_f32_16x16x32_bf16 v[100:103], v[228:231], v[56:59], v[100:103]
    ds_write_b128 v7, v[64:67] offset:0
    v_mfma_f32_16x16x32_bf16 v[104:107], v[232:235], v[56:59], v[104:107]
    ds_write_b128 v11, v[68:71] offset:0
    v_mfma_f32_16x16x32_bf16 v[104:107], v[248:251], v[60:63], v[104:107]
    ds_write_b128 v7, v[72:75] offset:128
    v_mfma_f32_16x16x32_bf16 v[108:111], v[252:255], v[60:63], v[108:111]
    ds_write_b128 v11, v[76:79] offset:128
    v_mfma_f32_16x16x32_bf16 v[108:111], v[236:239], v[56:59], v[108:111]
    s_waitcnt vmcnt(8)
    v_mfma_f32_16x16x32_bf16 v[112:115], v[224:227], v[12:15], v[112:115]
    s_lshl_b32 s65, s38, 12
    s_add_u32 s67, s65, s1
    s_add_u32 s67, s67, 114688
    buffer_load_dwordx4 v[56:59], v4, s[8:11], s67 offen offset:256 sc1
    v_mfma_f32_16x16x32_bf16 v[112:115], v[240:243], v[16:19], v[112:115]
    buffer_load_dwordx4 v[60:63], v4, s[8:11], s67 offen offset:2304 sc1
    v_mfma_f32_16x16x32_bf16 v[116:119], v[244:247], v[16:19], v[116:119]
    v_mfma_f32_16x16x32_bf16 v[116:119], v[228:231], v[12:15], v[116:119]
    ds_write_b128 v7, v[80:83] offset:4096
    v_mfma_f32_16x16x32_bf16 v[120:123], v[232:235], v[12:15], v[120:123]
    ds_write_b128 v11, v[84:87] offset:4096
    v_mfma_f32_16x16x32_bf16 v[120:123], v[248:251], v[16:19], v[120:123]
    ds_write_b128 v7, v[88:91] offset:4224
    v_mfma_f32_16x16x32_bf16 v[124:127], v[252:255], v[16:19], v[124:127]
    ds_write_b128 v11, v[92:95] offset:4224
    v_mfma_f32_16x16x32_bf16 v[124:127], v[236:239], v[12:15], v[124:127]
    ds_write_b32 v0, v5
    s_waitcnt vmcnt(8)
    v_mfma_f32_16x16x32_bf16 v[96:99], v[128:131], v[24:27], v[96:99]
    s_lshl_b32 s65, s39, 12
    s_add_u32 s67, s65, s1
    s_add_u32 s67, s67, 114688
    buffer_load_dwordx4 v[12:15], v4, s[8:11], s67 offen offset:256 sc1
    v_mfma_f32_16x16x32_bf16 v[96:99], v[144:147], v[28:31], v[96:99]
    buffer_load_dwordx4 v[16:19], v4, s[8:11], s67 offen offset:2304 sc1
    v_mfma_f32_16x16x32_bf16 v[100:103], v[148:151], v[28:31], v[100:103]
    v_mfma_f32_16x16x32_bf16 v[100:103], v[132:135], v[24:27], v[100:103]
    v_mfma_f32_16x16x32_bf16 v[104:107], v[136:139], v[24:27], v[104:107]
    v_mfma_f32_16x16x32_bf16 v[104:107], v[152:155], v[28:31], v[104:107]
    v_mfma_f32_16x16x32_bf16 v[108:111], v[156:159], v[28:31], v[108:111]
    v_mfma_f32_16x16x32_bf16 v[108:111], v[140:143], v[24:27], v[108:111]
    s_waitcnt vmcnt(8)
    v_mfma_f32_16x16x32_bf16 v[112:115], v[128:131], v[32:35], v[112:115]
    v_mfma_f32_16x16x32_bf16 v[112:115], v[144:147], v[36:39], v[112:115]
    v_mfma_f32_16x16x32_bf16 v[116:119], v[148:151], v[36:39], v[116:119]
    v_mfma_f32_16x16x32_bf16 v[116:119], v[132:135], v[32:35], v[116:119]
    v_mfma_f32_16x16x32_bf16 v[120:123], v[136:139], v[32:35], v[120:123]
    v_mfma_f32_16x16x32_bf16 v[120:123], v[152:155], v[36:39], v[120:123]
    v_mfma_f32_16x16x32_bf16 v[124:127], v[156:159], v[36:39], v[124:127]
    v_mfma_f32_16x16x32_bf16 v[124:127], v[140:143], v[32:35], v[124:127]
    s_waitcnt vmcnt(6)
    v_mfma_f32_16x16x32_bf16 v[96:99], v[160:163], v[40:43], v[96:99]
    v_mfma_f32_16x16x32_bf16 v[96:99], v[176:179], v[44:47], v[96:99]
    v_mfma_f32_16x16x32_bf16 v[100:103], v[180:183], v[44:47], v[100:103]
    v_mfma_f32_16x16x32_bf16 v[100:103], v[164:167], v[40:43], v[100:103]
    v_mfma_f32_16x16x32_bf16 v[104:107], v[168:171], v[40:43], v[104:107]
    v_mfma_f32_16x16x32_bf16 v[104:107], v[184:187], v[44:47], v[104:107]
    v_mfma_f32_16x16x32_bf16 v[108:111], v[188:191], v[44:47], v[108:111]
    v_mfma_f32_16x16x32_bf16 v[108:111], v[172:175], v[40:43], v[108:111]
    s_waitcnt vmcnt(4)
    v_mfma_f32_16x16x32_bf16 v[96:99], v[192:195], v[48:51], v[96:99]
    v_mfma_f32_16x16x32_bf16 v[96:99], v[208:211], v[52:55], v[96:99]
    v_mfma_f32_16x16x32_bf16 v[100:103], v[212:215], v[52:55], v[100:103]
    v_mfma_f32_16x16x32_bf16 v[100:103], v[196:199], v[48:51], v[100:103]
    v_mfma_f32_16x16x32_bf16 v[104:107], v[200:203], v[48:51], v[104:107]
    v_mfma_f32_16x16x32_bf16 v[104:107], v[216:219], v[52:55], v[104:107]
    v_mfma_f32_16x16x32_bf16 v[108:111], v[220:223], v[52:55], v[108:111]
    v_mfma_f32_16x16x32_bf16 v[108:111], v[204:207], v[48:51], v[108:111]
    s_waitcnt vmcnt(0)
    v_mfma_f32_16x16x32_bf16 v[112:115], v[160:163], v[56:59], v[112:115]
    v_mfma_f32_16x16x32_bf16 v[112:115], v[176:179], v[60:63], v[112:115]
    v_mfma_f32_16x16x32_bf16 v[112:115], v[192:195], v[12:15], v[112:115]
    ds_write_b128 v7, v[96:99] offset:33792
    v_mfma_f32_16x16x32_bf16 v[112:115], v[208:211], v[16:19], v[112:115]
    v_mfma_f32_16x16x32_bf16 v[116:119], v[164:167], v[56:59], v[116:119]
    ds_write_b128 v11, v[100:103] offset:33792
    v_mfma_f32_16x16x32_bf16 v[116:119], v[180:183], v[60:63], v[116:119]
    v_mfma_f32_16x16x32_bf16 v[116:119], v[196:199], v[12:15], v[116:119]
    ds_write_b128 v7, v[104:107] offset:33920
    v_mfma_f32_16x16x32_bf16 v[116:119], v[212:215], v[16:19], v[116:119]
    v_mfma_f32_16x16x32_bf16 v[120:123], v[168:171], v[56:59], v[120:123]
    ds_write_b128 v11, v[108:111] offset:33920
    v_mfma_f32_16x16x32_bf16 v[120:123], v[184:187], v[60:63], v[120:123]
    v_mfma_f32_16x16x32_bf16 v[120:123], v[200:203], v[12:15], v[120:123]
    ds_write_b128 v7, v[112:115] offset:37888
    v_mfma_f32_16x16x32_bf16 v[120:123], v[216:219], v[16:19], v[120:123]
    v_mfma_f32_16x16x32_bf16 v[124:127], v[172:175], v[56:59], v[124:127]
    v_mfma_f32_16x16x32_bf16 v[124:127], v[188:191], v[60:63], v[124:127]
    v_mfma_f32_16x16x32_bf16 v[124:127], v[204:207], v[12:15], v[124:127]
    ds_write_b128 v11, v[116:119] offset:37888
    v_mfma_f32_16x16x32_bf16 v[124:127], v[220:223], v[16:19], v[124:127]
    s_waitcnt lgkmcnt(11)
    s_nop 1
    ds_write_b128 v7, v[120:123] offset:38016
    s_nop 3
    ds_write_b128 v11, v[124:127] offset:38016
    s_waitcnt lgkmcnt(0)
    s_barrier
    s_endpgm
.p2align 12
L_GA:
    s_load_dwordx2 s[8:9], s[0:1], 96
    s_load_dwordx2 s[44:45], s[0:1], 40
    s_load_dwordx2 s[16:17], s[0:1], 80
    v_lshrrev_b32 v22, 5, v0
    v_and_b32 v23, 31, v0
    v_lshlrev_b32 v23, 4, v23
    v_lshl_add_u32 v23, v22, 10, v23
    s_lshl_b32 s65, s3, 3
    s_add_u32 s65, s65, s56
    s_lshl_b32 s65, s65, 2
    s_add_u32 s65, s65, s48
    s_lshl_b32 s65, s65, 1
    s_add_u32 s65, s65, s52
    s_lshl_b32 s66, s65, 10
    s_lshl_b32 s65, s65, 4
    s_add_u32 s65, s65, 32768
    v_lshlrev_b32 v22, 4, v22
    v_add_u32 v22, s65, v22
    s_waitcnt lgkmcnt(0)
    s_add_u32 s0, s2, 32
    s_and_b32 s0, s0, 255
    s_lshl_b32 s65, s0, 2
    s_load_dword s47, s[8:9], 0
    s_load_dword s46, s[44:45], s65
    buffer_load_dwordx4 v[224:227], v23, s[4:7], s66 offen sc1
    buffer_load_dwordx4 v[228:231], v23, s[4:7], s66 offen offset:512 sc1
    v_and_b32 v248, 31, v0
    v_min_u32 v248, 1, v248
    v_lshl_add_u32 v248, v248, 30, v22
    v_lshrrev_b32 v8, 5, v0
    v_lshlrev_b32 v1, 12, v8
    v_bfe_u32 v8, v0, 4, 1
    v_lshl_add_u32 v1, v8, 10, v1
    v_bfe_u32 v8, v0, 2, 2
    v_lshl_add_u32 v1, v8, 7, v1
    v_bfe_u32 v8, v0, 3, 2
    v_xor_b32 v8, s48, v8
    v_lshl_add_u32 v1, v8, 5, v1
    v_and_b32 v8, 3, v0
    v_lshl_add_u32 v1, v8, 3, v1
    v_add_u32 v1, 67584, v1
    v_and_b32 v8, 15, v0
    v_lshrrev_b32 v9, 4, v0
    v_bfe_u32 v10, v0, 1, 3
    v_xor_b32 v10, v10, v9
    v_lshlrev_b32 v2, 7, v8
    v_lshl_add_u32 v2, v10, 4, v2
    v_xor_b32 v3, 64, v2
    v_add_u32 v2, 67584, v2
    v_add_u32 v3, 67584, v3
    v_mul_u32_u24 v6, 1056, v8
    v_lshl_add_u32 v6, v9, 4, v6
    v_mov_b32 v112, 0x3f803f80
    v_mov_b32 v113, 0x3f803f80
    v_mov_b32 v114, 0x3f803f80
    v_mov_b32 v115, 0x3f803f80
    s_mov_b32 s10, 12582912
    s_mov_b32 s11, 0x00020000
    s_mov_b64 exec, 0
    s_cmp_eq_u32 s48, 0
    s_cbranch_scc1 L_stub_GA_1_0
    s_cmp_eq_u32 s48, 1
    s_cbranch_scc1 L_stub_GA_2_0
    s_cmp_eq_u32 s48, 2
    s_cbranch_scc1 L_stub_GA_3_0
    s_cmp_eq_u32 s48, 3
    s_cbranch_scc1 L_stub_GA_4_0
L_warm:
    s_mov_b64 exec, -1
    s_waitcnt lgkmcnt(0)
    s_add_u32 s47, s47, 0x9e3779b1
    v_mov_b32 v10, s47
    s_setprio 2
    s_barrier
    ds_read_b64_tr_b16 v[128:129], v1 offset:24576
    ds_read_b64_tr_b16 v[130:131], v1 offset:25088
    ds_read_b64_tr_b16 v[132:133], v1 offset:26624
    ds_read_b64_tr_b16 v[134:135], v1 offset:27136
    ds_read_b64_tr_b16 v[136:137], v1 offset:32768
    ds_read_b64_tr_b16 v[138:139], v1 offset:33280
    ds_read_b64_tr_b16 v[140:141], v1 offset:34816
    ds_read_b64_tr_b16 v[142:143], v1 offset:35328
    ds_read_b128 v[16:19], v2 offset:40960
    ds_read_b128 v[20:23], v3 offset:40960
    ds_read_b128 v[24:27], v2 offset:43008
    ds_read_b128 v[28:31], v3 offset:43008
    s_waitcnt lgkmcnt(2)
    ds_read_b128 v[32:35], v2 offset:45056
    ds_read_b128 v[36:39], v3 offset:45056
    s_waitcnt vmcnt(0)
    v_lshlrev_b32 v232, 16, v224
    v_and_b32 v233, 0xffff0000, v224
    v_lshlrev_b32 v234, 16, v225
    v_mfma_f32_16x16x32_bf16 v[48:51], v[128:131], v[16:19], 0
    v_and_b32 v235, 0xffff0000, v225
    v_lshlrev_b32 v236, 16, v226
    v_and_b32 v237, 0xffff0000, v226
    v_mfma_f32_16x16x32_bf16 v[48:51], v[136:139], v[20:23], v[48:51]
    v_lshlrev_b32 v238, 16, v227
    v_and_b32 v239, 0xffff0000, v227
    v_lshlrev_b32 v240, 16, v228
    v_mfma_f32_16x16x32_bf16 v[56:59], v[132:135], v[16:19], 0
    v_and_b32 v241, 0xffff0000, v228
    v_lshlrev_b32 v242, 16, v229
    v_and_b32 v243, 0xffff0000, v229
    v_mfma_f32_16x16x32_bf16 v[56:59], v[140:143], v[20:23], v[56:59]
    s_waitcnt lgkmcnt(2)
    ds_read_b128 v[40:43], v2 offset:47104
    ds_read_b128 v[44:47], v3 offset:47104
    v_lshlrev_b32 v244, 16, v230
    v_and_b32 v245, 0xffff0000, v230
    v_lshlrev_b32 v246, 16, v231
    v_mfma_f32_16x16x32_bf16 v[60:63], v[132:135], v[24:27], 0
    v_and_b32 v247, 0xffff0000, v231
    v_add_f32 v224, v232, v233
    v_add_f32 v225, v234, v235
    v_mfma_f32_16x16x32_bf16 v[60:63], v[140:143], v[28:31], v[60:63]
    v_add_f32 v226, v236, v237
    v_add_f32 v227, v238, v239
    v_add_f32 v228, v240, v241
    v_mfma_f32_16x16x32_bf16 v[52:55], v[128:131], v[24:27], 0
    v_add_f32 v229, v242, v243
    v_add_f32 v230, v244, v245
    v_add_f32 v231, v246, v247
    v_mfma_f32_16x16x32_bf16 v[52:55], v[136:139], v[28:31], v[52:55]
    s_waitcnt lgkmcnt(2)
    v_add_f32 v224, v224, v228
    v_add_f32 v225, v225, v229
    v_add_f32 v226, v226, v230
    v_mfma_f32_16x16x32_bf16 v[64:67], v[128:131], v[32:35], 0
    v_add_f32 v227, v227, v231
    v_add_f32 v224, v224, v226
    v_add_f32 v225, v225, v227
    v_mfma_f32_16x16x32_bf16 v[64:67], v[136:139], v[36:39], v[64:67]
    v_add_f32 v224, v224, v225
    s_nop 1
    v_add_f32_dpp v224, v224, v224 row_ror:8 row_mask:0xf bank_mask:0xf
    s_nop 1
    v_add_f32_dpp v224, v224, v224 row_ror:4 row_mask:0xf bank_mask:0xf
    v_mfma_f32_16x16x32_bf16 v[72:75], v[132:135], v[32:35], 0
    s_nop 0
    v_add_f32_dpp v224, v224, v224 row_ror:2 row_mask:0xf bank_mask:0xf
    s_nop 1
    v_add_f32_dpp v224, v224, v224 row_ror:1 row_mask:0xf bank_mask:0xf
    v_mov_b32 v225, v224
    v_mfma_f32_16x16x32_bf16 v[72:75], v[140:143], v[36:39], v[72:75]
    s_waitcnt lgkmcnt(0)
    s_barrier
    ds_read_b64_tr_b16 v[144:145], v1 offset:49152
    ds_read_b64_tr_b16 v[146:147], v1 offset:49664
    ds_read_b64_tr_b16 v[148:149], v1 offset:51200
    ds_read_b64_tr_b16 v[150:151], v1 offset:51712
    ds_read_b64_tr_b16 v[152:153], v1 offset:57344
    ds_read_b64_tr_b16 v[154:155], v1 offset:57856
    ds_read_b64_tr_b16 v[156:157], v1 offset:59392
    ds_read_b64_tr_b16 v[158:159], v1 offset:59904
    v_add_u32 v2, 0xc000, v2
    ds_read_b128 v[16:19], v2 offset:16384
    v_add_u32 v3, 0xc000, v3
    ds_read_b128 v[20:23], v3 offset:16384
    ds_read_b128 v[24:27], v2 offset:18432
    ds_read_b128 v[28:31], v3 offset:18432
    v_permlane16_swap_b32 v224, v225
    v_add_f32 v224, v224, v225
    v_mul_f32 v224, 0x3b000000, v224
    v_mfma_f32_16x16x32_bf16 v[76:79], v[132:135], v[40:43], 0
    v_sub_f32 v232, v232, v224
    v_sub_f32 v233, v233, v224
    v_sub_f32 v234, v234, v224
    v_mfma_f32_16x16x32_bf16 v[76:79], v[140:143], v[44:47], v[76:79]
    v_sub_f32 v235, v235, v224
    v_sub_f32 v236, v236, v224
    v_sub_f32 v237, v237, v224
    v_mfma_f32_16x16x32_bf16 v[68:71], v[128:131], v[40:43], 0
    v_sub_f32 v238, v238, v224
    v_sub_f32 v239, v239, v224
    v_sub_f32 v240, v240, v224
    v_mfma_f32_16x16x32_bf16 v[68:71], v[136:139], v[44:47], v[68:71]
    v_mfma_f32_16x16x32_bf16 v[80:83], v[128:131], v[112:115], 0
    v_mfma_f32_16x16x32_bf16 v[80:83], v[136:139], v[112:115], v[80:83]
    v_mfma_f32_16x16x32_bf16 v[84:87], v[132:135], v[112:115], 0
    v_mfma_f32_16x16x32_bf16 v[84:87], v[140:143], v[112:115], v[84:87]
    s_waitcnt lgkmcnt(2)
    ds_read_b128 v[32:35], v2 offset:20480
    ds_read_b128 v[36:39], v3 offset:20480
    v_sub_f32 v241, v241, v224
    v_sub_f32 v242, v242, v224
    v_sub_f32 v243, v243, v224
    v_mfma_f32_16x16x32_bf16 v[48:51], v[144:147], v[16:19], v[48:51]
    v_sub_f32 v244, v244, v224
    v_sub_f32 v245, v245, v224
    v_sub_f32 v246, v246, v224
    v_mfma_f32_16x16x32_bf16 v[48:51], v[152:155], v[20:23], v[48:51]
    v_sub_f32 v247, v247, v224
    v_mul_f32 v226, v232, v232
    v_mul_f32 v227, v233, v233
    v_mfma_f32_16x16x32_bf16 v[56:59], v[156:159], v[20:23], v[56:59]
    v_fmac_f32 v226, v234, v234
    v_fmac_f32 v227, v235, v235
    v_fmac_f32 v226, v236, v236
    v_mfma_f32_16x16x32_bf16 v[56:59], v[148:151], v[16:19], v[56:59]
    s_waitcnt lgkmcnt(2)
    ds_read_b128 v[40:43], v2 offset:22528
    ds_read_b128 v[44:47], v3 offset:22528
    v_fmac_f32 v227, v237, v237
    v_fmac_f32 v226, v238, v238
    v_fmac_f32 v227, v239, v239
    v_mfma_f32_16x16x32_bf16 v[60:63], v[148:151], v[24:27], v[60:63]
    v_fmac_f32 v226, v240, v240
    v_fmac_f32 v227, v241, v241
    v_fmac_f32 v226, v242, v242
    v_mfma_f32_16x16x32_bf16 v[60:63], v[156:159], v[28:31], v[60:63]
    v_fmac_f32 v227, v243, v243
    v_fmac_f32 v226, v244, v244
    v_fmac_f32 v227, v245, v245
    v_mfma_f32_16x16x32_bf16 v[52:55], v[152:155], v[28:31], v[52:55]
    v_fmac_f32 v226, v246, v246
    v_fmac_f32 v227, v247, v247
    v_add_f32 v226, v226, v227
    v_mfma_f32_16x16x32_bf16 v[52:55], v[144:147], v[24:27], v[52:55]
    s_waitcnt lgkmcnt(2)
    v_add_f32_dpp v226, v226, v226 row_ror:8 row_mask:0xf bank_mask:0xf
    s_nop 1
    v_add_f32_dpp v226, v226, v226 row_ror:4 row_mask:0xf bank_mask:0xf
    s_nop 1
    v_add_f32_dpp v226, v226, v226 row_ror:2 row_mask:0xf bank_mask:0xf
    v_mfma_f32_16x16x32_bf16 v[64:67], v[144:147], v[32:35], v[64:67]
    s_nop 0
    v_add_f32_dpp v226, v226, v226 row_ror:1 row_mask:0xf bank_mask:0xf
    v_mov_b32 v227, v226
    s_nop 1
    v_permlane16_swap_b32 v226, v227
    v_mfma_f32_16x16x32_bf16 v[64:67], v[152:155], v[36:39], v[64:67]
    v_add_f32 v226, v226, v227
    v_mul_f32 v226, 0x3b000000, v226
    v_cvt_pk_bf16_f32 v226, v226, v226
    v_mfma_f32_16x16x32_bf16 v[72:75], v[156:159], v[36:39], v[72:75]
    v_and_b32 v226, 0xffff0000, v226
    v_add_f32 v226, 0x3727c5ac, v226
    v_cvt_pk_bf16_f32 v226, v226, v226
    v_mfma_f32_16x16x32_bf16 v[72:75], v[148:151], v[32:35], v[72:75]
    s_waitcnt lgkmcnt(0)
    s_barrier
    ds_read_b64_tr_b16 v[160:161], v1 offset:0
    ds_read_b64_tr_b16 v[162:163], v1 offset:512
    ds_read_b64_tr_b16 v[164:165], v1 offset:2048
    ds_read_b64_tr_b16 v[166:167], v1 offset:2560
    ds_read_b64_tr_b16 v[168:169], v1 offset:8192
    ds_read_b64_tr_b16 v[170:171], v1 offset:8704
    ds_read_b64_tr_b16 v[172:173], v1 offset:10240
    ds_read_b64_tr_b16 v[174:175], v1 offset:10752
    v_add_u32 v2, 0xffff4000, v2
    ds_read_b128 v[16:19], v2 offset:16384
    v_add_u32 v3, 0xffff4000, v3
    ds_read_b128 v[20:23], v3 offset:16384
    ds_read_b128 v[24:27], v2 offset:18432
    ds_read_b128 v[28:31], v3 offset:18432
    v_and_b32 v226, 0xffff0000, v226
    v_sqrt_f32 v226, v226
    s_nop 0
    v_cvt_pk_bf16_f32 v226, v224, v226
    v_mfma_f32_16x16x32_bf16 v[76:79], v[148:151], v[40:43], v[76:79]
    v_lshlrev_b32 v229, 16, v226
    v_and_b32 v226, 0xffff0000, v226
    v_mfma_f32_16x16x32_bf16 v[76:79], v[156:159], v[44:47], v[76:79]
    v_rcp_f32 v226, v226
    s_nop 0
    v_mul_f32 v230, 0xc0135761, v226
    v_mfma_f32_16x16x32_bf16 v[68:71], v[152:155], v[44:47], v[68:71]
    v_mul_f32 v226, v226, v226
    v_mul_f32 v226, 0x3d372713, v226
    v_mul_f32 v231, v226, v230
    v_mfma_f32_16x16x32_bf16 v[68:71], v[144:147], v[40:43], v[68:71]
    v_mfma_f32_16x16x32_bf16 v[80:83], v[144:147], v[112:115], v[80:83]
    v_mfma_f32_16x16x32_bf16 v[80:83], v[152:155], v[112:115], v[80:83]
    v_mfma_f32_16x16x32_bf16 v[84:87], v[148:151], v[112:115], v[84:87]
    v_mfma_f32_16x16x32_bf16 v[84:87], v[156:159], v[112:115], v[84:87]
    s_waitcnt lgkmcnt(2)
    ds_read_b128 v[32:35], v2 offset:20480
    ds_read_b128 v[36:39], v3 offset:20480
    v_mov_b32 v228, s47
    buffer_store_dwordx4 v[228:231], v248, s[8:11], 0 offen sc1
    v_and_b32 v7, 15, v0
    v_mfma_f32_16x16x32_bf16 v[48:51], v[160:163], v[16:19], v[48:51]
    v_lshlrev_b32 v7, 4, v7
    v_add_u32 v7, 159744, v7
    s_lshl_b32 s66, s53, 12
    v_mfma_f32_16x16x32_bf16 v[48:51], v[168:171], v[20:23], v[48:51]
    s_add_u32 s66, s66, s61
    s_add_u32 s66, s66, 5242880
    s_add_u32 s65, s3, 0
    v_mfma_f32_16x16x32_bf16 v[56:59], v[172:175], v[20:23], v[56:59]
    s_and_b32 s65, s65, 3
    s_lshl_b32 s65, s65, 6
    s_add_u32 s65, s65, s52
    v_mfma_f32_16x16x32_bf16 v[56:59], v[164:167], v[16:19], v[56:59]
    s_waitcnt lgkmcnt(2)
    ds_read_b128 v[40:43], v2 offset:22528
    ds_read_b128 v[44:47], v3 offset:22528
    s_mul_i32 s20, s65, 3584
    s_add_u32 s20, s20, s66
    s_add_u32 s21, s20, 114688
    v_mfma_f32_16x16x32_bf16 v[60:63], v[164:167], v[24:27], v[60:63]
    s_add_u32 s65, s3, 1
    s_and_b32 s65, s65, 3
    s_lshl_b32 s65, s65, 6
    v_mfma_f32_16x16x32_bf16 v[60:63], v[172:175], v[28:31], v[60:63]
    s_add_u32 s65, s65, s52
    s_mul_i32 s22, s65, 3584
    s_add_u32 s22, s22, s66
    v_mfma_f32_16x16x32_bf16 v[52:55], v[168:171], v[28:31], v[52:55]
    s_add_u32 s23, s22, 114688
    s_add_u32 s65, s3, 2
    s_and_b32 s65, s65, 3
    v_mfma_f32_16x16x32_bf16 v[52:55], v[160:163], v[24:27], v[52:55]
    s_waitcnt lgkmcnt(2)
    s_lshl_b32 s65, s65, 6
    s_add_u32 s65, s65, s52
    s_mul_i32 s24, s65, 3584
    v_mfma_f32_16x16x32_bf16 v[64:67], v[160:163], v[32:35], v[64:67]
    s_add_u32 s24, s24, s66
    s_add_u32 s25, s24, 114688
    s_mul_i32 s36, s65, 112
    v_mfma_f32_16x16x32_bf16 v[64:67], v[168:171], v[36:39], v[64:67]
    s_lshl_b32 s67, s53, 7
    s_add_u32 s36, s36, s67
    s_lshl_b32 s67, s48, 2
    v_mfma_f32_16x16x32_bf16 v[72:75], v[172:175], v[36:39], v[72:75]
    s_add_u32 s36, s36, s67
    s_add_u32 s36, s36, 262144
    s_add_u32 s37, s36, 3584
    v_mfma_f32_16x16x32_bf16 v[72:75], v[164:167], v[32:35], v[72:75]
    s_waitcnt lgkmcnt(0)
    s_barrier
    ds_read_b64_tr_b16 v[176:177], v1 offset:24576
    ds_read_b64_tr_b16 v[178:179], v1 offset:25088
    ds_read_b64_tr_b16 v[180:181], v1 offset:26624
    ds_read_b64_tr_b16 v[182:183], v1 offset:27136
    ds_read_b64_tr_b16 v[184:185], v1 offset:32768
    ds_read_b64_tr_b16 v[186:187], v1 offset:33280
    ds_read_b64_tr_b16 v[188:189], v1 offset:34816
    ds_read_b64_tr_b16 v[190:191], v1 offset:35328
    ds_read_b128 v[16:19], v2 offset:40960
    ds_read_b128 v[20:23], v3 offset:40960
    ds_read_b128 v[24:27], v2 offset:43008
    ds_read_b128 v[28:31], v3 offset:43008
    s_add_u32 s65, s3, 3
    s_and_b32 s65, s65, 3
    s_lshl_b32 s65, s65, 6
    v_mfma_f32_16x16x32_bf16 v[76:79], v[164:167], v[40:43], v[76:79]
    s_add_u32 s65, s65, s52
    s_mul_i32 s26, s65, 3584
    s_add_u32 s26, s26, s66
    v_mfma_f32_16x16x32_bf16 v[76:79], v[172:175], v[44:47], v[76:79]
    s_add_u32 s27, s26, 114688
    s_mul_i32 s38, s65, 112
    s_lshl_b32 s67, s53, 7
    v_mfma_f32_16x16x32_bf16 v[68:71], v[168:171], v[44:47], v[68:71]
    s_add_u32 s38, s38, s67
    s_lshl_b32 s67, s48, 2
    s_add_u32 s38, s38, s67
    v_mfma_f32_16x16x32_bf16 v[68:71], v[160:163], v[40:43], v[68:71]
    v_mfma_f32_16x16x32_bf16 v[80:83], v[160:163], v[112:115], v[80:83]
    v_mfma_f32_16x16x32_bf16 v[80:83], v[168:171], v[112:115], v[80:83]
    v_mfma_f32_16x16x32_bf16 v[84:87], v[164:167], v[112:115], v[84:87]
    v_mfma_f32_16x16x32_bf16 v[84:87], v[172:175], v[112:115], v[84:87]
    s_waitcnt lgkmcnt(2)
    ds_read_b128 v[32:35], v2 offset:45056
    ds_read_b128 v[36:39], v3 offset:45056
    s_add_u32 s38, s38, 262144
    s_add_u32 s39, s38, 3584
    s_lshr_b32 s55, s52, 6
    v_mfma_f32_16x16x32_bf16 v[48:51], v[176:179], v[16:19], v[48:51]
    s_add_u32 s65, s3, 0
    s_and_b32 s65, s65, 3
    s_add_u32 s55, s55, s65
    v_mfma_f32_16x16x32_bf16 v[48:51], v[184:187], v[20:23], v[48:51]
    s_xor_b32 s56, s56, 4
    v_and_b32 v121, 15, v0
    v_sub_u32 v122, 15, v121
    v_mfma_f32_16x16x32_bf16 v[56:59], v[188:191], v[20:23], v[56:59]
    v_and_b32 v122, 3, v122
    v_add_u32 v8, v121, v122
    v_lshlrev_b32 v8, 1, v8
    v_mfma_f32_16x16x32_bf16 v[56:59], v[180:183], v[16:19], v[56:59]
    s_waitcnt lgkmcnt(2)
    ds_read_b128 v[40:43], v2 offset:47104
    ds_read_b128 v[44:47], v3 offset:47104
    v_mul_u32_u24 v122, 4160, v122
    v_add_u32 v8, v8, v122
    v_lshrrev_b32 v122, 4, v0
    v_mfma_f32_16x16x32_bf16 v[60:63], v[180:183], v[24:27], v[60:63]
    v_lshl_add_u32 v8, v122, 4, v8
    s_lshr_b32 s65, s48, 1
    s_mul_i32 s66, s65, 16640
    v_mfma_f32_16x16x32_bf16 v[60:63], v[188:191], v[28:31], v[60:63]
    s_and_b32 s67, s48, 1
    s_lshl_b32 s67, s67, 8
    s_add_u32 s66, s66, s67
    v_mfma_f32_16x16x32_bf16 v[52:55], v[184:187], v[28:31], v[52:55]
    s_add_u32 s66, s66, 2
    v_add_u32 v8, s66, v8
    v_lshlrev_b32 v9, 4, v122
    v_mfma_f32_16x16x32_bf16 v[52:55], v[176:179], v[24:27], v[52:55]
    s_waitcnt lgkmcnt(2)
    v_lshlrev_b32 v121, 5, v121
    v_sub_u32 v9, v9, v121
    s_mul_i32 s66, s65, 5120
    v_mfma_f32_16x16x32_bf16 v[64:67], v[176:179], v[32:35], v[64:67]
    s_add_u32 s66, s66, s67
    s_add_u32 s66, s66, 151008
    v_add_u32 v9, s66, v9
    v_mfma_f32_16x16x32_bf16 v[64:67], v[184:187], v[36:39], v[64:67]
    v_lshlrev_b32 v15, 4, v0
    v_min_u32 v11, 1, v0
    v_lshlrev_b32 v11, 30, v11
    v_mfma_f32_16x16x32_bf16 v[72:75], v[188:191], v[36:39], v[72:75]
    v_bfe_u32 v121, v0, 4, 1
    v_lshlrev_b32 v12, 9, v121
    v_lshrrev_b32 v121, 5, v0
    v_mfma_f32_16x16x32_bf16 v[72:75], v[180:183], v[32:35], v[72:75]
    s_waitcnt lgkmcnt(0)
    s_barrier
    ds_read_b64_tr_b16 v[192:193], v1 offset:49152
    ds_read_b64_tr_b16 v[194:195], v1 offset:49664
    ds_read_b64_tr_b16 v[196:197], v1 offset:51200
    ds_read_b64_tr_b16 v[198:199], v1 offset:51712
    ds_read_b64_tr_b16 v[200:201], v1 offset:57344
    ds_read_b64_tr_b16 v[202:203], v1 offset:57856
    ds_read_b64_tr_b16 v[204:205], v1 offset:59392
    ds_read_b64_tr_b16 v[206:207], v1 offset:59904
    v_add_u32 v2, 0xc000, v2
    ds_read_b128 v[16:19], v2 offset:16384
    v_add_u32 v3, 0xc000, v3
    ds_read_b128 v[20:23], v3 offset:16384
    ds_read_b128 v[24:27], v2 offset:18432
    ds_read_b128 v[28:31], v3 offset:18432
    v_lshl_add_u32 v12, v121, 4, v12
    v_and_b32 v121, 15, v0
    v_lshl_add_u32 v12, v121, 5, v12
    v_mfma_f32_16x16x32_bf16 v[76:79], v[180:183], v[40:43], v[76:79]
    s_lshl_b32 s34, s0, 13
    s_lshr_b32 s66, s48, 1
    s_lshl_b32 s66, s66, 12
    v_mfma_f32_16x16x32_bf16 v[76:79], v[188:191], v[44:47], v[76:79]
    s_add_u32 s34, s34, s66
    s_add_u32 s34, s34, 3145728
    v_lshrrev_b32 v121, 3, v0
    v_mfma_f32_16x16x32_bf16 v[68:71], v[184:187], v[44:47], v[68:71]
    v_mul_u32_u24 v121, 384, v121
    v_add_u32 v121, v121, v15
    s_lshr_b32 s66, s48, 1
    v_mfma_f32_16x16x32_bf16 v[68:71], v[176:179], v[40:43], v[68:71]
    v_mfma_f32_16x16x32_bf16 v[80:83], v[176:179], v[112:115], v[80:83]
    v_mfma_f32_16x16x32_bf16 v[80:83], v[184:187], v[112:115], v[80:83]
    v_mfma_f32_16x16x32_bf16 v[84:87], v[180:183], v[112:115], v[84:87]
    v_mfma_f32_16x16x32_bf16 v[84:87], v[188:191], v[112:115], v[84:87]
    s_waitcnt lgkmcnt(2)
    ds_read_b128 v[32:35], v2 offset:20480
    ds_read_b128 v[36:39], v3 offset:20480
    s_mul_i32 s66, s66, 16640
    s_add_u32 s66, s66, 96
    v_add_u32 v121, s66, v121
    v_mfma_f32_16x16x32_bf16 v[48:51], v[192:195], v[16:19], v[48:51]
    v_add_u32 v13, s67, v121
    s_xor_b32 s67, s67, 256
    v_add_u32 v14, s67, v121
    v_mfma_f32_16x16x32_bf16 v[48:51], v[200:203], v[20:23], v[48:51]
    s_lshr_b32 s67, s67, 8
    s_lshl_b32 s67, s67, 10
    v_bfe_u32 v121, v0, 4, 1
    v_mfma_f32_16x16x32_bf16 v[56:59], v[204:207], v[20:23], v[56:59]
    v_mad_u32_u24 v12, v121, s67, v12
    s_lshl_b32 s66, s48, 2
    s_add_u32 s66, s66, 155136
    v_mfma_f32_16x16x32_bf16 v[56:59], v[196:199], v[16:19], v[56:59]
    s_waitcnt lgkmcnt(2)
    ds_read_b128 v[40:43], v2 offset:22528
    ds_read_b128 v[44:47], v3 offset:22528
    v_mov_b32 v5, s66
    s_mov_b32 s18, 2097152
    s_mov_b32 s19, 0x00020000
    v_mfma_f32_16x16x32_bf16 v[60:63], v[196:199], v[24:27], v[60:63]
    s_and_b32 s65, s48, 1
    s_lshl_b32 s65, s65, 15
    s_lshr_b32 s66, s48, 1
    v_mfma_f32_16x16x32_bf16 v[60:63], v[204:207], v[28:31], v[60:63]
    s_lshl_b32 s66, s66, 2
    s_add_u32 s65, s65, s66
    s_lshl_b32 s66, s0, 7
    v_mfma_f32_16x16x32_bf16 v[52:55], v[200:203], v[28:31], v[52:55]
    s_add_u32 s65, s65, s66
    s_add_u32 s71, s65, 131072
    v_mfma_f32_16x16x32_bf16 v[52:55], v[192:195], v[24:27], v[52:55]
    s_waitcnt lgkmcnt(2)
    v_mfma_f32_16x16x32_bf16 v[64:67], v[192:195], v[32:35], v[64:67]
    v_mfma_f32_16x16x32_bf16 v[64:67], v[200:203], v[36:39], v[64:67]
    v_mfma_f32_16x16x32_bf16 v[72:75], v[204:207], v[36:39], v[72:75]
    v_mfma_f32_16x16x32_bf16 v[72:75], v[196:199], v[32:35], v[72:75]
    s_waitcnt lgkmcnt(0)
    s_barrier
    ds_read_b64_tr_b16 v[208:209], v1 offset:0
    ds_read_b64_tr_b16 v[210:211], v1 offset:512
    ds_read_b64_tr_b16 v[212:213], v1 offset:2048
    ds_read_b64_tr_b16 v[214:215], v1 offset:2560
    ds_read_b64_tr_b16 v[216:217], v1 offset:8192
    ds_read_b64_tr_b16 v[218:219], v1 offset:8704
    ds_read_b64_tr_b16 v[220:221], v1 offset:10240
    ds_read_b64_tr_b16 v[222:223], v1 offset:10752
    v_add_u32 v2, 0xffff4000, v2
    ds_read_b128 v[16:19], v2 offset:16384
    v_add_u32 v3, 0xffff4000, v3
    ds_read_b128 v[20:23], v3 offset:16384
    ds_read_b128 v[24:27], v2 offset:18432
    ds_read_b128 v[28:31], v3 offset:18432
    v_mfma_f32_16x16x32_bf16 v[76:79], v[196:199], v[40:43], v[76:79]
    v_mfma_f32_16x16x32_bf16 v[76:79], v[204:207], v[44:47], v[76:79]
    v_mfma_f32_16x16x32_bf16 v[68:71], v[200:203], v[44:47], v[68:71]
    v_mfma_f32_16x16x32_bf16 v[68:71], v[192:195], v[40:43], v[68:71]
    v_mfma_f32_16x16x32_bf16 v[80:83], v[192:195], v[112:115], v[80:83]
    v_mfma_f32_16x16x32_bf16 v[80:83], v[200:203], v[112:115], v[80:83]
    v_mfma_f32_16x16x32_bf16 v[84:87], v[196:199], v[112:115], v[84:87]
    v_mfma_f32_16x16x32_bf16 v[84:87], v[204:207], v[112:115], v[84:87]
    s_waitcnt lgkmcnt(2)
    ds_read_b128 v[32:35], v2 offset:20480
    ds_read_b128 v[36:39], v3 offset:20480
    v_mfma_f32_16x16x32_bf16 v[48:51], v[208:211], v[16:19], v[48:51]
    v_mfma_f32_16x16x32_bf16 v[48:51], v[216:219], v[20:23], v[48:51]
    v_mfma_f32_16x16x32_bf16 v[56:59], v[220:223], v[20:23], v[56:59]
    v_mfma_f32_16x16x32_bf16 v[56:59], v[212:215], v[16:19], v[56:59]
    s_waitcnt lgkmcnt(2)
    ds_read_b128 v[40:43], v2 offset:22528
    ds_read_b128 v[44:47], v3 offset:22528
    v_mfma_f32_16x16x32_bf16 v[60:63], v[212:215], v[24:27], v[60:63]
    v_mfma_f32_16x16x32_bf16 v[60:63], v[220:223], v[28:31], v[60:63]
    v_mfma_f32_16x16x32_bf16 v[52:55], v[216:219], v[28:31], v[52:55]
    v_mfma_f32_16x16x32_bf16 v[52:55], v[208:211], v[24:27], v[52:55]
    s_waitcnt lgkmcnt(2)
    v_mfma_f32_16x16x32_bf16 v[64:67], v[208:211], v[32:35], v[64:67]
    v_mfma_f32_16x16x32_bf16 v[64:67], v[216:219], v[36:39], v[64:67]
    v_mfma_f32_16x16x32_bf16 v[72:75], v[220:223], v[36:39], v[72:75]
    v_mfma_f32_16x16x32_bf16 v[72:75], v[212:215], v[32:35], v[72:75]
    s_waitcnt lgkmcnt(0)
    s_barrier
    ds_read_b64_tr_b16 v[224:225], v1 offset:24576
    ds_read_b64_tr_b16 v[226:227], v1 offset:25088
    ds_read_b64_tr_b16 v[228:229], v1 offset:26624
    ds_read_b64_tr_b16 v[230:231], v1 offset:27136
    ds_read_b64_tr_b16 v[232:233], v1 offset:32768
    ds_read_b64_tr_b16 v[234:235], v1 offset:33280
    ds_read_b64_tr_b16 v[236:237], v1 offset:34816
    ds_read_b64_tr_b16 v[238:239], v1 offset:35328
    ds_read_b128 v[16:19], v2 offset:40960
    ds_read_b128 v[20:23], v3 offset:40960
    ds_read_b128 v[24:27], v2 offset:43008
    ds_read_b128 v[28:31], v3 offset:43008
    v_mfma_f32_16x16x32_bf16 v[76:79], v[212:215], v[40:43], v[76:79]
    v_mfma_f32_16x16x32_bf16 v[76:79], v[220:223], v[44:47], v[76:79]
    v_mfma_f32_16x16x32_bf16 v[68:71], v[216:219], v[44:47], v[68:71]
    v_mfma_f32_16x16x32_bf16 v[68:71], v[208:211], v[40:43], v[68:71]
    v_mfma_f32_16x16x32_bf16 v[80:83], v[208:211], v[112:115], v[80:83]
    v_mfma_f32_16x16x32_bf16 v[80:83], v[216:219], v[112:115], v[80:83]
    v_mfma_f32_16x16x32_bf16 v[84:87], v[212:215], v[112:115], v[84:87]
    v_mfma_f32_16x16x32_bf16 v[84:87], v[220:223], v[112:115], v[84:87]
    s_waitcnt lgkmcnt(2)
    ds_read_b128 v[32:35], v2 offset:45056
    ds_read_b128 v[36:39], v3 offset:45056
    v_mfma_f32_16x16x32_bf16 v[48:51], v[224:227], v[16:19], v[48:51]
    v_mfma_f32_16x16x32_bf16 v[48:51], v[232:235], v[20:23], v[48:51]
    v_mfma_f32_16x16x32_bf16 v[56:59], v[236:239], v[20:23], v[56:59]
    v_mfma_f32_16x16x32_bf16 v[56:59], v[228:231], v[16:19], v[56:59]
    s_waitcnt lgkmcnt(2)
    ds_read_b128 v[40:43], v2 offset:47104
    ds_read_b128 v[44:47], v3 offset:47104
    v_mfma_f32_16x16x32_bf16 v[60:63], v[228:231], v[24:27], v[60:63]
    v_mfma_f32_16x16x32_bf16 v[60:63], v[236:239], v[28:31], v[60:63]
    v_mfma_f32_16x16x32_bf16 v[52:55], v[232:235], v[28:31], v[52:55]
    v_mfma_f32_16x16x32_bf16 v[52:55], v[224:227], v[24:27], v[52:55]
    s_waitcnt lgkmcnt(2)
    v_mfma_f32_16x16x32_bf16 v[64:67], v[224:227], v[32:35], v[64:67]
    v_mfma_f32_16x16x32_bf16 v[64:67], v[232:235], v[36:39], v[64:67]
    v_mfma_f32_16x16x32_bf16 v[72:75], v[236:239], v[36:39], v[72:75]
    v_mfma_f32_16x16x32_bf16 v[72:75], v[228:231], v[32:35], v[72:75]
    s_waitcnt lgkmcnt(0)
    s_barrier
    ds_read_b64_tr_b16 v[240:241], v1 offset:49152
    ds_read_b64_tr_b16 v[242:243], v1 offset:49664
    ds_read_b64_tr_b16 v[244:245], v1 offset:51200
    ds_read_b64_tr_b16 v[246:247], v1 offset:51712
    ds_read_b64_tr_b16 v[248:249], v1 offset:57344
    ds_read_b64_tr_b16 v[250:251], v1 offset:57856
    ds_read_b64_tr_b16 v[252:253], v1 offset:59392
    ds_read_b64_tr_b16 v[254:255], v1 offset:59904
    v_add_u32 v2, 0xc000, v2
    ds_read_b128 v[16:19], v2 offset:16384
    v_add_u32 v3, 0xc000, v3
    ds_read_b128 v[20:23], v3 offset:16384
    ds_read_b128 v[24:27], v2 offset:18432
    ds_read_b128 v[28:31], v3 offset:18432
    v_mfma_f32_16x16x32_bf16 v[76:79], v[228:231], v[40:43], v[76:79]
    v_mfma_f32_16x16x32_bf16 v[76:79], v[236:239], v[44:47], v[76:79]
    v_mfma_f32_16x16x32_bf16 v[68:71], v[232:235], v[44:47], v[68:71]
    v_mfma_f32_16x16x32_bf16 v[68:71], v[224:227], v[40:43], v[68:71]
    v_mfma_f32_16x16x32_bf16 v[80:83], v[224:227], v[112:115], v[80:83]
    v_mfma_f32_16x16x32_bf16 v[80:83], v[232:235], v[112:115], v[80:83]
    v_mfma_f32_16x16x32_bf16 v[84:87], v[228:231], v[112:115], v[84:87]
    v_mfma_f32_16x16x32_bf16 v[84:87], v[236:239], v[112:115], v[84:87]
    s_waitcnt lgkmcnt(2)
    ds_read_b128 v[32:35], v2 offset:20480
    ds_read_b128 v[36:39], v3 offset:20480
    v_mfma_f32_16x16x32_bf16 v[48:51], v[240:243], v[16:19], v[48:51]
    v_mfma_f32_16x16x32_bf16 v[48:51], v[248:251], v[20:23], v[48:51]
    v_mfma_f32_16x16x32_bf16 v[56:59], v[252:255], v[20:23], v[56:59]
    v_mfma_f32_16x16x32_bf16 v[56:59], v[244:247], v[16:19], v[56:59]
    s_waitcnt lgkmcnt(2)
    ds_read_b128 v[40:43], v2 offset:22528
    ds_read_b128 v[44:47], v3 offset:22528
    v_mfma_f32_16x16x32_bf16 v[60:63], v[244:247], v[24:27], v[60:63]
    v_mfma_f32_16x16x32_bf16 v[60:63], v[252:255], v[28:31], v[60:63]
    v_mfma_f32_16x16x32_bf16 v[52:55], v[248:251], v[28:31], v[52:55]
    v_mfma_f32_16x16x32_bf16 v[52:55], v[240:243], v[24:27], v[52:55]
    s_waitcnt lgkmcnt(2)
    v_mfma_f32_16x16x32_bf16 v[64:67], v[240:243], v[32:35], v[64:67]
    v_mfma_f32_16x16x32_bf16 v[64:67], v[248:251], v[36:39], v[64:67]
    v_mfma_f32_16x16x32_bf16 v[72:75], v[252:255], v[36:39], v[72:75]
    v_mfma_f32_16x16x32_bf16 v[72:75], v[244:247], v[32:35], v[72:75]
    s_waitcnt lgkmcnt(0)
    s_barrier
    v_lshrrev_b32 v4, 3, v0
    s_lshl_b32 s65, s48, 7
    s_add_u32 s65, s65, 159744
    v_lshl_add_u32 v4, v4, 4, s65
    ds_read_b32 v1, v4 offset:4
    ds_read_b32 v2, v4 offset:8
    ds_read_b32 v3, v4 offset:516
L_stub_GA_1_0:
    s_cbranch_execz L_stub_GB_1_0
    ds_read_b32 v4, v4 offset:520
    ds_read_b128 v[116:119], v7 offset:0
    ds_read_b128 v[120:123], v7 offset:256
    ds_read_b128 v[16:19], v6 offset:0
    ds_read_b128 v[20:23], v6 offset:64
    ds_read_b128 v[24:27], v6 offset:128
    ds_read_b128 v[28:31], v6 offset:192
    ds_read_b128 v[32:35], v6 offset:256
    ds_read_b128 v[36:39], v6 offset:320
    v_mfma_f32_16x16x32_bf16 v[76:79], v[244:247], v[40:43], v[76:79]
    v_mfma_f32_16x16x32_bf16 v[76:79], v[252:255], v[44:47], v[76:79]
    v_mfma_f32_16x16x32_bf16 v[68:71], v[248:251], v[44:47], v[68:71]
    v_mfma_f32_16x16x32_bf16 v[68:71], v[240:243], v[40:43], v[68:71]
    v_mfma_f32_16x16x32_bf16 v[80:83], v[240:243], v[112:115], v[80:83]
    v_mfma_f32_16x16x32_bf16 v[80:83], v[248:251], v[112:115], v[80:83]
    v_mfma_f32_16x16x32_bf16 v[84:87], v[244:247], v[112:115], v[84:87]
    v_mfma_f32_16x16x32_bf16 v[84:87], v[252:255], v[112:115], v[84:87]
    ds_read_b128 v[40:43], v6 offset:384
    ds_read_b128 v[44:47], v6 offset:448
    s_waitcnt lgkmcnt(4)
    s_nop 2
    v_fma_f32 v48, -v117, v80, v48
    v_fma_f32 v49, -v117, v81, v49
    v_mfma_f32_16x16x32_bf16 v[96:99], v[128:131], v[16:19], 0
    v_fma_f32 v50, -v117, v82, v50
    v_fma_f32 v51, -v117, v83, v51
    v_mfma_f32_16x16x32_bf16 v[96:99], v[136:139], v[20:23], v[96:99]
    v_fma_f32 v52, -v121, v80, v52
    v_fma_f32 v53, -v121, v81, v53
    v_mfma_f32_16x16x32_bf16 v[104:107], v[132:135], v[16:19], 0
    v_fma_f32 v54, -v121, v82, v54
    v_fma_f32 v55, -v121, v83, v55
    v_mfma_f32_16x16x32_bf16 v[104:107], v[140:143], v[20:23], v[104:107]
    ds_read_b128 v[16:19], v6 offset:512
    ds_read_b128 v[20:23], v6 offset:576
    v_mul_f32 v112, v48, v48
    v_mul_f32 v113, v49, v49
    v_mfma_f32_16x16x32_bf16 v[104:107], v[148:151], v[24:27], v[104:107]
    v_mul_f32 v114, v50, v50
    v_mul_f32 v115, v51, v51
    v_mfma_f32_16x16x32_bf16 v[104:107], v[156:159], v[28:31], v[104:107]
    v_mul_f32 v124, v52, v52
    v_mul_f32 v125, v53, v53
    v_mfma_f32_16x16x32_bf16 v[96:99], v[152:155], v[28:31], v[96:99]
    v_mul_f32 v126, v54, v54
    v_mul_f32 v127, v55, v55
    v_mfma_f32_16x16x32_bf16 v[96:99], v[144:147], v[24:27], v[96:99]
    ds_read_b128 v[24:27], v6 offset:640
    ds_read_b128 v[28:31], v6 offset:704
    s_waitcnt lgkmcnt(4)
    v_fma_f32 v112, v112, v119, v118
    v_fma_f32 v113, v113, v119, v118
    v_mfma_f32_16x16x32_bf16 v[96:99], v[160:163], v[32:35], v[96:99]
    v_fma_f32 v114, v114, v119, v118
    v_fma_f32 v115, v115, v119, v118
    v_mfma_f32_16x16x32_bf16 v[96:99], v[168:171], v[36:39], v[96:99]
    v_fma_f32 v124, v124, v123, v122
    v_fma_f32 v125, v125, v123, v122
    v_mfma_f32_16x16x32_bf16 v[104:107], v[172:175], v[36:39], v[104:107]
    v_fma_f32 v126, v126, v123, v122
    v_fma_f32 v127, v127, v123, v122
    v_mfma_f32_16x16x32_bf16 v[104:107], v[164:167], v[32:35], v[104:107]
    ds_read_b128 v[32:35], v6 offset:768
    ds_read_b128 v[36:39], v6 offset:832
    v_mul_f32 v112, v112, v48
    v_mul_f32 v113, v113, v49
    v_mfma_f32_16x16x32_bf16 v[104:107], v[180:183], v[40:43], v[104:107]
    v_mul_f32 v114, v114, v50
    v_mul_f32 v115, v115, v51
    v_mfma_f32_16x16x32_bf16 v[104:107], v[188:191], v[44:47], v[104:107]
    v_mul_f32 v124, v124, v52
    v_mul_f32 v125, v125, v53
    v_mfma_f32_16x16x32_bf16 v[96:99], v[184:187], v[44:47], v[96:99]
    v_mul_f32 v126, v126, v54
    v_mul_f32 v127, v127, v55
    v_mfma_f32_16x16x32_bf16 v[96:99], v[176:179], v[40:43], v[96:99]
    ds_read_b128 v[40:43], v6 offset:896
    ds_read_b128 v[44:47], v6 offset:960
    s_waitcnt lgkmcnt(4)
    v_exp_f32 v112, v112
    v_mfma_f32_16x16x32_bf16 v[96:99], v[192:195], v[16:19], v[96:99]
    v_fma_f32 v56, -v117, v84, v56
    v_fma_f32 v57, -v117, v85, v57
    v_mfma_f32_16x16x32_bf16 v[96:99], v[200:203], v[20:23], v[96:99]
    v_exp_f32 v113, v113
    v_mfma_f32_16x16x32_bf16 v[104:107], v[204:207], v[20:23], v[104:107]
    v_exp_f32 v114, v114
    v_mfma_f32_16x16x32_bf16 v[104:107], v[196:199], v[16:19], v[104:107]
    ds_read_b128 v[16:19], v6 offset:16896
    ds_read_b128 v[20:23], v6 offset:16960
    v_fma_f32 v58, -v117, v86, v58
    v_fma_f32 v59, -v117, v87, v59
    v_mfma_f32_16x16x32_bf16 v[104:107], v[212:215], v[24:27], v[104:107]
    v_exp_f32 v115, v115
    v_mfma_f32_16x16x32_bf16 v[104:107], v[220:223], v[28:31], v[104:107]
    v_exp_f32 v124, v124
    v_mfma_f32_16x16x32_bf16 v[96:99], v[216:219], v[28:31], v[96:99]
    v_fma_f32 v60, -v121, v84, v60
    v_fma_f32 v61, -v121, v85, v61
    v_mfma_f32_16x16x32_bf16 v[96:99], v[208:211], v[24:27], v[96:99]
    ds_read_b128 v[24:27], v6 offset:17024
    ds_read_b128 v[28:31], v6 offset:17088
    s_waitcnt lgkmcnt(4)
    v_exp_f32 v125, v125
    v_mfma_f32_16x16x32_bf16 v[96:99], v[224:227], v[32:35], v[96:99]
    v_exp_f32 v126, v126
    v_mfma_f32_16x16x32_bf16 v[96:99], v[232:235], v[36:39], v[96:99]
    v_fma_f32 v62, -v121, v86, v62
    v_fma_f32 v63, -v121, v87, v63
    v_mfma_f32_16x16x32_bf16 v[104:107], v[236:239], v[36:39], v[104:107]
    v_exp_f32 v127, v127
    v_mfma_f32_16x16x32_bf16 v[104:107], v[228:231], v[32:35], v[104:107]
    ds_read_b128 v[32:35], v6 offset:17152
    ds_read_b128 v[36:39], v6 offset:17216
    v_add_f32 v112, 1.0, v112
    v_add_f32 v113, 1.0, v113
    ds_read_b128 v[116:119], v7 offset:512
    ds_read_b128 v[120:123], v7 offset:768
    v_mfma_f32_16x16x32_bf16 v[104:107], v[244:247], v[40:43], v[104:107]
    v_add_f32 v114, 1.0, v114
    v_add_f32 v115, 1.0, v115
    v_mfma_f32_16x16x32_bf16 v[104:107], v[252:255], v[44:47], v[104:107]
    v_add_f32 v124, 1.0, v124
    v_add_f32 v125, 1.0, v125
    v_mfma_f32_16x16x32_bf16 v[96:99], v[248:251], v[44:47], v[96:99]
    v_add_f32 v126, 1.0, v126
    v_add_f32 v127, 1.0, v127
    v_mfma_f32_16x16x32_bf16 v[96:99], v[240:243], v[40:43], v[96:99]
    ds_read_b128 v[40:43], v6 offset:17280
    ds_read_b128 v[44:47], v6 offset:17344
    s_waitcnt lgkmcnt(6)
    v_rcp_f32 v112, v112
    v_mfma_f32_16x16x32_bf16 v[100:103], v[128:131], v[16:19], 0
    v_mul_f32 v56, v56, v48
    v_mul_f32 v57, v57, v49
    v_mfma_f32_16x16x32_bf16 v[100:103], v[136:139], v[20:23], v[100:103]
    v_rcp_f32 v113, v113
    v_mfma_f32_16x16x32_bf16 v[108:111], v[132:135], v[16:19], 0
    v_rcp_f32 v114, v114
    v_mfma_f32_16x16x32_bf16 v[108:111], v[140:143], v[20:23], v[108:111]
    ds_read_b128 v[16:19], v6 offset:17408
    ds_read_b128 v[20:23], v6 offset:17472
    v_mul_f32 v58, v58, v50
    v_mul_f32 v59, v59, v51
    v_mfma_f32_16x16x32_bf16 v[108:111], v[148:151], v[24:27], v[108:111]
    v_rcp_f32 v115, v115
    v_mfma_f32_16x16x32_bf16 v[108:111], v[156:159], v[28:31], v[108:111]
    v_rcp_f32 v124, v124
    v_mfma_f32_16x16x32_bf16 v[100:103], v[152:155], v[28:31], v[100:103]
    v_mul_f32 v60, v60, v52
    v_mul_f32 v61, v61, v53
    v_mfma_f32_16x16x32_bf16 v[100:103], v[144:147], v[24:27], v[100:103]
    ds_read_b128 v[24:27], v6 offset:17536
    ds_read_b128 v[28:31], v6 offset:17600
    s_waitcnt lgkmcnt(4)
    v_rcp_f32 v125, v125
    v_mfma_f32_16x16x32_bf16 v[100:103], v[160:163], v[32:35], v[100:103]
    v_rcp_f32 v126, v126
    v_mfma_f32_16x16x32_bf16 v[100:103], v[168:171], v[36:39], v[100:103]
    v_mul_f32 v62, v62, v54
    v_mul_f32 v63, v63, v55
    v_mfma_f32_16x16x32_bf16 v[108:111], v[172:175], v[36:39], v[108:111]
    v_rcp_f32 v127, v127
    v_mfma_f32_16x16x32_bf16 v[108:111], v[164:167], v[32:35], v[108:111]
    ds_read_b128 v[32:35], v6 offset:17664
    ds_read_b128 v[36:39], v6 offset:17728
    v_mul_f32 v56, v56, v112
    v_mul_f32 v57, v57, v113
    v_mfma_f32_16x16x32_bf16 v[108:111], v[180:183], v[40:43], v[108:111]
    v_mul_f32 v58, v58, v114
    v_mul_f32 v59, v59, v115
    v_mfma_f32_16x16x32_bf16 v[108:111], v[188:191], v[44:47], v[108:111]
    v_mul_f32 v60, v60, v124
    v_mul_f32 v61, v61, v125
    v_mfma_f32_16x16x32_bf16 v[100:103], v[184:187], v[44:47], v[100:103]
    v_mul_f32 v62, v62, v126
    v_mul_f32 v63, v63, v127
    v_mfma_f32_16x16x32_bf16 v[100:103], v[176:179], v[40:43], v[100:103]
    ds_read_b128 v[40:43], v6 offset:17792
    ds_read_b128 v[44:47], v6 offset:17856
    s_waitcnt lgkmcnt(4)
    v_cvt_pk_bf16_f32 v88, v56, v57
    v_cvt_pk_bf16_f32 v90, v60, v61
    v_mfma_f32_16x16x32_bf16 v[100:103], v[192:195], v[16:19], v[100:103]
    v_cvt_pk_bf16_f32 v89, v58, v59
    v_cvt_pk_bf16_f32 v91, v62, v63
    v_mfma_f32_16x16x32_bf16 v[100:103], v[200:203], v[20:23], v[100:103]
    v_permlane16_swap_b32 v88, v90
    v_permlane16_swap_b32 v89, v91
    v_mfma_f32_16x16x32_bf16 v[108:111], v[204:207], v[20:23], v[108:111]
    v_fma_f32 v64, -v117, v80, v64
    v_fma_f32 v65, -v117, v81, v65
    v_mfma_f32_16x16x32_bf16 v[108:111], v[196:199], v[16:19], v[108:111]
    v_fma_f32 v66, -v117, v82, v66
    v_fma_f32 v67, -v117, v83, v67
    v_mfma_f32_16x16x32_bf16 v[108:111], v[212:215], v[24:27], v[108:111]
    v_fma_f32 v68, -v121, v80, v68
    v_fma_f32 v69, -v121, v81, v69
    v_mfma_f32_16x16x32_bf16 v[108:111], v[220:223], v[28:31], v[108:111]
    v_fma_f32 v70, -v121, v82, v70
    v_fma_f32 v71, -v121, v83, v71
    v_mfma_f32_16x16x32_bf16 v[100:103], v[216:219], v[28:31], v[100:103]
    v_mul_f32 v112, v64, v64
    v_mul_f32 v113, v65, v65
    v_mfma_f32_16x16x32_bf16 v[100:103], v[208:211], v[24:27], v[100:103]
    s_waitcnt lgkmcnt(0)
    s_barrier
    buffer_store_dwordx4 v[88:91], v15, s[8:11], s20 offen sc1
    ds_read_b128 v[16:19], v6 offset:33792
    ds_read_b128 v[20:23], v6 offset:33856
    ds_read_b128 v[24:27], v6 offset:33920
    ds_read_b128 v[28:31], v6 offset:33984
    v_mul_f32 v114, v66, v66
    v_mul_f32 v115, v67, v67
    v_mfma_f32_16x16x32_bf16 v[100:103], v[224:227], v[32:35], v[100:103]
    v_mul_f32 v124, v68, v68
    v_mul_f32 v125, v69, v69
    v_mfma_f32_16x16x32_bf16 v[100:103], v[232:235], v[36:39], v[100:103]
    v_mul_f32 v126, v70, v70
    v_mul_f32 v127, v71, v71
    v_mfma_f32_16x16x32_bf16 v[108:111], v[236:239], v[36:39], v[108:111]
    v_fma_f32 v112, v112, v119, v118
    v_fma_f32 v113, v113, v119, v118
    v_mfma_f32_16x16x32_bf16 v[108:111], v[228:231], v[32:35], v[108:111]
    ds_read_b128 v[32:35], v6 offset:34048
    ds_read_b128 v[36:39], v6 offset:34112
    v_fma_f32 v114, v114, v119, v118
    v_fma_f32 v115, v115, v119, v118
    v_mfma_f32_16x16x32_bf16 v[108:111], v[244:247], v[40:43], v[108:111]
    v_fma_f32 v124, v124, v123, v122
    v_fma_f32 v125, v125, v123, v122
    v_mfma_f32_16x16x32_bf16 v[108:111], v[252:255], v[44:47], v[108:111]
    v_fma_f32 v126, v126, v123, v122
    v_fma_f32 v127, v127, v123, v122
    v_mfma_f32_16x16x32_bf16 v[100:103], v[248:251], v[44:47], v[100:103]
    v_mul_f32 v112, v112, v64
    v_mul_f32 v113, v113, v65
    v_mfma_f32_16x16x32_bf16 v[100:103], v[240:243], v[40:43], v[100:103]
    ds_read_b128 v[40:43], v6 offset:34176
    ds_read_b128 v[44:47], v6 offset:34240
    s_waitcnt lgkmcnt(4)
    v_mul_f32 v114, v114, v66
    v_mul_f32 v115, v115, v67
    v_mfma_f32_16x16x32_bf16 v[48:51], v[128:131], v[16:19], 0
    v_mul_f32 v124, v124, v68
    v_mul_f32 v125, v125, v69
    v_mfma_f32_16x16x32_bf16 v[48:51], v[136:139], v[20:23], v[48:51]
    v_mul_f32 v126, v126, v70
    v_mul_f32 v127, v127, v71
    v_mfma_f32_16x16x32_bf16 v[56:59], v[132:135], v[16:19], 0
    v_exp_f32 v112, v112
    v_mfma_f32_16x16x32_bf16 v[56:59], v[140:143], v[20:23], v[56:59]
    ds_read_b128 v[16:19], v6 offset:34304
    ds_read_b128 v[20:23], v6 offset:34368
    v_fma_f32 v72, -v117, v84, v72
    v_fma_f32 v73, -v117, v85, v73
    v_mfma_f32_16x16x32_bf16 v[56:59], v[148:151], v[24:27], v[56:59]
    v_exp_f32 v113, v113
    v_mfma_f32_16x16x32_bf16 v[56:59], v[156:159], v[28:31], v[56:59]
    v_exp_f32 v114, v114
    v_mfma_f32_16x16x32_bf16 v[48:51], v[152:155], v[28:31], v[48:51]
    v_fma_f32 v74, -v117, v86, v74
    v_fma_f32 v75, -v117, v87, v75
    v_mfma_f32_16x16x32_bf16 v[48:51], v[144:147], v[24:27], v[48:51]
    ds_read_b128 v[24:27], v6 offset:34432
    ds_read_b128 v[28:31], v6 offset:34496
    s_waitcnt lgkmcnt(4)
    v_exp_f32 v115, v115
    v_mfma_f32_16x16x32_bf16 v[48:51], v[160:163], v[32:35], v[48:51]
    v_exp_f32 v124, v124
    v_mfma_f32_16x16x32_bf16 v[48:51], v[168:171], v[36:39], v[48:51]
    v_fma_f32 v76, -v121, v84, v76
    v_fma_f32 v77, -v121, v85, v77
    v_mfma_f32_16x16x32_bf16 v[56:59], v[172:175], v[36:39], v[56:59]
    v_exp_f32 v125, v125
    v_mfma_f32_16x16x32_bf16 v[56:59], v[164:167], v[32:35], v[56:59]
    ds_read_b128 v[32:35], v6 offset:34560
    ds_read_b128 v[36:39], v6 offset:34624
    v_exp_f32 v126, v126
    v_mfma_f32_16x16x32_bf16 v[56:59], v[180:183], v[40:43], v[56:59]
    v_fma_f32 v78, -v121, v86, v78
    v_fma_f32 v79, -v121, v87, v79
    v_mfma_f32_16x16x32_bf16 v[56:59], v[188:191], v[44:47], v[56:59]
    v_exp_f32 v127, v127
    v_mfma_f32_16x16x32_bf16 v[48:51], v[184:187], v[44:47], v[48:51]
    v_add_f32 v112, 1.0, v112
    v_add_f32 v113, 1.0, v113
    ds_read_b128 v[116:119], v7 offset:1024
    ds_read_b128 v[120:123], v7 offset:1280
    v_mfma_f32_16x16x32_bf16 v[48:51], v[176:179], v[40:43], v[48:51]
    ds_read_b128 v[40:43], v6 offset:34688
    ds_read_b128 v[44:47], v6 offset:34752
    s_waitcnt lgkmcnt(6)
    v_add_f32 v114, 1.0, v114
    v_add_f32 v115, 1.0, v115
    v_mfma_f32_16x16x32_bf16 v[48:51], v[192:195], v[16:19], v[48:51]
    v_add_f32 v124, 1.0, v124
    v_add_f32 v125, 1.0, v125
    v_mfma_f32_16x16x32_bf16 v[48:51], v[200:203], v[20:23], v[48:51]
    v_add_f32 v126, 1.0, v126
    v_add_f32 v127, 1.0, v127
    v_mfma_f32_16x16x32_bf16 v[56:59], v[204:207], v[20:23], v[56:59]
    v_rcp_f32 v112, v112
    v_mfma_f32_16x16x32_bf16 v[56:59], v[196:199], v[16:19], v[56:59]
    ds_read_b128 v[16:19], v6 offset:50688
    ds_read_b128 v[20:23], v6 offset:50752
    v_mul_f32 v72, v72, v64
    v_mul_f32 v73, v73, v65
    v_mfma_f32_16x16x32_bf16 v[56:59], v[212:215], v[24:27], v[56:59]
    v_rcp_f32 v113, v113
    v_mfma_f32_16x16x32_bf16 v[56:59], v[220:223], v[28:31], v[56:59]
    v_rcp_f32 v114, v114
    v_mfma_f32_16x16x32_bf16 v[48:51], v[216:219], v[28:31], v[48:51]
    v_mul_f32 v74, v74, v66
    v_mul_f32 v75, v75, v67
    v_mfma_f32_16x16x32_bf16 v[48:51], v[208:211], v[24:27], v[48:51]
    ds_read_b128 v[24:27], v6 offset:50816
    ds_read_b128 v[28:31], v6 offset:50880
    s_waitcnt lgkmcnt(4)
    v_rcp_f32 v115, v115
    v_mfma_f32_16x16x32_bf16 v[48:51], v[224:227], v[32:35], v[48:51]
    v_rcp_f32 v124, v124
    v_mfma_f32_16x16x32_bf16 v[48:51], v[232:235], v[36:39], v[48:51]
    v_mul_f32 v76, v76, v68
    v_mul_f32 v77, v77, v69
    v_mfma_f32_16x16x32_bf16 v[56:59], v[236:239], v[36:39], v[56:59]
    v_rcp_f32 v125, v125
    v_mfma_f32_16x16x32_bf16 v[56:59], v[228:231], v[32:35], v[56:59]
    ds_read_b128 v[32:35], v6 offset:50944
    ds_read_b128 v[36:39], v6 offset:51008
    v_rcp_f32 v126, v126
    v_mfma_f32_16x16x32_bf16 v[56:59], v[244:247], v[40:43], v[56:59]
    v_mul_f32 v78, v78, v70
    v_mul_f32 v79, v79, v71
    v_mfma_f32_16x16x32_bf16 v[56:59], v[252:255], v[44:47], v[56:59]
    v_rcp_f32 v127, v127
    v_mfma_f32_16x16x32_bf16 v[48:51], v[248:251], v[44:47], v[48:51]
    v_mul_f32 v72, v72, v112
    v_mul_f32 v73, v73, v113
    v_mfma_f32_16x16x32_bf16 v[48:51], v[240:243], v[40:43], v[48:51]
    ds_read_b128 v[40:43], v6 offset:51072
    ds_read_b128 v[44:47], v6 offset:51136
    s_waitcnt lgkmcnt(4)
    v_mul_f32 v74, v74, v114
    v_mul_f32 v75, v75, v115
    v_mfma_f32_16x16x32_bf16 v[52:55], v[128:131], v[16:19], 0
    v_mul_f32 v76, v76, v124
    v_mul_f32 v77, v77, v125
    v_mfma_f32_16x16x32_bf16 v[52:55], v[136:139], v[20:23], v[52:55]
    v_mul_f32 v78, v78, v126
    v_mul_f32 v79, v79, v127
    v_mfma_f32_16x16x32_bf16 v[60:63], v[132:135], v[16:19], 0
    v_cvt_pk_bf16_f32 v92, v72, v73
    v_cvt_pk_bf16_f32 v94, v76, v77
    v_mfma_f32_16x16x32_bf16 v[60:63], v[140:143], v[20:23], v[60:63]
    ds_read_b128 v[16:19], v6 offset:51200
    ds_read_b128 v[20:23], v6 offset:51264
    v_cvt_pk_bf16_f32 v93, v74, v75
    v_cvt_pk_bf16_f32 v95, v78, v79
    v_mfma_f32_16x16x32_bf16 v[60:63], v[148:151], v[24:27], v[60:63]
    v_permlane16_swap_b32 v92, v94
    v_permlane16_swap_b32 v93, v95
    v_mfma_f32_16x16x32_bf16 v[60:63], v[156:159], v[28:31], v[60:63]
    v_fma_f32 v96, -v117, v80, v96
    v_fma_f32 v97, -v117, v81, v97
    v_mfma_f32_16x16x32_bf16 v[52:55], v[152:155], v[28:31], v[52:55]
    v_fma_f32 v98, -v117, v82, v98
    v_fma_f32 v99, -v117, v83, v99
    v_mfma_f32_16x16x32_bf16 v[52:55], v[144:147], v[24:27], v[52:55]
    ds_read_b128 v[24:27], v6 offset:51328
    ds_read_b128 v[28:31], v6 offset:51392
    s_waitcnt lgkmcnt(4)
    v_fma_f32 v100, -v121, v80, v100
    v_fma_f32 v101, -v121, v81, v101
    v_mfma_f32_16x16x32_bf16 v[52:55], v[160:163], v[32:35], v[52:55]
    v_fma_f32 v102, -v121, v82, v102
    v_fma_f32 v103, -v121, v83, v103
    v_mfma_f32_16x16x32_bf16 v[52:55], v[168:171], v[36:39], v[52:55]
    v_mul_f32 v112, v96, v96
    v_mul_f32 v113, v97, v97
    v_mfma_f32_16x16x32_bf16 v[60:63], v[172:175], v[36:39], v[60:63]
    v_mul_f32 v114, v98, v98
    v_mul_f32 v115, v99, v99
    v_mfma_f32_16x16x32_bf16 v[60:63], v[164:167], v[32:35], v[60:63]
    ds_read_b128 v[32:35], v6 offset:51456
    ds_read_b128 v[36:39], v6 offset:51520
    v_mul_f32 v124, v100, v100
    v_mul_f32 v125, v101, v101
    v_mfma_f32_16x16x32_bf16 v[60:63], v[180:183], v[40:43], v[60:63]
    v_mul_f32 v126, v102, v102
    v_mul_f32 v127, v103, v103
    v_mfma_f32_16x16x32_bf16 v[60:63], v[188:191], v[44:47], v[60:63]
    v_fma_f32 v112, v112, v119, v118
    v_fma_f32 v113, v113, v119, v118
    v_mfma_f32_16x16x32_bf16 v[52:55], v[184:187], v[44:47], v[52:55]
    v_fma_f32 v114, v114, v119, v118
    v_fma_f32 v115, v115, v119, v118
    v_mfma_f32_16x16x32_bf16 v[52:55], v[176:179], v[40:43], v[52:55]
    ds_read_b128 v[40:43], v6 offset:51584
    ds_read_b128 v[44:47], v6 offset:51648
    s_waitcnt lgkmcnt(4)
    v_fma_f32 v124, v124, v123, v122
    v_fma_f32 v125, v125, v123, v122
    v_mfma_f32_16x16x32_bf16 v[52:55], v[192:195], v[16:19], v[52:55]
    v_fma_f32 v126, v126, v123, v122
    v_fma_f32 v127, v127, v123, v122
    v_mfma_f32_16x16x32_bf16 v[52:55], v[200:203], v[20:23], v[52:55]
    v_mul_f32 v112, v112, v96
    v_mul_f32 v113, v113, v97
    v_mfma_f32_16x16x32_bf16 v[60:63], v[204:207], v[20:23], v[60:63]
    v_mul_f32 v114, v114, v98
    v_mul_f32 v115, v115, v99
    v_mfma_f32_16x16x32_bf16 v[60:63], v[196:199], v[16:19], v[60:63]
    v_mul_f32 v124, v124, v100
    v_mul_f32 v125, v125, v101
    v_mfma_f32_16x16x32_bf16 v[60:63], v[212:215], v[24:27], v[60:63]
    v_mul_f32 v126, v126, v102
    v_mul_f32 v127, v127, v103
    v_mfma_f32_16x16x32_bf16 v[60:63], v[220:223], v[28:31], v[60:63]
    v_exp_f32 v112, v112
    v_mfma_f32_16x16x32_bf16 v[52:55], v[216:219], v[28:31], v[52:55]
    v_fma_f32 v104, -v117, v84, v104
    v_fma_f32 v105, -v117, v85, v105
    v_mfma_f32_16x16x32_bf16 v[52:55], v[208:211], v[24:27], v[52:55]
    s_waitcnt vmcnt(0) lgkmcnt(0)
    s_barrier
    buffer_store_dwordx4 v[92:95], v15, s[8:11], s21 offen sc1
    v_add_u32 v6, 0x10800, v6
    ds_read_b128 v[16:19], v6 offset:0
    ds_read_b128 v[20:23], v6 offset:64
    ds_read_b128 v[24:27], v6 offset:128
    ds_read_b128 v[28:31], v6 offset:192
    v_exp_f32 v113, v113
    v_mfma_f32_16x16x32_bf16 v[52:55], v[224:227], v[32:35], v[52:55]
    v_exp_f32 v114, v114
    v_mfma_f32_16x16x32_bf16 v[52:55], v[232:235], v[36:39], v[52:55]
    v_fma_f32 v106, -v117, v86, v106
    v_fma_f32 v107, -v117, v87, v107
    v_mfma_f32_16x16x32_bf16 v[60:63], v[236:239], v[36:39], v[60:63]
    v_exp_f32 v115, v115
    v_mfma_f32_16x16x32_bf16 v[60:63], v[228:231], v[32:35], v[60:63]
    ds_read_b128 v[32:35], v6 offset:256
    ds_read_b128 v[36:39], v6 offset:320
    v_exp_f32 v124, v124
    v_mfma_f32_16x16x32_bf16 v[60:63], v[244:247], v[40:43], v[60:63]
    v_fma_f32 v108, -v121, v84, v108
    v_fma_f32 v109, -v121, v85, v109
    v_mfma_f32_16x16x32_bf16 v[60:63], v[252:255], v[44:47], v[60:63]
    v_exp_f32 v125, v125
    v_mfma_f32_16x16x32_bf16 v[52:55], v[248:251], v[44:47], v[52:55]
    v_exp_f32 v126, v126
    v_mfma_f32_16x16x32_bf16 v[52:55], v[240:243], v[40:43], v[52:55]
    ds_read_b128 v[40:43], v6 offset:384
    ds_read_b128 v[44:47], v6 offset:448
    s_waitcnt lgkmcnt(4)
    v_fma_f32 v110, -v121, v86, v110
    v_fma_f32 v111, -v121, v87, v111
    v_mfma_f32_16x16x32_bf16 v[64:67], v[128:131], v[16:19], 0
    v_exp_f32 v127, v127
    v_mfma_f32_16x16x32_bf16 v[64:67], v[136:139], v[20:23], v[64:67]
    v_add_f32 v112, 1.0, v112
    v_add_f32 v113, 1.0, v113
    ds_read_b128 v[116:119], v7 offset:1536
    ds_read_b128 v[120:123], v7 offset:1792
    v_mfma_f32_16x16x32_bf16 v[72:75], v[132:135], v[16:19], 0
    v_add_f32 v114, 1.0, v114
    v_add_f32 v115, 1.0, v115
    v_mfma_f32_16x16x32_bf16 v[72:75], v[140:143], v[20:23], v[72:75]
    ds_read_b128 v[16:19], v6 offset:512
    ds_read_b128 v[20:23], v6 offset:576
    v_add_f32 v124, 1.0, v124
    v_add_f32 v125, 1.0, v125
    v_mfma_f32_16x16x32_bf16 v[72:75], v[148:151], v[24:27], v[72:75]
    v_add_f32 v126, 1.0, v126
    v_add_f32 v127, 1.0, v127
    v_mfma_f32_16x16x32_bf16 v[72:75], v[156:159], v[28:31], v[72:75]
    v_rcp_f32 v112, v112
    v_mfma_f32_16x16x32_bf16 v[64:67], v[152:155], v[28:31], v[64:67]
    v_mul_f32 v104, v104, v96
    v_mul_f32 v105, v105, v97
    v_mfma_f32_16x16x32_bf16 v[64:67], v[144:147], v[24:27], v[64:67]
    ds_read_b128 v[24:27], v6 offset:640
    ds_read_b128 v[28:31], v6 offset:704
    s_waitcnt lgkmcnt(6)
    v_rcp_f32 v113, v113
    v_mfma_f32_16x16x32_bf16 v[64:67], v[160:163], v[32:35], v[64:67]
    v_rcp_f32 v114, v114
    v_mfma_f32_16x16x32_bf16 v[64:67], v[168:171], v[36:39], v[64:67]
    v_mul_f32 v106, v106, v98
    v_mul_f32 v107, v107, v99
    v_mfma_f32_16x16x32_bf16 v[72:75], v[172:175], v[36:39], v[72:75]
    v_rcp_f32 v115, v115
    v_mfma_f32_16x16x32_bf16 v[72:75], v[164:167], v[32:35], v[72:75]
    ds_read_b128 v[32:35], v6 offset:768
    ds_read_b128 v[36:39], v6 offset:832
    v_rcp_f32 v124, v124
    v_mfma_f32_16x16x32_bf16 v[72:75], v[180:183], v[40:43], v[72:75]
    v_mul_f32 v108, v108, v100
    v_mul_f32 v109, v109, v101
    v_mfma_f32_16x16x32_bf16 v[72:75], v[188:191], v[44:47], v[72:75]
    v_rcp_f32 v125, v125
    v_mfma_f32_16x16x32_bf16 v[64:67], v[184:187], v[44:47], v[64:67]
    v_rcp_f32 v126, v126
    v_mfma_f32_16x16x32_bf16 v[64:67], v[176:179], v[40:43], v[64:67]
    ds_read_b128 v[40:43], v6 offset:896
    ds_read_b128 v[44:47], v6 offset:960
    s_waitcnt lgkmcnt(4)
    v_mul_f32 v110, v110, v102
    v_mul_f32 v111, v111, v103
    v_mfma_f32_16x16x32_bf16 v[64:67], v[192:195], v[16:19], v[64:67]
    v_rcp_f32 v127, v127
    v_mfma_f32_16x16x32_bf16 v[64:67], v[200:203], v[20:23], v[64:67]
    v_mul_f32 v104, v104, v112
    v_mul_f32 v105, v105, v113
    v_mfma_f32_16x16x32_bf16 v[72:75], v[204:207], v[20:23], v[72:75]
    v_mul_f32 v106, v106, v114
    v_mul_f32 v107, v107, v115
    v_mfma_f32_16x16x32_bf16 v[72:75], v[196:199], v[16:19], v[72:75]
    ds_read_b128 v[16:19], v6 offset:16896
    ds_read_b128 v[20:23], v6 offset:16960
    v_mul_f32 v108, v108, v124
    v_mul_f32 v109, v109, v125
    v_mfma_f32_16x16x32_bf16 v[72:75], v[212:215], v[24:27], v[72:75]
    v_mul_f32 v110, v110, v126
    v_mul_f32 v111, v111, v127
    v_mfma_f32_16x16x32_bf16 v[72:75], v[220:223], v[28:31], v[72:75]
    v_cvt_pk_bf16_f32 v88, v104, v105
    v_cvt_pk_bf16_f32 v90, v108, v109
    v_mfma_f32_16x16x32_bf16 v[64:67], v[216:219], v[28:31], v[64:67]
    v_cvt_pk_bf16_f32 v89, v106, v107
    v_cvt_pk_bf16_f32 v91, v110, v111
    v_mfma_f32_16x16x32_bf16 v[64:67], v[208:211], v[24:27], v[64:67]
    ds_read_b128 v[24:27], v6 offset:17024
    ds_read_b128 v[28:31], v6 offset:17088
    s_waitcnt lgkmcnt(4)
    v_permlane16_swap_b32 v88, v90
    v_permlane16_swap_b32 v89, v91
    v_mfma_f32_16x16x32_bf16 v[64:67], v[224:227], v[32:35], v[64:67]
    v_fma_f32 v48, -v117, v80, v48
    v_fma_f32 v49, -v117, v81, v49
    v_mfma_f32_16x16x32_bf16 v[64:67], v[232:235], v[36:39], v[64:67]
    v_fma_f32 v50, -v117, v82, v50
    v_fma_f32 v51, -v117, v83, v51
    v_mfma_f32_16x16x32_bf16 v[72:75], v[236:239], v[36:39], v[72:75]
    v_fma_f32 v52, -v121, v80, v52
    v_fma_f32 v53, -v121, v81, v53
    v_mfma_f32_16x16x32_bf16 v[72:75], v[228:231], v[32:35], v[72:75]
    ds_read_b128 v[32:35], v6 offset:17152
    ds_read_b128 v[36:39], v6 offset:17216
    v_fma_f32 v54, -v121, v82, v54
    v_fma_f32 v55, -v121, v83, v55
    v_mfma_f32_16x16x32_bf16 v[72:75], v[244:247], v[40:43], v[72:75]
    v_mul_f32 v112, v48, v48
    v_mul_f32 v113, v49, v49
    v_mfma_f32_16x16x32_bf16 v[72:75], v[252:255], v[44:47], v[72:75]
    v_mul_f32 v114, v50, v50
    v_mul_f32 v115, v51, v51
    v_mfma_f32_16x16x32_bf16 v[64:67], v[248:251], v[44:47], v[64:67]
    v_mul_f32 v124, v52, v52
    v_mul_f32 v125, v53, v53
    v_mfma_f32_16x16x32_bf16 v[64:67], v[240:243], v[40:43], v[64:67]
    ds_read_b128 v[40:43], v6 offset:17280
    ds_read_b128 v[44:47], v6 offset:17344
    s_waitcnt lgkmcnt(4)
    v_mul_f32 v126, v54, v54
    v_mul_f32 v127, v55, v55
    v_mfma_f32_16x16x32_bf16 v[68:71], v[128:131], v[16:19], 0
    v_fma_f32 v112, v112, v119, v118
    v_fma_f32 v113, v113, v119, v118
    v_mfma_f32_16x16x32_bf16 v[68:71], v[136:139], v[20:23], v[68:71]
    v_fma_f32 v114, v114, v119, v118
    v_fma_f32 v115, v115, v119, v118
    v_mfma_f32_16x16x32_bf16 v[76:79], v[132:135], v[16:19], 0
    v_fma_f32 v124, v124, v123, v122
    v_fma_f32 v125, v125, v123, v122
    v_mfma_f32_16x16x32_bf16 v[76:79], v[140:143], v[20:23], v[76:79]
    ds_read_b128 v[16:19], v6 offset:17408
    ds_read_b128 v[20:23], v6 offset:17472
    v_fma_f32 v126, v126, v123, v122
    v_fma_f32 v127, v127, v123, v122
    v_mfma_f32_16x16x32_bf16 v[76:79], v[148:151], v[24:27], v[76:79]
    v_mul_f32 v112, v112, v48
    v_mul_f32 v113, v113, v49
    v_mfma_f32_16x16x32_bf16 v[76:79], v[156:159], v[28:31], v[76:79]
    v_mul_f32 v114, v114, v50
    v_mul_f32 v115, v115, v51
    v_mfma_f32_16x16x32_bf16 v[68:71], v[152:155], v[28:31], v[68:71]
    v_mul_f32 v124, v124, v52
    v_mul_f32 v125, v125, v53
    v_mfma_f32_16x16x32_bf16 v[68:71], v[144:147], v[24:27], v[68:71]
    ds_read_b128 v[24:27], v6 offset:17536
    ds_read_b128 v[28:31], v6 offset:17600
    s_waitcnt lgkmcnt(4)
    v_mul_f32 v126, v126, v54
    v_mul_f32 v127, v127, v55
    v_mfma_f32_16x16x32_bf16 v[68:71], v[160:163], v[32:35], v[68:71]
    v_exp_f32 v112, v112
    v_mfma_f32_16x16x32_bf16 v[68:71], v[168:171], v[36:39], v[68:71]
    v_fma_f32 v56, -v117, v84, v56
    v_fma_f32 v57, -v117, v85, v57
    v_mfma_f32_16x16x32_bf16 v[76:79], v[172:175], v[36:39], v[76:79]
    v_exp_f32 v113, v113
    v_mfma_f32_16x16x32_bf16 v[76:79], v[164:167], v[32:35], v[76:79]
    ds_read_b128 v[32:35], v6 offset:17664
    ds_read_b128 v[36:39], v6 offset:17728
    v_exp_f32 v114, v114
    v_mfma_f32_16x16x32_bf16 v[76:79], v[180:183], v[40:43], v[76:79]
    v_fma_f32 v58, -v117, v86, v58
    v_fma_f32 v59, -v117, v87, v59
    v_mfma_f32_16x16x32_bf16 v[76:79], v[188:191], v[44:47], v[76:79]
    v_exp_f32 v115, v115
    v_mfma_f32_16x16x32_bf16 v[68:71], v[184:187], v[44:47], v[68:71]
    v_exp_f32 v124, v124
    v_mfma_f32_16x16x32_bf16 v[68:71], v[176:179], v[40:43], v[68:71]
    ds_read_b128 v[40:43], v6 offset:17792
    ds_read_b128 v[44:47], v6 offset:17856
    s_waitcnt lgkmcnt(4)
    v_fma_f32 v60, -v121, v84, v60
    v_fma_f32 v61, -v121, v85, v61
    v_mfma_f32_16x16x32_bf16 v[68:71], v[192:195], v[16:19], v[68:71]
    v_exp_f32 v125, v125
    v_mfma_f32_16x16x32_bf16 v[68:71], v[200:203], v[20:23], v[68:71]
    v_exp_f32 v126, v126
L_stub_GA_2_0:
    s_cbranch_execz L_stub_GB_2_0
    v_mfma_f32_16x16x32_bf16 v[76:79], v[204:207], v[20:23], v[76:79]
    v_fma_f32 v62, -v121, v86, v62
    v_fma_f32 v63, -v121, v87, v63
    v_mfma_f32_16x16x32_bf16 v[76:79], v[196:199], v[16:19], v[76:79]
    v_exp_f32 v127, v127
    v_mfma_f32_16x16x32_bf16 v[76:79], v[212:215], v[24:27], v[76:79]
    v_add_f32 v112, 1.0, v112
    v_add_f32 v113, 1.0, v113
    ds_read_b128 v[116:119], v7 offset:2048
    ds_read_b128 v[120:123], v7 offset:2304
    v_mfma_f32_16x16x32_bf16 v[76:79], v[220:223], v[28:31], v[76:79]
    v_add_f32 v114, 1.0, v114
    v_add_f32 v115, 1.0, v115
    v_mfma_f32_16x16x32_bf16 v[68:71], v[216:219], v[28:31], v[68:71]
    v_add_f32 v124, 1.0, v124
    v_add_f32 v125, 1.0, v125
    v_mfma_f32_16x16x32_bf16 v[68:71], v[208:211], v[24:27], v[68:71]
    s_waitcnt vmcnt(0) lgkmcnt(0)
    s_barrier
    buffer_store_dwordx4 v[88:91], v15, s[8:11], s22 offen sc1
    v_add_u32 v6, 0xfffef800, v6
    ds_read_b128 v[16:19], v6 offset:0
    ds_read_b128 v[20:23], v6 offset:64
    ds_read_b128 v[24:27], v6 offset:128
    ds_read_b128 v[28:31], v6 offset:192
    v_add_f32 v126, 1.0, v126
    v_add_f32 v127, 1.0, v127
    v_mfma_f32_16x16x32_bf16 v[68:71], v[224:227], v[32:35], v[68:71]
    v_rcp_f32 v112, v112
    v_mfma_f32_16x16x32_bf16 v[68:71], v[232:235], v[36:39], v[68:71]
    v_mul_f32 v56, v56, v48
    v_mul_f32 v57, v57, v49
    v_mfma_f32_16x16x32_bf16 v[76:79], v[236:239], v[36:39], v[76:79]
    v_rcp_f32 v113, v113
    v_mfma_f32_16x16x32_bf16 v[76:79], v[228:231], v[32:35], v[76:79]
    ds_read_b128 v[32:35], v6 offset:256
    ds_read_b128 v[36:39], v6 offset:320
    v_rcp_f32 v114, v114
    v_mfma_f32_16x16x32_bf16 v[76:79], v[244:247], v[40:43], v[76:79]
    v_mul_f32 v58, v58, v50
    v_mul_f32 v59, v59, v51
    v_mfma_f32_16x16x32_bf16 v[76:79], v[252:255], v[44:47], v[76:79]
    v_rcp_f32 v115, v115
    v_mfma_f32_16x16x32_bf16 v[68:71], v[248:251], v[44:47], v[68:71]
    v_rcp_f32 v124, v124
    v_mfma_f32_16x16x32_bf16 v[68:71], v[240:243], v[40:43], v[68:71]
    ds_read_b128 v[40:43], v6 offset:384
    ds_read_b128 v[44:47], v6 offset:448
    s_waitcnt lgkmcnt(4)
    v_mul_f32 v60, v60, v52
    v_mul_f32 v61, v61, v53
    v_mfma_f32_16x16x32_bf16 v[96:99], v[128:131], v[16:19], 0
    v_rcp_f32 v125, v125
    v_mfma_f32_16x16x32_bf16 v[96:99], v[136:139], v[20:23], v[96:99]
    v_rcp_f32 v126, v126
    v_mfma_f32_16x16x32_bf16 v[104:107], v[132:135], v[16:19], 0
    v_mul_f32 v62, v62, v54
    v_mul_f32 v63, v63, v55
    v_mfma_f32_16x16x32_bf16 v[104:107], v[140:143], v[20:23], v[104:107]
    ds_read_b128 v[16:19], v6 offset:512
    ds_read_b128 v[20:23], v6 offset:576
    v_rcp_f32 v127, v127
    v_mfma_f32_16x16x32_bf16 v[104:107], v[148:151], v[24:27], v[104:107]
    v_mul_f32 v56, v56, v112
    v_mul_f32 v57, v57, v113
    v_mfma_f32_16x16x32_bf16 v[104:107], v[156:159], v[28:31], v[104:107]
    v_mul_f32 v58, v58, v114
    v_mul_f32 v59, v59, v115
    v_mfma_f32_16x16x32_bf16 v[96:99], v[152:155], v[28:31], v[96:99]
    v_mul_f32 v60, v60, v124
    v_mul_f32 v61, v61, v125
    v_mfma_f32_16x16x32_bf16 v[96:99], v[144:147], v[24:27], v[96:99]
    ds_read_b128 v[24:27], v6 offset:640
    ds_read_b128 v[28:31], v6 offset:704
    s_waitcnt lgkmcnt(4)
    v_mul_f32 v62, v62, v126
    v_mul_f32 v63, v63, v127
    v_mfma_f32_16x16x32_bf16 v[96:99], v[160:163], v[32:35], v[96:99]
    v_cvt_pk_bf16_f32 v92, v56, v57
    v_cvt_pk_bf16_f32 v94, v60, v61
    v_mfma_f32_16x16x32_bf16 v[96:99], v[168:171], v[36:39], v[96:99]
    v_cvt_pk_bf16_f32 v93, v58, v59
    v_cvt_pk_bf16_f32 v95, v62, v63
    v_mfma_f32_16x16x32_bf16 v[104:107], v[172:175], v[36:39], v[104:107]
    v_permlane16_swap_b32 v92, v94
    v_permlane16_swap_b32 v93, v95
    v_mfma_f32_16x16x32_bf16 v[104:107], v[164:167], v[32:35], v[104:107]
    ds_read_b128 v[32:35], v6 offset:768
    ds_read_b128 v[36:39], v6 offset:832
    v_fma_f32 v64, -v117, v80, v64
    v_fma_f32 v65, -v117, v81, v65
    v_mfma_f32_16x16x32_bf16 v[104:107], v[180:183], v[40:43], v[104:107]
    v_fma_f32 v66, -v117, v82, v66
    v_fma_f32 v67, -v117, v83, v67
    v_mfma_f32_16x16x32_bf16 v[104:107], v[188:191], v[44:47], v[104:107]
    v_fma_f32 v68, -v121, v80, v68
    v_fma_f32 v69, -v121, v81, v69
    v_mfma_f32_16x16x32_bf16 v[96:99], v[184:187], v[44:47], v[96:99]
    v_fma_f32 v70, -v121, v82, v70
    v_fma_f32 v71, -v121, v83, v71
    v_mfma_f32_16x16x32_bf16 v[96:99], v[176:179], v[40:43], v[96:99]
    ds_read_b128 v[40:43], v6 offset:896
    ds_read_b128 v[44:47], v6 offset:960
    s_waitcnt lgkmcnt(4)
    v_mul_f32 v112, v64, v64
    v_mul_f32 v113, v65, v65
    v_mfma_f32_16x16x32_bf16 v[96:99], v[192:195], v[16:19], v[96:99]
    v_mul_f32 v114, v66, v66
    v_mul_f32 v115, v67, v67
    v_mfma_f32_16x16x32_bf16 v[96:99], v[200:203], v[20:23], v[96:99]
    v_mul_f32 v124, v68, v68
    v_mul_f32 v125, v69, v69
    v_mfma_f32_16x16x32_bf16 v[104:107], v[204:207], v[20:23], v[104:107]
    v_mul_f32 v126, v70, v70
    v_mul_f32 v127, v71, v71
    v_mfma_f32_16x16x32_bf16 v[104:107], v[196:199], v[16:19], v[104:107]
    ds_read_b128 v[16:19], v6 offset:16896
    ds_read_b128 v[20:23], v6 offset:16960
    v_fma_f32 v112, v112, v119, v118
    v_fma_f32 v113, v113, v119, v118
    v_mfma_f32_16x16x32_bf16 v[104:107], v[212:215], v[24:27], v[104:107]
    v_fma_f32 v114, v114, v119, v118
    v_fma_f32 v115, v115, v119, v118
    v_mfma_f32_16x16x32_bf16 v[104:107], v[220:223], v[28:31], v[104:107]
    v_fma_f32 v124, v124, v123, v122
    v_fma_f32 v125, v125, v123, v122
    v_mfma_f32_16x16x32_bf16 v[96:99], v[216:219], v[28:31], v[96:99]
    v_fma_f32 v126, v126, v123, v122
    v_fma_f32 v127, v127, v123, v122
    v_mfma_f32_16x16x32_bf16 v[96:99], v[208:211], v[24:27], v[96:99]
    ds_read_b128 v[24:27], v6 offset:17024
    ds_read_b128 v[28:31], v6 offset:17088
    s_waitcnt lgkmcnt(4)
    v_mul_f32 v112, v112, v64
    v_mul_f32 v113, v113, v65
    v_mfma_f32_16x16x32_bf16 v[96:99], v[224:227], v[32:35], v[96:99]
    v_mul_f32 v114, v114, v66
    v_mul_f32 v115, v115, v67
    v_mfma_f32_16x16x32_bf16 v[96:99], v[232:235], v[36:39], v[96:99]
    v_mul_f32 v124, v124, v68
    v_mul_f32 v125, v125, v69
    v_mfma_f32_16x16x32_bf16 v[104:107], v[236:239], v[36:39], v[104:107]
    v_mul_f32 v126, v126, v70
    v_mul_f32 v127, v127, v71
    v_mfma_f32_16x16x32_bf16 v[104:107], v[228:231], v[32:35], v[104:107]
    ds_read_b128 v[32:35], v6 offset:17152
    ds_read_b128 v[36:39], v6 offset:17216
    v_exp_f32 v112, v112
    v_mfma_f32_16x16x32_bf16 v[104:107], v[244:247], v[40:43], v[104:107]
    v_fma_f32 v72, -v117, v84, v72
    v_fma_f32 v73, -v117, v85, v73
    v_mfma_f32_16x16x32_bf16 v[104:107], v[252:255], v[44:47], v[104:107]
    v_exp_f32 v113, v113
    v_mfma_f32_16x16x32_bf16 v[96:99], v[248:251], v[44:47], v[96:99]
    v_exp_f32 v114, v114
    v_mfma_f32_16x16x32_bf16 v[96:99], v[240:243], v[40:43], v[96:99]
    ds_read_b128 v[40:43], v6 offset:17280
    ds_read_b128 v[44:47], v6 offset:17344
    s_waitcnt lgkmcnt(4)
    v_fma_f32 v74, -v117, v86, v74
    v_fma_f32 v75, -v117, v87, v75
    v_mfma_f32_16x16x32_bf16 v[100:103], v[128:131], v[16:19], 0
    v_exp_f32 v115, v115
    v_mfma_f32_16x16x32_bf16 v[100:103], v[136:139], v[20:23], v[100:103]
    v_exp_f32 v124, v124
    v_mfma_f32_16x16x32_bf16 v[108:111], v[132:135], v[16:19], 0
    v_fma_f32 v76, -v121, v84, v76
    v_fma_f32 v77, -v121, v85, v77
    v_mfma_f32_16x16x32_bf16 v[108:111], v[140:143], v[20:23], v[108:111]
    ds_read_b128 v[16:19], v6 offset:17408
    ds_read_b128 v[20:23], v6 offset:17472
    v_exp_f32 v125, v125
    v_mfma_f32_16x16x32_bf16 v[108:111], v[148:151], v[24:27], v[108:111]
    v_exp_f32 v126, v126
    v_mfma_f32_16x16x32_bf16 v[108:111], v[156:159], v[28:31], v[108:111]
    v_fma_f32 v78, -v121, v86, v78
    v_fma_f32 v79, -v121, v87, v79
    v_mfma_f32_16x16x32_bf16 v[100:103], v[152:155], v[28:31], v[100:103]
    v_exp_f32 v127, v127
    v_mfma_f32_16x16x32_bf16 v[100:103], v[144:147], v[24:27], v[100:103]
    ds_read_b128 v[24:27], v6 offset:17536
    ds_read_b128 v[28:31], v6 offset:17600
    s_waitcnt lgkmcnt(4)
    v_add_f32 v112, 1.0, v112
    v_add_f32 v113, 1.0, v113
    ds_read_b128 v[116:119], v7 offset:2560
    ds_read_b128 v[120:123], v7 offset:2816
    v_mfma_f32_16x16x32_bf16 v[100:103], v[160:163], v[32:35], v[100:103]
    v_add_f32 v114, 1.0, v114
    v_add_f32 v115, 1.0, v115
    v_mfma_f32_16x16x32_bf16 v[100:103], v[168:171], v[36:39], v[100:103]
    v_add_f32 v124, 1.0, v124
    v_add_f32 v125, 1.0, v125
    v_mfma_f32_16x16x32_bf16 v[108:111], v[172:175], v[36:39], v[108:111]
    v_add_f32 v126, 1.0, v126
    v_add_f32 v127, 1.0, v127
    v_mfma_f32_16x16x32_bf16 v[108:111], v[164:167], v[32:35], v[108:111]
    ds_read_b128 v[32:35], v6 offset:17664
    ds_read_b128 v[36:39], v6 offset:17728
    v_rcp_f32 v112, v112
    v_mfma_f32_16x16x32_bf16 v[108:111], v[180:183], v[40:43], v[108:111]
    v_mul_f32 v72, v72, v64
    v_mul_f32 v73, v73, v65
    v_mfma_f32_16x16x32_bf16 v[108:111], v[188:191], v[44:47], v[108:111]
    v_rcp_f32 v113, v113
    v_mfma_f32_16x16x32_bf16 v[100:103], v[184:187], v[44:47], v[100:103]
    v_rcp_f32 v114, v114
    v_mfma_f32_16x16x32_bf16 v[100:103], v[176:179], v[40:43], v[100:103]
    ds_read_b128 v[40:43], v6 offset:17792
    ds_read_b128 v[44:47], v6 offset:17856
    s_waitcnt lgkmcnt(6)
    v_mul_f32 v74, v74, v66
    v_mul_f32 v75, v75, v67
    v_mfma_f32_16x16x32_bf16 v[100:103], v[192:195], v[16:19], v[100:103]
    v_rcp_f32 v115, v115
    v_mfma_f32_16x16x32_bf16 v[100:103], v[200:203], v[20:23], v[100:103]
    v_rcp_f32 v124, v124
    v_mfma_f32_16x16x32_bf16 v[108:111], v[204:207], v[20:23], v[108:111]
    v_mul_f32 v76, v76, v68
    v_mul_f32 v77, v77, v69
    v_mfma_f32_16x16x32_bf16 v[108:111], v[196:199], v[16:19], v[108:111]
    v_rcp_f32 v125, v125
    v_mfma_f32_16x16x32_bf16 v[108:111], v[212:215], v[24:27], v[108:111]
    v_rcp_f32 v126, v126
    v_mfma_f32_16x16x32_bf16 v[108:111], v[220:223], v[28:31], v[108:111]
    v_mul_f32 v78, v78, v70
    v_mul_f32 v79, v79, v71
    v_mfma_f32_16x16x32_bf16 v[100:103], v[216:219], v[28:31], v[100:103]
    v_rcp_f32 v127, v127
    v_mfma_f32_16x16x32_bf16 v[100:103], v[208:211], v[24:27], v[100:103]
    s_waitcnt vmcnt(0) lgkmcnt(0)
    s_barrier
    buffer_store_dwordx4 v[92:95], v15, s[8:11], s23 offen sc1
    ds_read_b128 v[16:19], v6 offset:33792
    ds_read_b128 v[20:23], v6 offset:33856
    ds_read_b128 v[24:27], v6 offset:33920
    ds_read_b128 v[28:31], v6 offset:33984
    v_mul_f32 v72, v72, v112
    v_mul_f32 v73, v73, v113
    v_mfma_f32_16x16x32_bf16 v[100:103], v[224:227], v[32:35], v[100:103]
    v_mul_f32 v74, v74, v114
    v_mul_f32 v75, v75, v115
    v_mfma_f32_16x16x32_bf16 v[100:103], v[232:235], v[36:39], v[100:103]
    v_mul_f32 v76, v76, v124
    v_mul_f32 v77, v77, v125
    v_mfma_f32_16x16x32_bf16 v[108:111], v[236:239], v[36:39], v[108:111]
    v_mul_f32 v78, v78, v126
    v_mul_f32 v79, v79, v127
    v_mfma_f32_16x16x32_bf16 v[108:111], v[228:231], v[32:35], v[108:111]
    ds_read_b128 v[32:35], v6 offset:34048
    ds_read_b128 v[36:39], v6 offset:34112
    v_cvt_pk_bf16_f32 v88, v72, v73
    v_cvt_pk_bf16_f32 v90, v76, v77
    v_mfma_f32_16x16x32_bf16 v[108:111], v[244:247], v[40:43], v[108:111]
    v_cvt_pk_bf16_f32 v89, v74, v75
    v_cvt_pk_bf16_f32 v91, v78, v79
    v_mfma_f32_16x16x32_bf16 v[108:111], v[252:255], v[44:47], v[108:111]
    v_permlane16_swap_b32 v88, v90
    v_permlane16_swap_b32 v89, v91
    buffer_store_dwordx4 v[88:91], v15, s[8:11], s24 offen sc1
    v_mfma_f32_16x16x32_bf16 v[100:103], v[248:251], v[44:47], v[100:103]
    v_mfma_f32_16x16x32_bf16 v[100:103], v[240:243], v[40:43], v[100:103]
    ds_read_b128 v[40:43], v6 offset:34176
    ds_read_b128 v[44:47], v6 offset:34240
    s_waitcnt lgkmcnt(4)
    v_fma_f32 v96, -v117, v80, v96
    v_fma_f32 v97, -v117, v81, v97
    v_mfma_f32_16x16x32_bf16 v[48:51], v[128:131], v[16:19], 0
    v_fma_f32 v98, -v117, v82, v98
    v_fma_f32 v99, -v117, v83, v99
    v_mfma_f32_16x16x32_bf16 v[48:51], v[136:139], v[20:23], v[48:51]
    v_fma_f32 v100, -v121, v80, v100
    v_fma_f32 v101, -v121, v81, v101
    v_mfma_f32_16x16x32_bf16 v[56:59], v[132:135], v[16:19], 0
    v_fma_f32 v102, -v121, v82, v102
    v_fma_f32 v103, -v121, v83, v103
    v_mfma_f32_16x16x32_bf16 v[56:59], v[140:143], v[20:23], v[56:59]
    ds_read_b128 v[16:19], v6 offset:34304
    ds_read_b128 v[20:23], v6 offset:34368
    v_mul_f32 v112, v96, v96
    v_mul_f32 v113, v97, v97
    v_mfma_f32_16x16x32_bf16 v[56:59], v[148:151], v[24:27], v[56:59]
    v_mul_f32 v114, v98, v98
    v_mul_f32 v115, v99, v99
    v_mfma_f32_16x16x32_bf16 v[56:59], v[156:159], v[28:31], v[56:59]
    v_mul_f32 v124, v100, v100
    v_mul_f32 v125, v101, v101
    v_mfma_f32_16x16x32_bf16 v[48:51], v[152:155], v[28:31], v[48:51]
    v_mul_f32 v126, v102, v102
    v_mul_f32 v127, v103, v103
    v_mfma_f32_16x16x32_bf16 v[48:51], v[144:147], v[24:27], v[48:51]
    ds_read_b128 v[24:27], v6 offset:34432
    ds_read_b128 v[28:31], v6 offset:34496
    s_waitcnt lgkmcnt(4)
    v_fma_f32 v112, v112, v119, v118
    v_fma_f32 v113, v113, v119, v118
    v_mfma_f32_16x16x32_bf16 v[48:51], v[160:163], v[32:35], v[48:51]
    v_fma_f32 v114, v114, v119, v118
    v_fma_f32 v115, v115, v119, v118
    v_mfma_f32_16x16x32_bf16 v[48:51], v[168:171], v[36:39], v[48:51]
    v_fma_f32 v124, v124, v123, v122
    v_fma_f32 v125, v125, v123, v122
    v_mfma_f32_16x16x32_bf16 v[56:59], v[172:175], v[36:39], v[56:59]
    v_fma_f32 v126, v126, v123, v122
    v_fma_f32 v127, v127, v123, v122
    v_mfma_f32_16x16x32_bf16 v[56:59], v[164:167], v[32:35], v[56:59]
    ds_read_b128 v[32:35], v6 offset:34560
    ds_read_b128 v[36:39], v6 offset:34624
    v_mul_f32 v112, v112, v96
    v_mul_f32 v113, v113, v97
    v_mfma_f32_16x16x32_bf16 v[56:59], v[180:183], v[40:43], v[56:59]
    v_mul_f32 v114, v114, v98
    v_mul_f32 v115, v115, v99
    v_mfma_f32_16x16x32_bf16 v[56:59], v[188:191], v[44:47], v[56:59]
    v_mul_f32 v124, v124, v100
    v_mul_f32 v125, v125, v101
    v_mfma_f32_16x16x32_bf16 v[48:51], v[184:187], v[44:47], v[48:51]
    v_mul_f32 v126, v126, v102
    v_mul_f32 v127, v127, v103
    v_mfma_f32_16x16x32_bf16 v[48:51], v[176:179], v[40:43], v[48:51]
    ds_read_b128 v[40:43], v6 offset:34688
    ds_read_b128 v[44:47], v6 offset:34752
    s_waitcnt lgkmcnt(4)
    v_exp_f32 v112, v112
    v_mfma_f32_16x16x32_bf16 v[48:51], v[192:195], v[16:19], v[48:51]
    v_fma_f32 v104, -v117, v84, v104
    v_fma_f32 v105, -v117, v85, v105
    v_mfma_f32_16x16x32_bf16 v[48:51], v[200:203], v[20:23], v[48:51]
    v_exp_f32 v113, v113
    v_mfma_f32_16x16x32_bf16 v[56:59], v[204:207], v[20:23], v[56:59]
    v_exp_f32 v114, v114
    v_mfma_f32_16x16x32_bf16 v[56:59], v[196:199], v[16:19], v[56:59]
    ds_read_b128 v[16:19], v6 offset:50688
    ds_read_b128 v[20:23], v6 offset:50752
    v_fma_f32 v106, -v117, v86, v106
    v_fma_f32 v107, -v117, v87, v107
    v_mfma_f32_16x16x32_bf16 v[56:59], v[212:215], v[24:27], v[56:59]
    v_exp_f32 v115, v115
    v_mfma_f32_16x16x32_bf16 v[56:59], v[220:223], v[28:31], v[56:59]
    v_exp_f32 v124, v124
    v_mfma_f32_16x16x32_bf16 v[48:51], v[216:219], v[28:31], v[48:51]
    v_fma_f32 v108, -v121, v84, v108
    v_fma_f32 v109, -v121, v85, v109
    v_mfma_f32_16x16x32_bf16 v[48:51], v[208:211], v[24:27], v[48:51]
    ds_read_b128 v[24:27], v6 offset:50816
    ds_read_b128 v[28:31], v6 offset:50880
    s_waitcnt lgkmcnt(4)
    v_exp_f32 v125, v125
    v_mfma_f32_16x16x32_bf16 v[48:51], v[224:227], v[32:35], v[48:51]
    v_exp_f32 v126, v126
    v_mfma_f32_16x16x32_bf16 v[48:51], v[232:235], v[36:39], v[48:51]
    v_fma_f32 v110, -v121, v86, v110
    v_fma_f32 v111, -v121, v87, v111
    v_mfma_f32_16x16x32_bf16 v[56:59], v[236:239], v[36:39], v[56:59]
    v_exp_f32 v127, v127
    v_mfma_f32_16x16x32_bf16 v[56:59], v[228:231], v[32:35], v[56:59]
    ds_read_b128 v[32:35], v6 offset:50944
    ds_read_b128 v[36:39], v6 offset:51008
    v_add_f32 v112, 1.0, v112
    v_add_f32 v113, 1.0, v113
    ds_read_b128 v[116:119], v7 offset:3072
    ds_read_b128 v[120:123], v7 offset:3328
    v_mfma_f32_16x16x32_bf16 v[56:59], v[244:247], v[40:43], v[56:59]
    v_add_f32 v114, 1.0, v114
    v_add_f32 v115, 1.0, v115
    v_mfma_f32_16x16x32_bf16 v[56:59], v[252:255], v[44:47], v[56:59]
    v_add_f32 v124, 1.0, v124
    v_add_f32 v125, 1.0, v125
    v_mfma_f32_16x16x32_bf16 v[48:51], v[248:251], v[44:47], v[48:51]
    v_add_f32 v126, 1.0, v126
    v_add_f32 v127, 1.0, v127
    v_mfma_f32_16x16x32_bf16 v[48:51], v[240:243], v[40:43], v[48:51]
    ds_read_b128 v[40:43], v6 offset:51072
    ds_read_b128 v[44:47], v6 offset:51136
    s_waitcnt lgkmcnt(6)
    v_rcp_f32 v112, v112
    v_mfma_f32_16x16x32_bf16 v[52:55], v[128:131], v[16:19], 0
    v_mul_f32 v104, v104, v96
    v_mul_f32 v105, v105, v97
    v_mfma_f32_16x16x32_bf16 v[52:55], v[136:139], v[20:23], v[52:55]
    v_rcp_f32 v113, v113
    v_mfma_f32_16x16x32_bf16 v[60:63], v[132:135], v[16:19], 0
    v_rcp_f32 v114, v114
    v_mfma_f32_16x16x32_bf16 v[60:63], v[140:143], v[20:23], v[60:63]
    ds_read_b128 v[16:19], v6 offset:51200
    ds_read_b128 v[20:23], v6 offset:51264
    v_mul_f32 v106, v106, v98
    v_mul_f32 v107, v107, v99
    v_mfma_f32_16x16x32_bf16 v[60:63], v[148:151], v[24:27], v[60:63]
    v_rcp_f32 v115, v115
    v_mfma_f32_16x16x32_bf16 v[60:63], v[156:159], v[28:31], v[60:63]
    v_rcp_f32 v124, v124
    v_mfma_f32_16x16x32_bf16 v[52:55], v[152:155], v[28:31], v[52:55]
    v_mul_f32 v108, v108, v100
    v_mul_f32 v109, v109, v101
    v_mfma_f32_16x16x32_bf16 v[52:55], v[144:147], v[24:27], v[52:55]
    ds_read_b128 v[24:27], v6 offset:51328
    ds_read_b128 v[28:31], v6 offset:51392
    s_waitcnt lgkmcnt(4)
    v_rcp_f32 v125, v125
    v_mfma_f32_16x16x32_bf16 v[52:55], v[160:163], v[32:35], v[52:55]
    v_rcp_f32 v126, v126
    v_mfma_f32_16x16x32_bf16 v[52:55], v[168:171], v[36:39], v[52:55]
    v_mul_f32 v110, v110, v102
    v_mul_f32 v111, v111, v103
    v_mfma_f32_16x16x32_bf16 v[60:63], v[172:175], v[36:39], v[60:63]
    v_rcp_f32 v127, v127
    v_mfma_f32_16x16x32_bf16 v[60:63], v[164:167], v[32:35], v[60:63]
    ds_read_b128 v[32:35], v6 offset:51456
    ds_read_b128 v[36:39], v6 offset:51520
    v_mul_f32 v104, v104, v112
    v_mul_f32 v105, v105, v113
    v_mfma_f32_16x16x32_bf16 v[60:63], v[180:183], v[40:43], v[60:63]
    v_mul_f32 v106, v106, v114
    v_mul_f32 v107, v107, v115
    v_mfma_f32_16x16x32_bf16 v[60:63], v[188:191], v[44:47], v[60:63]
    v_mul_f32 v108, v108, v124
    v_mul_f32 v109, v109, v125
    v_mfma_f32_16x16x32_bf16 v[52:55], v[184:187], v[44:47], v[52:55]
    v_mul_f32 v110, v110, v126
    v_mul_f32 v111, v111, v127
    v_mfma_f32_16x16x32_bf16 v[52:55], v[176:179], v[40:43], v[52:55]
    ds_read_b128 v[40:43], v6 offset:51584
    ds_read_b128 v[44:47], v6 offset:51648
    s_waitcnt lgkmcnt(4)
    v_cvt_pk_bf16_f32 v92, v104, v105
    v_cvt_pk_bf16_f32 v94, v108, v109
    v_mfma_f32_16x16x32_bf16 v[52:55], v[192:195], v[16:19], v[52:55]
    v_cvt_pk_bf16_f32 v93, v106, v107
    v_cvt_pk_bf16_f32 v95, v110, v111
    v_mfma_f32_16x16x32_bf16 v[52:55], v[200:203], v[20:23], v[52:55]
    v_permlane16_swap_b32 v92, v94
    v_permlane16_swap_b32 v93, v95
    v_mfma_f32_16x16x32_bf16 v[60:63], v[204:207], v[20:23], v[60:63]
    v_mfma_f32_16x16x32_bf16 v[60:63], v[196:199], v[16:19], v[60:63]
    v_mfma_f32_16x16x32_bf16 v[60:63], v[212:215], v[24:27], v[60:63]
    v_mfma_f32_16x16x32_bf16 v[60:63], v[220:223], v[28:31], v[60:63]
    v_mfma_f32_16x16x32_bf16 v[52:55], v[216:219], v[28:31], v[52:55]
    v_mfma_f32_16x16x32_bf16 v[52:55], v[208:211], v[24:27], v[52:55]
    s_waitcnt vmcnt(0) lgkmcnt(0)
    s_barrier
    buffer_store_dwordx4 v[92:95], v15, s[8:11], s25 offen sc1
    v_add_u32 v6, 0x10800, v6
    ds_read_b128 v[16:19], v6 offset:0
    ds_read_b128 v[20:23], v6 offset:64
    ds_read_b128 v[24:27], v6 offset:128
    ds_read_b128 v[28:31], v6 offset:192
    v_mfma_f32_16x16x32_bf16 v[52:55], v[224:227], v[32:35], v[52:55]
    v_mfma_f32_16x16x32_bf16 v[52:55], v[232:235], v[36:39], v[52:55]
    v_mfma_f32_16x16x32_bf16 v[60:63], v[236:239], v[36:39], v[60:63]
    v_mfma_f32_16x16x32_bf16 v[60:63], v[228:231], v[32:35], v[60:63]
    ds_read_b128 v[32:35], v6 offset:256
    ds_read_b128 v[36:39], v6 offset:320
    v_mfma_f32_16x16x32_bf16 v[60:63], v[244:247], v[40:43], v[60:63]
    v_mfma_f32_16x16x32_bf16 v[60:63], v[252:255], v[44:47], v[60:63]
    v_mfma_f32_16x16x32_bf16 v[52:55], v[248:251], v[44:47], v[52:55]
    v_mfma_f32_16x16x32_bf16 v[52:55], v[240:243], v[40:43], v[52:55]
    ds_read_b128 v[40:43], v6 offset:384
    ds_read_b128 v[44:47], v6 offset:448
    s_waitcnt lgkmcnt(4)
    v_fma_f32 v48, -v117, v80, v48
    v_fma_f32 v49, -v117, v81, v49
    v_mfma_f32_16x16x32_bf16 v[64:67], v[128:131], v[16:19], 0
    v_fma_f32 v50, -v117, v82, v50
    v_fma_f32 v51, -v117, v83, v51
    v_mfma_f32_16x16x32_bf16 v[64:67], v[136:139], v[20:23], v[64:67]
    v_fma_f32 v52, -v121, v80, v52
    v_fma_f32 v53, -v121, v81, v53
    v_mfma_f32_16x16x32_bf16 v[72:75], v[132:135], v[16:19], 0
    v_fma_f32 v54, -v121, v82, v54
    v_fma_f32 v55, -v121, v83, v55
    v_mfma_f32_16x16x32_bf16 v[72:75], v[140:143], v[20:23], v[72:75]
    ds_read_b128 v[16:19], v6 offset:512
    ds_read_b128 v[20:23], v6 offset:576
    v_mul_f32 v112, v48, v48
    v_mul_f32 v113, v49, v49
    v_mfma_f32_16x16x32_bf16 v[72:75], v[148:151], v[24:27], v[72:75]
    v_mul_f32 v114, v50, v50
    v_mul_f32 v115, v51, v51
    v_mfma_f32_16x16x32_bf16 v[72:75], v[156:159], v[28:31], v[72:75]
    v_mul_f32 v124, v52, v52
    v_mul_f32 v125, v53, v53
    v_mfma_f32_16x16x32_bf16 v[64:67], v[152:155], v[28:31], v[64:67]
    v_mul_f32 v126, v54, v54
    v_mul_f32 v127, v55, v55
    v_mfma_f32_16x16x32_bf16 v[64:67], v[144:147], v[24:27], v[64:67]
    ds_read_b128 v[24:27], v6 offset:640
    ds_read_b128 v[28:31], v6 offset:704
    s_waitcnt lgkmcnt(4)
    v_fma_f32 v112, v112, v119, v118
    v_fma_f32 v113, v113, v119, v118
    v_mfma_f32_16x16x32_bf16 v[64:67], v[160:163], v[32:35], v[64:67]
    v_fma_f32 v114, v114, v119, v118
    v_fma_f32 v115, v115, v119, v118
    v_mfma_f32_16x16x32_bf16 v[64:67], v[168:171], v[36:39], v[64:67]
    v_fma_f32 v124, v124, v123, v122
    v_fma_f32 v125, v125, v123, v122
    v_mfma_f32_16x16x32_bf16 v[72:75], v[172:175], v[36:39], v[72:75]
    v_fma_f32 v126, v126, v123, v122
    v_fma_f32 v127, v127, v123, v122
    v_mfma_f32_16x16x32_bf16 v[72:75], v[164:167], v[32:35], v[72:75]
    ds_read_b128 v[32:35], v6 offset:768
    ds_read_b128 v[36:39], v6 offset:832
    v_mul_f32 v112, v112, v48
    v_mul_f32 v113, v113, v49
    v_mfma_f32_16x16x32_bf16 v[72:75], v[180:183], v[40:43], v[72:75]
    v_mul_f32 v114, v114, v50
    v_mul_f32 v115, v115, v51
    v_mfma_f32_16x16x32_bf16 v[72:75], v[188:191], v[44:47], v[72:75]
    v_mul_f32 v124, v124, v52
    v_mul_f32 v125, v125, v53
    v_mfma_f32_16x16x32_bf16 v[64:67], v[184:187], v[44:47], v[64:67]
    v_mul_f32 v126, v126, v54
    v_mul_f32 v127, v127, v55
    v_mfma_f32_16x16x32_bf16 v[64:67], v[176:179], v[40:43], v[64:67]
    ds_read_b128 v[40:43], v6 offset:896
    ds_read_b128 v[44:47], v6 offset:960
    s_waitcnt lgkmcnt(4)
    v_exp_f32 v112, v112
    v_mfma_f32_16x16x32_bf16 v[64:67], v[192:195], v[16:19], v[64:67]
    v_fma_f32 v56, -v117, v84, v56
    v_fma_f32 v57, -v117, v85, v57
    v_mfma_f32_16x16x32_bf16 v[64:67], v[200:203], v[20:23], v[64:67]
    v_exp_f32 v113, v113
    v_mfma_f32_16x16x32_bf16 v[72:75], v[204:207], v[20:23], v[72:75]
    v_exp_f32 v114, v114
    v_mfma_f32_16x16x32_bf16 v[72:75], v[196:199], v[16:19], v[72:75]
    ds_read_b128 v[16:19], v6 offset:16896
    ds_read_b128 v[20:23], v6 offset:16960
    v_fma_f32 v58, -v117, v86, v58
    v_fma_f32 v59, -v117, v87, v59
    v_mfma_f32_16x16x32_bf16 v[72:75], v[212:215], v[24:27], v[72:75]
    v_exp_f32 v115, v115
    v_mfma_f32_16x16x32_bf16 v[72:75], v[220:223], v[28:31], v[72:75]
    v_exp_f32 v124, v124
    v_mfma_f32_16x16x32_bf16 v[64:67], v[216:219], v[28:31], v[64:67]
    v_fma_f32 v60, -v121, v84, v60
    v_fma_f32 v61, -v121, v85, v61
    v_mfma_f32_16x16x32_bf16 v[64:67], v[208:211], v[24:27], v[64:67]
    ds_read_b128 v[24:27], v6 offset:17024
    ds_read_b128 v[28:31], v6 offset:17088
    s_waitcnt lgkmcnt(4)
    v_exp_f32 v125, v125
    v_mfma_f32_16x16x32_bf16 v[64:67], v[224:227], v[32:35], v[64:67]
    v_exp_f32 v126, v126
    v_mfma_f32_16x16x32_bf16 v[64:67], v[232:235], v[36:39], v[64:67]
    v_fma_f32 v62, -v121, v86, v62
    v_fma_f32 v63, -v121, v87, v63
    v_mfma_f32_16x16x32_bf16 v[72:75], v[236:239], v[36:39], v[72:75]
    v_exp_f32 v127, v127
    v_mfma_f32_16x16x32_bf16 v[72:75], v[228:231], v[32:35], v[72:75]
    ds_read_b128 v[32:35], v6 offset:17152
    ds_read_b128 v[36:39], v6 offset:17216
    v_add_f32 v112, 1.0, v112
    v_add_f32 v113, 1.0, v113
    ds_read_b128 v[116:119], v7 offset:3584
    ds_read_b128 v[120:123], v7 offset:3840
    v_mfma_f32_16x16x32_bf16 v[72:75], v[244:247], v[40:43], v[72:75]
    v_add_f32 v114, 1.0, v114
    v_add_f32 v115, 1.0, v115
    v_mfma_f32_16x16x32_bf16 v[72:75], v[252:255], v[44:47], v[72:75]
    v_add_f32 v124, 1.0, v124
    v_add_f32 v125, 1.0, v125
    v_mfma_f32_16x16x32_bf16 v[64:67], v[248:251], v[44:47], v[64:67]
    v_add_f32 v126, 1.0, v126
    v_add_f32 v127, 1.0, v127
    v_mfma_f32_16x16x32_bf16 v[64:67], v[240:243], v[40:43], v[64:67]
    ds_read_b128 v[40:43], v6 offset:17280
    ds_read_b128 v[44:47], v6 offset:17344
    s_waitcnt lgkmcnt(6)
    v_rcp_f32 v112, v112
    v_mfma_f32_16x16x32_bf16 v[68:71], v[128:131], v[16:19], 0
    v_mul_f32 v56, v56, v48
    v_mul_f32 v57, v57, v49
    v_mfma_f32_16x16x32_bf16 v[68:71], v[136:139], v[20:23], v[68:71]
    v_rcp_f32 v113, v113
    v_mfma_f32_16x16x32_bf16 v[76:79], v[132:135], v[16:19], 0
    v_rcp_f32 v114, v114
    v_mfma_f32_16x16x32_bf16 v[76:79], v[140:143], v[20:23], v[76:79]
    ds_read_b128 v[16:19], v6 offset:17408
    ds_read_b128 v[20:23], v6 offset:17472
    v_mul_f32 v58, v58, v50
    v_mul_f32 v59, v59, v51
    v_mfma_f32_16x16x32_bf16 v[76:79], v[148:151], v[24:27], v[76:79]
    v_rcp_f32 v115, v115
    v_mfma_f32_16x16x32_bf16 v[76:79], v[156:159], v[28:31], v[76:79]
    v_rcp_f32 v124, v124
    v_mfma_f32_16x16x32_bf16 v[68:71], v[152:155], v[28:31], v[68:71]
    v_mul_f32 v60, v60, v52
    v_mul_f32 v61, v61, v53
    v_mfma_f32_16x16x32_bf16 v[68:71], v[144:147], v[24:27], v[68:71]
    ds_read_b128 v[24:27], v6 offset:17536
    ds_read_b128 v[28:31], v6 offset:17600
    s_waitcnt lgkmcnt(4)
    v_rcp_f32 v125, v125
    v_mfma_f32_16x16x32_bf16 v[68:71], v[160:163], v[32:35], v[68:71]
    v_rcp_f32 v126, v126
    v_mfma_f32_16x16x32_bf16 v[68:71], v[168:171], v[36:39], v[68:71]
    v_mul_f32 v62, v62, v54
    v_mul_f32 v63, v63, v55
    v_mfma_f32_16x16x32_bf16 v[76:79], v[172:175], v[36:39], v[76:79]
    v_rcp_f32 v127, v127
    v_mfma_f32_16x16x32_bf16 v[76:79], v[164:167], v[32:35], v[76:79]
    ds_read_b128 v[32:35], v6 offset:17664
    ds_read_b128 v[36:39], v6 offset:17728
    v_mul_f32 v56, v56, v112
    v_mul_f32 v57, v57, v113
    v_mfma_f32_16x16x32_bf16 v[76:79], v[180:183], v[40:43], v[76:79]
    v_mul_f32 v58, v58, v114
    v_mul_f32 v59, v59, v115
    v_mfma_f32_16x16x32_bf16 v[76:79], v[188:191], v[44:47], v[76:79]
    v_mul_f32 v60, v60, v124
    v_mul_f32 v61, v61, v125
    v_mfma_f32_16x16x32_bf16 v[68:71], v[184:187], v[44:47], v[68:71]
    v_mul_f32 v62, v62, v126
    v_mul_f32 v63, v63, v127
    v_mfma_f32_16x16x32_bf16 v[68:71], v[176:179], v[40:43], v[68:71]
    ds_read_b128 v[40:43], v6 offset:17792
    ds_read_b128 v[44:47], v6 offset:17856
    s_waitcnt lgkmcnt(4)
    v_cvt_pk_bf16_f32 v88, v56, v57
    v_cvt_pk_bf16_f32 v90, v60, v61
    v_mfma_f32_16x16x32_bf16 v[68:71], v[192:195], v[16:19], v[68:71]
    v_cvt_pk_bf16_f32 v89, v58, v59
    v_cvt_pk_bf16_f32 v91, v62, v63
    v_mfma_f32_16x16x32_bf16 v[68:71], v[200:203], v[20:23], v[68:71]
    v_permlane16_swap_b32 v88, v90
    v_permlane16_swap_b32 v89, v91
    v_mfma_f32_16x16x32_bf16 v[76:79], v[204:207], v[20:23], v[76:79]
    v_mfma_f32_16x16x32_bf16 v[76:79], v[196:199], v[16:19], v[76:79]
L_stub_GA_3_0:
    s_cbranch_execz L_warm
    v_mfma_f32_16x16x32_bf16 v[76:79], v[212:215], v[24:27], v[76:79]
    v_mfma_f32_16x16x32_bf16 v[76:79], v[220:223], v[28:31], v[76:79]
    v_mfma_f32_16x16x32_bf16 v[68:71], v[216:219], v[28:31], v[68:71]
    v_mfma_f32_16x16x32_bf16 v[68:71], v[208:211], v[24:27], v[68:71]
    s_waitcnt vmcnt(0) lgkmcnt(0)
    s_barrier
    buffer_store_dwordx4 v[88:91], v15, s[8:11], s26 offen sc1
    v_mfma_f32_16x16x32_bf16 v[68:71], v[224:227], v[32:35], v[68:71]
    v_mfma_f32_16x16x32_bf16 v[68:71], v[232:235], v[36:39], v[68:71]
    v_mfma_f32_16x16x32_bf16 v[76:79], v[236:239], v[36:39], v[76:79]
    v_mfma_f32_16x16x32_bf16 v[76:79], v[228:231], v[32:35], v[76:79]
    v_mfma_f32_16x16x32_bf16 v[76:79], v[244:247], v[40:43], v[76:79]
    v_mfma_f32_16x16x32_bf16 v[76:79], v[252:255], v[44:47], v[76:79]
    v_mfma_f32_16x16x32_bf16 v[68:71], v[248:251], v[44:47], v[68:71]
    v_mfma_f32_16x16x32_bf16 v[68:71], v[240:243], v[40:43], v[68:71]
    ds_read_b64 v[128:129], v8 offset:64
    ds_read_b64 v[130:131], v8 offset:72
    ds_read_b128 v[132:135], v9 offset:3648
    ds_read_b128 v[136:139], v9 offset:3136
    ds_read_b64 v[140:141], v8 offset:576
    ds_read_b64 v[142:143], v8 offset:584
    ds_read_b128 v[144:147], v9 offset:2624
    ds_read_b64 v[148:149], v8 offset:1088
    ds_read_b64 v[150:151], v8 offset:1096
    ds_read_b128 v[152:155], v9 offset:2112
    ds_read_b64 v[156:157], v8 offset:1600
    ds_read_b64 v[158:159], v8 offset:1608
    ds_read_b128 v[160:163], v9 offset:1600
    v_fma_f32 v64, -v117, v80, v64
    v_fma_f32 v65, -v117, v81, v65
    s_waitcnt lgkmcnt(7)
    v_mfma_f32_16x16x32_bf16 v[16:19], v[128:131], v[132:135], 0
    v_fma_f32 v66, -v117, v82, v66
    v_fma_f32 v67, -v117, v83, v67
    v_mfma_f32_16x16x32_bf16 v[20:23], v[128:131], v[136:139], 0
    v_fma_f32 v68, -v121, v80, v68
    v_fma_f32 v69, -v121, v81, v69
    v_mfma_f32_16x16x32_bf16 v[20:23], v[140:143], v[132:135], v[20:23]
    v_fma_f32 v70, -v121, v82, v70
    v_fma_f32 v71, -v121, v83, v71
    s_waitcnt lgkmcnt(4)
    v_mfma_f32_16x16x32_bf16 v[24:27], v[128:131], v[144:147], 0
    ds_read_b64 v[164:165], v8 offset:2112
    ds_read_b64 v[166:167], v8 offset:2120
    v_mul_f32 v112, v64, v64
    v_mul_f32 v113, v65, v65
    v_mfma_f32_16x16x32_bf16 v[24:27], v[140:143], v[136:139], v[24:27]
    ds_read_b128 v[168:171], v9 offset:1088
    v_mul_f32 v114, v66, v66
    v_mul_f32 v115, v67, v67
    v_mfma_f32_16x16x32_bf16 v[24:27], v[148:151], v[132:135], v[24:27]
    v_mul_f32 v124, v68, v68
    v_mul_f32 v125, v69, v69
    s_waitcnt lgkmcnt(6)
    v_mfma_f32_16x16x32_bf16 v[28:31], v[128:131], v[152:155], 0
    v_mul_f32 v126, v70, v70
    v_mul_f32 v127, v71, v71
    v_mfma_f32_16x16x32_bf16 v[28:31], v[140:143], v[144:147], v[28:31]
    v_fma_f32 v112, v112, v119, v118
    v_fma_f32 v113, v113, v119, v118
    v_mfma_f32_16x16x32_bf16 v[28:31], v[148:151], v[136:139], v[28:31]
    v_fma_f32 v114, v114, v119, v118
    v_fma_f32 v115, v115, v119, v118
    s_waitcnt lgkmcnt(3)
    v_mfma_f32_16x16x32_bf16 v[28:31], v[156:159], v[132:135], v[28:31]
    ds_read_b64 v[172:173], v8 offset:2624
    ds_read_b64 v[174:175], v8 offset:2632
    v_fma_f32 v124, v124, v123, v122
    v_fma_f32 v125, v125, v123, v122
    v_mfma_f32_16x16x32_bf16 v[32:35], v[128:131], v[160:163], 0
    ds_read_b128 v[176:179], v9 offset:576
    v_fma_f32 v126, v126, v123, v122
    v_fma_f32 v127, v127, v123, v122
    v_mfma_f32_16x16x32_bf16 v[32:35], v[140:143], v[152:155], v[32:35]
    v_mul_f32 v112, v112, v64
    v_mul_f32 v113, v113, v65
    v_mfma_f32_16x16x32_bf16 v[32:35], v[148:151], v[144:147], v[32:35]
    ds_read_b64 v[180:181], v8 offset:3136
    ds_read_b64 v[182:183], v8 offset:3144
    v_mul_f32 v114, v114, v66
    v_mul_f32 v115, v115, v67
    v_mfma_f32_16x16x32_bf16 v[32:35], v[156:159], v[136:139], v[32:35]
    v_mul_f32 v124, v124, v68
    v_mul_f32 v125, v125, v69
    s_waitcnt lgkmcnt(5)
    v_mfma_f32_16x16x32_bf16 v[32:35], v[164:167], v[132:135], v[32:35]
    v_mul_f32 v126, v126, v70
    v_mul_f32 v127, v127, v71
    v_mfma_f32_16x16x32_bf16 v[36:39], v[128:131], v[168:171], 0
    ds_read_b128 v[184:187], v9 offset:64
    v_exp_f32 v112, v112
    v_mfma_f32_16x16x32_bf16 v[36:39], v[140:143], v[160:163], v[36:39]
    ds_read_b64 v[188:189], v8 offset:3648
    ds_read_b64 v[190:191], v8 offset:3656
    v_fma_f32 v72, -v117, v84, v72
    v_fma_f32 v73, -v117, v85, v73
    v_mfma_f32_16x16x32_bf16 v[36:39], v[148:151], v[152:155], v[36:39]
    v_exp_f32 v113, v113
    v_mfma_f32_16x16x32_bf16 v[36:39], v[156:159], v[144:147], v[36:39]
    v_exp_f32 v114, v114
    v_mfma_f32_16x16x32_bf16 v[36:39], v[164:167], v[136:139], v[36:39]
    ds_read_b64 v[192:193], v8 offset:128
    ds_read_b64 v[194:195], v8 offset:136
    v_fma_f32 v74, -v117, v86, v74
    v_fma_f32 v75, -v117, v87, v75
    s_waitcnt lgkmcnt(7)
    v_mfma_f32_16x16x32_bf16 v[36:39], v[172:175], v[132:135], v[36:39]
    v_exp_f32 v115, v115
    v_mfma_f32_16x16x32_bf16 v[40:43], v[128:131], v[176:179], 0
    ds_read_b128 v[196:199], v9 offset:3712
    v_exp_f32 v124, v124
    v_mfma_f32_16x16x32_bf16 v[40:43], v[140:143], v[168:171], v[40:43]
    ds_read_b128 v[200:203], v9 offset:3200
    v_fma_f32 v76, -v121, v84, v76
    v_fma_f32 v77, -v121, v85, v77
    v_mfma_f32_16x16x32_bf16 v[40:43], v[148:151], v[160:163], v[40:43]
    ds_read_b64 v[204:205], v8 offset:640
    ds_read_b64 v[206:207], v8 offset:648
    v_exp_f32 v125, v125
    v_mfma_f32_16x16x32_bf16 v[40:43], v[156:159], v[152:155], v[40:43]
    v_exp_f32 v126, v126
    v_mfma_f32_16x16x32_bf16 v[40:43], v[164:167], v[144:147], v[40:43]
    v_fma_f32 v78, -v121, v86, v78
    v_fma_f32 v79, -v121, v87, v79
    v_mfma_f32_16x16x32_bf16 v[40:43], v[172:175], v[136:139], v[40:43]
    ds_read_b128 v[208:211], v9 offset:2688
    v_exp_f32 v127, v127
    s_waitcnt lgkmcnt(9)
    v_mfma_f32_16x16x32_bf16 v[40:43], v[180:183], v[132:135], v[40:43]
    ds_read_b64 v[212:213], v8 offset:1152
    ds_read_b64 v[214:215], v8 offset:1160
    v_add_f32 v112, 1.0, v112
    v_add_f32 v113, 1.0, v113
    v_mfma_f32_16x16x32_bf16 v[44:47], v[128:131], v[184:187], 0
    v_add_f32 v114, 1.0, v114
    v_add_f32 v115, 1.0, v115
    v_mfma_f32_16x16x32_bf16 v[44:47], v[140:143], v[176:179], v[44:47]
    ds_read_b128 v[216:219], v9 offset:2176
    v_add_f32 v124, 1.0, v124
    v_add_f32 v125, 1.0, v125
    v_mfma_f32_16x16x32_bf16 v[44:47], v[148:151], v[168:171], v[44:47]
    v_add_f32 v126, 1.0, v126
    v_add_f32 v127, 1.0, v127
    v_mfma_f32_16x16x32_bf16 v[44:47], v[156:159], v[160:163], v[44:47]
    ds_read_b64 v[220:221], v8 offset:1664
    ds_read_b64 v[222:223], v8 offset:1672
    v_rcp_f32 v112, v112
    v_mfma_f32_16x16x32_bf16 v[44:47], v[164:167], v[152:155], v[44:47]
    v_mul_f32 v72, v72, v64
    v_mul_f32 v73, v73, v65
    v_mfma_f32_16x16x32_bf16 v[44:47], v[172:175], v[144:147], v[44:47]
    v_rcp_f32 v113, v113
    v_mfma_f32_16x16x32_bf16 v[44:47], v[180:183], v[136:139], v[44:47]
    v_rcp_f32 v114, v114
    s_waitcnt lgkmcnt(8)
    v_mfma_f32_16x16x32_bf16 v[44:47], v[188:191], v[132:135], v[44:47]
    ds_read_b128 v[224:227], v9 offset:1664
    ds_read_b64 v[228:229], v8 offset:2176
    ds_read_b64 v[230:231], v8 offset:2184
    v_mul_f32 v74, v74, v66
    v_mul_f32 v75, v75, v67
    v_mfma_f32_16x16x32_bf16 v[16:19], v[192:195], v[196:199], v[16:19]
    v_rcp_f32 v115, v115
    v_mfma_f32_16x16x32_bf16 v[20:23], v[192:195], v[200:203], v[20:23]
    ds_read_b128 v[232:235], v9 offset:1152
    v_rcp_f32 v124, v124
    s_waitcnt lgkmcnt(9)
    v_mfma_f32_16x16x32_bf16 v[20:23], v[204:207], v[196:199], v[20:23]
    ds_read_b64 v[236:237], v8 offset:2688
    ds_read_b64 v[238:239], v8 offset:2696
    v_mul_f32 v76, v76, v68
    v_mul_f32 v77, v77, v69
    v_mfma_f32_16x16x32_bf16 v[24:27], v[192:195], v[208:211], v[24:27]
    v_rcp_f32 v125, v125
    v_mfma_f32_16x16x32_bf16 v[24:27], v[204:207], v[200:203], v[24:27]
    ds_read_b128 v[240:243], v9 offset:640
    v_rcp_f32 v126, v126
    s_waitcnt lgkmcnt(9)
    v_mfma_f32_16x16x32_bf16 v[24:27], v[212:215], v[196:199], v[24:27]
    ds_read_b64 v[244:245], v8 offset:3200
    ds_read_b64 v[246:247], v8 offset:3208
    v_mul_f32 v78, v78, v70
    v_mul_f32 v79, v79, v71
    v_mfma_f32_16x16x32_bf16 v[28:31], v[192:195], v[216:219], v[28:31]
    v_rcp_f32 v127, v127
    v_mfma_f32_16x16x32_bf16 v[28:31], v[204:207], v[208:211], v[28:31]
    v_mul_f32 v72, v72, v112
    v_mul_f32 v73, v73, v113
    v_mfma_f32_16x16x32_bf16 v[28:31], v[212:215], v[200:203], v[28:31]
    ds_read_b128 v[248:251], v9 offset:128
    v_mul_f32 v74, v74, v114
    v_mul_f32 v75, v75, v115
    s_waitcnt lgkmcnt(9)
    v_mfma_f32_16x16x32_bf16 v[28:31], v[220:223], v[196:199], v[28:31]
    ds_read_b64 v[252:253], v8 offset:3712
    ds_read_b64 v[254:255], v8 offset:3720
    v_mul_f32 v76, v76, v124
    v_mul_f32 v77, v77, v125
    v_mfma_f32_16x16x32_bf16 v[32:35], v[192:195], v[224:227], v[32:35]
    v_mul_f32 v78, v78, v126
    v_mul_f32 v79, v79, v127
    v_mfma_f32_16x16x32_bf16 v[32:35], v[204:207], v[216:219], v[32:35]
    v_cvt_pk_bf16_f32 v92, v72, v73
    v_cvt_pk_bf16_f32 v94, v76, v77
    v_mfma_f32_16x16x32_bf16 v[32:35], v[212:215], v[208:211], v[32:35]
    ds_read_b64 v[128:129], v8 offset:192
    ds_read_b64 v[130:131], v8 offset:200
    v_cvt_pk_bf16_f32 v93, v74, v75
    v_cvt_pk_bf16_f32 v95, v78, v79
    v_mfma_f32_16x16x32_bf16 v[32:35], v[220:223], v[200:203], v[32:35]
    v_permlane16_swap_b32 v92, v94
    v_permlane16_swap_b32 v93, v95
    buffer_store_dwordx4 v[92:95], v15, s[8:11], s27 offen sc1
    s_waitcnt lgkmcnt(10)
    v_mfma_f32_16x16x32_bf16 v[32:35], v[228:231], v[196:199], v[32:35]
    ds_read_b128 v[184:187], v9 offset:3776
    s_lshr_b32 s66, s48, 1
    v_mfma_f32_16x16x32_bf16 v[36:39], v[192:195], v[232:235], v[36:39]
    ds_read_b128 v[140:143], v9 offset:3264
    s_lshl_b32 s66, s66, 4
    v_mfma_f32_16x16x32_bf16 v[36:39], v[204:207], v[224:227], v[36:39]
    ds_read_b64 v[176:177], v8 offset:704
    ds_read_b64 v[178:179], v8 offset:712
    s_lshr_b32 s66, s46, s66
    v_mfma_f32_16x16x32_bf16 v[36:39], v[212:215], v[216:219], v[36:39]
    s_and_b32 s66, s66, 0xffff
    v_mfma_f32_16x16x32_bf16 v[36:39], v[220:223], v[208:211], v[36:39]
    v_and_b32 v110, 15, v0
    s_waitcnt vmcnt(1)
    buffer_store_dword v10, v11, s[8:11], s38 offen sc1
    v_mfma_f32_16x16x32_bf16 v[36:39], v[228:231], v[200:203], v[36:39]
    v_lshrrev_b32 v111, 4, v0
    s_waitcnt lgkmcnt(11)
    v_mfma_f32_16x16x32_bf16 v[36:39], v[236:239], v[196:199], v[36:39]
    ds_read_b128 v[148:151], v9 offset:2752
    ds_read_b64 v[168:169], v8 offset:1216
    ds_read_b64 v[170:171], v8 offset:1224
    v_lshl_add_u32 v110, v111, 3, v110
    v_mfma_f32_16x16x32_bf16 v[40:43], v[192:195], v[240:243], v[40:43]
    s_and_b32 s67, s48, 1
    v_mfma_f32_16x16x32_bf16 v[40:43], v[204:207], v[232:235], v[40:43]
    s_lshl_b32 s67, s67, 6
    v_mfma_f32_16x16x32_bf16 v[40:43], v[212:215], v[224:227], v[40:43]
    s_sub_u32 s67, 15, s67
    v_mfma_f32_16x16x32_bf16 v[40:43], v[220:223], v[216:219], v[40:43]
    v_sub_u32 v110, s67, v110
    v_mfma_f32_16x16x32_bf16 v[40:43], v[228:231], v[208:211], v[40:43]
    v_subrev_u32 v111, 0, v110
    v_mfma_f32_16x16x32_bf16 v[40:43], v[236:239], v[200:203], v[40:43]
    v_med3_i32 v111, v111, 0, 2
    s_waitcnt lgkmcnt(11)
    v_mfma_f32_16x16x32_bf16 v[40:43], v[244:247], v[196:199], v[40:43]
    ds_read_b128 v[156:159], v9 offset:2240
    ds_read_b64 v[160:161], v8 offset:1728
    ds_read_b64 v[162:163], v8 offset:1736
    v_lshlrev_b32 v111, 3, v111
    v_mfma_f32_16x16x32_bf16 v[44:47], v[192:195], v[248:251], v[44:47]
    v_lshlrev_b32 v100, v111, -1
    v_mfma_f32_16x16x32_bf16 v[44:47], v[204:207], v[240:243], v[44:47]
    v_lshlrev_b32 v100, v111, v100
    v_mfma_f32_16x16x32_bf16 v[44:47], v[212:215], v[232:235], v[44:47]
    v_subrev_u32 v111, 2, v110
    v_mfma_f32_16x16x32_bf16 v[44:47], v[220:223], v[224:227], v[44:47]
    v_med3_i32 v111, v111, 0, 2
    v_mfma_f32_16x16x32_bf16 v[44:47], v[228:231], v[216:219], v[44:47]
    v_lshlrev_b32 v111, 3, v111
    v_mfma_f32_16x16x32_bf16 v[44:47], v[236:239], v[208:211], v[44:47]
    v_lshlrev_b32 v101, v111, -1
    v_mfma_f32_16x16x32_bf16 v[44:47], v[244:247], v[200:203], v[44:47]
    v_lshlrev_b32 v101, v111, v101
    s_waitcnt lgkmcnt(8)
    v_mfma_f32_16x16x32_bf16 v[44:47], v[252:255], v[196:199], v[44:47]
    ds_read_b128 v[164:167], v9 offset:1728
    ds_read_b64 v[152:153], v8 offset:2240
    ds_read_b64 v[154:155], v8 offset:2248
    ds_read_b128 v[172:175], v9 offset:1216
    ds_read_b64 v[144:145], v8 offset:2752
    ds_read_b64 v[146:147], v8 offset:2760
    v_subrev_u32 v111, 4, v110
    v_mfma_f32_16x16x32_bf16 v[16:19], v[128:131], v[184:187], v[16:19]
    v_med3_i32 v111, v111, 0, 2
    v_mfma_f32_16x16x32_bf16 v[20:23], v[128:131], v[140:143], v[20:23]
    v_lshlrev_b32 v111, 3, v111
    s_waitcnt lgkmcnt(11)
    v_mfma_f32_16x16x32_bf16 v[20:23], v[176:179], v[184:187], v[20:23]
    ds_read_b128 v[180:183], v9 offset:704
    ds_read_b64 v[136:137], v8 offset:3264
    ds_read_b64 v[138:139], v8 offset:3272
    v_lshlrev_b32 v102, v111, -1
    v_mfma_f32_16x16x32_bf16 v[24:27], v[128:131], v[148:151], v[24:27]
    v_lshlrev_b32 v102, v111, v102
    v_mfma_f32_16x16x32_bf16 v[24:27], v[176:179], v[140:143], v[24:27]
    v_subrev_u32 v111, 6, v110
    s_waitcnt lgkmcnt(11)
    v_mfma_f32_16x16x32_bf16 v[24:27], v[168:171], v[184:187], v[24:27]
    ds_read_b128 v[188:191], v9 offset:192
    ds_read_b64 v[132:133], v8 offset:3776
    ds_read_b64 v[134:135], v8 offset:3784
    v_med3_i32 v111, v111, 0, 2
    v_mfma_f32_16x16x32_bf16 v[28:31], v[128:131], v[156:159], v[28:31]
    v_lshlrev_b32 v111, 3, v111
    v_mfma_f32_16x16x32_bf16 v[28:31], v[176:179], v[148:151], v[28:31]
    v_lshlrev_b32 v103, v111, -1
    v_mfma_f32_16x16x32_bf16 v[28:31], v[168:171], v[140:143], v[28:31]
    v_lshlrev_b32 v103, v111, v103
    s_waitcnt lgkmcnt(11)
    v_mfma_f32_16x16x32_bf16 v[28:31], v[160:163], v[184:187], v[28:31]
    ds_read_b64 v[192:193], v8 offset:0
    ds_read_b64 v[194:195], v8 offset:8
    ds_read_b128 v[248:251], v9 offset:3584
    v_and_b32 v111, 1, v110
    v_mfma_f32_16x16x32_bf16 v[32:35], v[128:131], v[164:167], v[32:35]
    v_lshlrev_b32 v111, 4, v111
    v_mfma_f32_16x16x32_bf16 v[32:35], v[176:179], v[156:159], v[32:35]
    v_lshlrev_b32 v111, v111, s66
    v_mfma_f32_16x16x32_bf16 v[32:35], v[168:171], v[148:151], v[32:35]
    v_ashrrev_i32 v110, 1, v110
    v_mfma_f32_16x16x32_bf16 v[32:35], v[160:163], v[140:143], v[32:35]
    v_cmp_eq_u32 s[68:69], 0, v110
    s_waitcnt lgkmcnt(11)
    v_mfma_f32_16x16x32_bf16 v[32:35], v[152:155], v[184:187], v[32:35]
    ds_read_b64 v[204:205], v8 offset:512
    ds_read_b64 v[206:207], v8 offset:520
    ds_read_b128 v[240:243], v9 offset:3072
    v_cndmask_b32 v96, 0, v111, s[68:69]
    v_mfma_f32_16x16x32_bf16 v[36:39], v[128:131], v[172:175], v[36:39]
    v_cmp_eq_u32 s[68:69], 1, v110
    v_mfma_f32_16x16x32_bf16 v[36:39], v[176:179], v[164:167], v[36:39]
    s_nop 0
    v_cndmask_b32 v97, 0, v111, s[68:69]
    v_mfma_f32_16x16x32_bf16 v[36:39], v[168:171], v[156:159], v[36:39]
    v_cmp_eq_u32 s[68:69], 2, v110
    v_mfma_f32_16x16x32_bf16 v[36:39], v[160:163], v[148:151], v[36:39]
    s_nop 0
    v_cndmask_b32 v98, 0, v111, s[68:69]
    v_mfma_f32_16x16x32_bf16 v[36:39], v[152:155], v[140:143], v[36:39]
    v_cmp_eq_u32 s[68:69], 3, v110
    s_waitcnt lgkmcnt(11)
    v_mfma_f32_16x16x32_bf16 v[36:39], v[144:147], v[184:187], v[36:39]
    ds_read_b64 v[212:213], v8 offset:1024
    ds_read_b64 v[214:215], v8 offset:1032
    ds_read_b128 v[232:235], v9 offset:2560
    v_cndmask_b32 v99, 0, v111, s[68:69]
    v_mfma_f32_16x16x32_bf16 v[40:43], v[128:131], v[180:183], v[40:43]
    v_xor_b32 v104, 36, v5
    v_mfma_f32_16x16x32_bf16 v[40:43], v[176:179], v[172:175], v[40:43]
    v_mov_b32 v105, 1
    v_mfma_f32_16x16x32_bf16 v[40:43], v[168:171], v[164:167], v[40:43]
    s_lshl_b32 s40, s55, 16
    v_mfma_f32_16x16x32_bf16 v[40:43], v[160:163], v[156:159], v[40:43]
    s_add_u32 s40, s40, s63
    v_mfma_f32_16x16x32_bf16 v[40:43], v[152:155], v[148:151], v[40:43]
    s_lshl_b32 s65, s56, 7
    v_mfma_f32_16x16x32_bf16 v[40:43], v[144:147], v[140:143], v[40:43]
    s_add_u32 s40, s40, s65
    s_waitcnt lgkmcnt(11)
    v_mfma_f32_16x16x32_bf16 v[40:43], v[136:139], v[184:187], v[40:43]
    ds_read_b64 v[220:221], v8 offset:1536
    ds_read_b64 v[222:223], v8 offset:1544
    ds_read_b128 v[224:227], v9 offset:2048
    s_add_u32 s41, s40, 32768
    v_mfma_f32_16x16x32_bf16 v[44:47], v[128:131], v[188:191], v[44:47]
    s_lshl_b32 s65, s48, 7
    v_mfma_f32_16x16x32_bf16 v[44:47], v[176:179], v[180:183], v[44:47]
    v_lshrrev_b32 v108, 3, v0
    v_mfma_f32_16x16x32_bf16 v[44:47], v[168:171], v[172:175], v[44:47]
    v_and_b32 v107, 7, v0
    v_lshlrev_b32 v107, 4, v107
    v_mfma_f32_16x16x32_bf16 v[44:47], v[160:163], v[164:167], v[44:47]
    v_lshl_add_u32 v107, v108, 10, v107
    v_mfma_f32_16x16x32_bf16 v[44:47], v[152:155], v[156:159], v[44:47]
    s_waitcnt vmcnt(1)
    buffer_store_dword v10, v11, s[8:11], s39 offen sc1
    v_mfma_f32_16x16x32_bf16 v[44:47], v[144:147], v[148:151], v[44:47]
    v_mfma_f32_16x16x32_bf16 v[44:47], v[136:139], v[140:143], v[44:47]
    s_waitcnt lgkmcnt(12)
    v_mfma_f32_16x16x32_bf16 v[44:47], v[132:135], v[184:187], v[44:47]
    ds_read_b64 v[228:229], v8 offset:2048
    ds_read_b64 v[230:231], v8 offset:2056
    ds_read_b128 v[216:219], v9 offset:1536
    s_waitcnt lgkmcnt(11)
    ds_read_b64 v[236:237], v8 offset:2560
    ds_read_b64 v[238:239], v8 offset:2568
    ds_read_b128 v[208:211], v9 offset:1024
    ds_read_b64 v[244:245], v8 offset:3072
    s_waitcnt lgkmcnt(11)
    ds_read_b64 v[246:247], v8 offset:3080
    ds_read_b128 v[200:203], v9 offset:512
    ds_read_b64 v[252:253], v8 offset:3584
    ds_read_b64 v[254:255], v8 offset:3592
    s_waitcnt lgkmcnt(11)
    ds_read_b128 v[196:199], v9 offset:0
    buffer_load_dwordx4 v[48:51], v107, s[4:7], s40 offen sc1
    buffer_load_dwordx4 v[52:55], v107, s[4:7], s41 offen sc1
    v_and_b32 v192, v192, v100
    v_and_b32 v193, v193, v101
    v_and_b32 v194, v194, v102
    v_and_b32 v195, v195, v103
    s_bitcmp1_b32 s48, 0
    s_cbranch_scc1 L_odd_1
    v_mfma_f32_16x16x32_bf16 v[20:23], v[192:195], v[240:243], v[20:23]
    v_mfma_f32_16x16x32_bf16 v[20:23], v[204:207], v[248:251], v[20:23]
    v_mfma_f32_16x16x32_bf16 v[20:23], v[96:99], v[240:243], v[20:23]
    v_mfma_f32_16x16x32_bf16 v[24:27], v[192:195], v[232:235], v[24:27]
    v_mfma_f32_16x16x32_bf16 v[24:27], v[204:207], v[240:243], v[24:27]
    v_mfma_f32_16x16x32_bf16 v[24:27], v[212:215], v[248:251], v[24:27]
    v_mfma_f32_16x16x32_bf16 v[24:27], v[96:99], v[232:235], v[24:27]
    s_waitcnt lgkmcnt(6)
    v_mfma_f32_16x16x32_bf16 v[36:39], v[192:195], v[208:211], v[36:39]
    v_mfma_f32_16x16x32_bf16 v[36:39], v[204:207], v[216:219], v[36:39]
    v_mfma_f32_16x16x32_bf16 v[36:39], v[212:215], v[224:227], v[36:39]
    v_mfma_f32_16x16x32_bf16 v[36:39], v[220:223], v[232:235], v[36:39]
    v_mfma_f32_16x16x32_bf16 v[36:39], v[228:231], v[240:243], v[36:39]
    v_mfma_f32_16x16x32_bf16 v[36:39], v[236:239], v[248:251], v[36:39]
    v_mfma_f32_16x16x32_bf16 v[36:39], v[96:99], v[208:211], v[36:39]
    s_waitcnt lgkmcnt(3)
    v_mfma_f32_16x16x32_bf16 v[40:43], v[192:195], v[200:203], v[40:43]
    v_mfma_f32_16x16x32_bf16 v[40:43], v[204:207], v[208:211], v[40:43]
    v_mfma_f32_16x16x32_bf16 v[40:43], v[212:215], v[216:219], v[40:43]
    v_mfma_f32_16x16x32_bf16 v[40:43], v[220:223], v[224:227], v[40:43]
    v_mfma_f32_16x16x32_bf16 v[40:43], v[228:231], v[232:235], v[40:43]
    v_mfma_f32_16x16x32_bf16 v[40:43], v[236:239], v[240:243], v[40:43]
    v_mfma_f32_16x16x32_bf16 v[40:43], v[244:247], v[248:251], v[40:43]
    v_mfma_f32_16x16x32_bf16 v[40:43], v[96:99], v[200:203], v[40:43]
    s_waitcnt lgkmcnt(0)
    v_mfma_f32_16x16x32_bf16 v[44:47], v[192:195], v[196:199], v[44:47]
    v_mfma_f32_16x16x32_bf16 v[44:47], v[204:207], v[200:203], v[44:47]
    ds_write_b128 v13, v[20:23] offset:0
    v_mfma_f32_16x16x32_bf16 v[44:47], v[212:215], v[208:211], v[44:47]
    v_mfma_f32_16x16x32_bf16 v[44:47], v[220:223], v[216:219], v[44:47]
    ds_write_b128 v13, v[24:27] offset:4160
    v_mfma_f32_16x16x32_bf16 v[44:47], v[228:231], v[224:227], v[44:47]
    v_mfma_f32_16x16x32_bf16 v[44:47], v[236:239], v[232:235], v[44:47]
    ds_write_b128 v13, v[36:39] offset:8320
    v_mfma_f32_16x16x32_bf16 v[44:47], v[244:247], v[240:243], v[44:47]
    v_mfma_f32_16x16x32_bf16 v[44:47], v[252:255], v[248:251], v[44:47]
    ds_write_b128 v13, v[40:43] offset:12480
    v_mfma_f32_16x16x32_bf16 v[44:47], v[96:99], v[196:199], v[44:47]
    ds_write_b32 v5, v105 offset:32
    v_mfma_f32_16x16x32_bf16 v[32:35], v[192:195], v[216:219], v[32:35]
    v_mfma_f32_16x16x32_bf16 v[32:35], v[204:207], v[224:227], v[32:35]
    v_mfma_f32_16x16x32_bf16 v[32:35], v[212:215], v[232:235], v[32:35]
    v_mfma_f32_16x16x32_bf16 v[32:35], v[220:223], v[240:243], v[32:35]
    v_mfma_f32_16x16x32_bf16 v[32:35], v[228:231], v[248:251], v[32:35]
    v_mfma_f32_16x16x32_bf16 v[32:35], v[96:99], v[216:219], v[32:35]
    ds_read_b32 v106, v104
    ds_read_b128 v[128:131], v14 offset:0
    ds_read_b128 v[188:191], v14 offset:4160
    ds_read_b128 v[176:179], v14 offset:8320
    ds_read_b128 v[180:183], v14 offset:12480
    v_mfma_f32_16x16x32_bf16 v[28:31], v[192:195], v[224:227], v[28:31]
    v_mfma_f32_16x16x32_bf16 v[28:31], v[204:207], v[232:235], v[28:31]
    v_mfma_f32_16x16x32_bf16 v[28:31], v[212:215], v[240:243], v[28:31]
    v_mfma_f32_16x16x32_bf16 v[28:31], v[220:223], v[248:251], v[28:31]
    v_mfma_f32_16x16x32_bf16 v[28:31], v[96:99], v[224:227], v[28:31]
    v_mfma_f32_16x16x32_bf16 v[16:19], v[192:195], v[248:251], v[16:19]
    v_mfma_f32_16x16x32_bf16 v[16:19], v[96:99], v[248:251], v[16:19]
    s_waitcnt lgkmcnt(0)
    v_cmp_ne_u32 vcc, 1, v106
    s_cbranch_vccz L_got_3
    s_mov_b32 s70, 0
L_spin_4:
    ds_read_b32 v106, v104
    ds_read_b128 v[128:131], v14 offset:0
    ds_read_b128 v[188:191], v14 offset:4160
    ds_read_b128 v[176:179], v14 offset:8320
    ds_read_b128 v[180:183], v14 offset:12480
    s_waitcnt lgkmcnt(0)
    v_cmp_ne_u32 vcc, 1, v106
    s_cbranch_vccz L_spinok_5
    s_add_u32 s70, s70, 1
    s_cmp_le_u32 s70, 2560000
    s_cbranch_scc1 L_spin_4
L_spinok_5:
L_got_3:
    v_add_f32 v176, v32, v176
    v_add_f32 v177, v33, v177
    v_add_f32 v178, v34, v178
    v_add_f32 v179, v35, v179
    v_add_f32 v180, v44, v180
    v_add_f32 v181, v45, v181
    v_add_f32 v182, v46, v182
    v_add_f32 v183, v47, v183
    v_cvt_pk_bf16_f32 v100, v176, v177
    v_cvt_pk_bf16_f32 v102, v180, v181
    v_cvt_pk_bf16_f32 v101, v178, v179
    v_cvt_pk_bf16_f32 v103, v182, v183
    v_permlane16_swap_b32 v100, v102
    s_nop 0
    v_permlane16_swap_b32 v101, v103
    buffer_store_dwordx4 v[100:103], v12, s[8:11], s34 offen offset:2048 sc1
    v_add_f32 v128, v16, v128
    v_add_f32 v129, v17, v129
    v_add_f32 v130, v18, v130
    v_add_f32 v131, v19, v131
    v_add_f32 v188, v28, v188
    v_add_f32 v189, v29, v189
    v_add_f32 v190, v30, v190
    v_add_f32 v191, v31, v191
    v_cvt_pk_bf16_f32 v96, v128, v129
    v_cvt_pk_bf16_f32 v98, v188, v189
    v_cvt_pk_bf16_f32 v97, v130, v131
    v_cvt_pk_bf16_f32 v99, v190, v191
    v_permlane16_swap_b32 v96, v98
    s_nop 0
    v_permlane16_swap_b32 v97, v99
    buffer_store_dwordx4 v[96:99], v12, s[8:11], s34 offen offset:0 sc1
    s_branch L_xjoin_2
L_odd_1:
    s_nop 1
    v_mfma_f32_16x16x32_bf16 v[16:19], v[192:195], v[248:251], v[16:19]
    v_mfma_f32_16x16x32_bf16 v[28:31], v[192:195], v[224:227], v[28:31]
    v_mfma_f32_16x16x32_bf16 v[28:31], v[204:207], v[232:235], v[28:31]
    v_mfma_f32_16x16x32_bf16 v[28:31], v[212:215], v[240:243], v[28:31]
    v_mfma_f32_16x16x32_bf16 v[28:31], v[220:223], v[248:251], v[28:31]
    s_waitcnt lgkmcnt(9)
    v_mfma_f32_16x16x32_bf16 v[32:35], v[192:195], v[216:219], v[32:35]
    v_mfma_f32_16x16x32_bf16 v[32:35], v[204:207], v[224:227], v[32:35]
    v_mfma_f32_16x16x32_bf16 v[32:35], v[212:215], v[232:235], v[32:35]
    v_mfma_f32_16x16x32_bf16 v[32:35], v[220:223], v[240:243], v[32:35]
    v_mfma_f32_16x16x32_bf16 v[32:35], v[228:231], v[248:251], v[32:35]
    s_waitcnt lgkmcnt(0)
    v_mfma_f32_16x16x32_bf16 v[44:47], v[192:195], v[196:199], v[44:47]
    v_mfma_f32_16x16x32_bf16 v[44:47], v[204:207], v[200:203], v[44:47]
    v_mfma_f32_16x16x32_bf16 v[44:47], v[212:215], v[208:211], v[44:47]
    v_mfma_f32_16x16x32_bf16 v[44:47], v[220:223], v[216:219], v[44:47]
    v_mfma_f32_16x16x32_bf16 v[44:47], v[228:231], v[224:227], v[44:47]
    v_mfma_f32_16x16x32_bf16 v[44:47], v[236:239], v[232:235], v[44:47]
    v_mfma_f32_16x16x32_bf16 v[44:47], v[244:247], v[240:243], v[44:47]
    v_mfma_f32_16x16x32_bf16 v[44:47], v[252:255], v[248:251], v[44:47]
    v_mfma_f32_16x16x32_bf16 v[40:43], v[192:195], v[200:203], v[40:43]
    v_mfma_f32_16x16x32_bf16 v[40:43], v[204:207], v[208:211], v[40:43]
    ds_write_b128 v13, v[16:19] offset:0
    v_mfma_f32_16x16x32_bf16 v[40:43], v[212:215], v[216:219], v[40:43]
    v_mfma_f32_16x16x32_bf16 v[40:43], v[220:223], v[224:227], v[40:43]
    ds_write_b128 v13, v[28:31] offset:4160
    v_mfma_f32_16x16x32_bf16 v[40:43], v[228:231], v[232:235], v[40:43]
    v_mfma_f32_16x16x32_bf16 v[40:43], v[236:239], v[240:243], v[40:43]
    ds_write_b128 v13, v[32:35] offset:8320
    v_mfma_f32_16x16x32_bf16 v[40:43], v[244:247], v[248:251], v[40:43]
    v_mfma_f32_16x16x32_bf16 v[36:39], v[192:195], v[208:211], v[36:39]
    ds_write_b128 v13, v[44:47] offset:12480
    v_mfma_f32_16x16x32_bf16 v[36:39], v[204:207], v[216:219], v[36:39]
    ds_write_b32 v5, v105 offset:32
    v_mfma_f32_16x16x32_bf16 v[36:39], v[212:215], v[224:227], v[36:39]
    v_mfma_f32_16x16x32_bf16 v[36:39], v[220:223], v[232:235], v[36:39]
    ds_read_b32 v106, v104
    ds_read_b128 v[128:131], v14 offset:0
    ds_read_b128 v[188:191], v14 offset:4160
    ds_read_b128 v[176:179], v14 offset:8320
    ds_read_b128 v[180:183], v14 offset:12480
    v_mfma_f32_16x16x32_bf16 v[36:39], v[228:231], v[240:243], v[36:39]
    v_mfma_f32_16x16x32_bf16 v[36:39], v[236:239], v[248:251], v[36:39]
    v_mfma_f32_16x16x32_bf16 v[24:27], v[192:195], v[232:235], v[24:27]
    v_mfma_f32_16x16x32_bf16 v[24:27], v[204:207], v[240:243], v[24:27]
    v_mfma_f32_16x16x32_bf16 v[24:27], v[212:215], v[248:251], v[24:27]
    v_mfma_f32_16x16x32_bf16 v[20:23], v[192:195], v[240:243], v[20:23]
    v_mfma_f32_16x16x32_bf16 v[20:23], v[204:207], v[248:251], v[20:23]
    s_waitcnt lgkmcnt(0)
    v_cmp_ne_u32 vcc, 1, v106
    s_cbranch_vccz L_got_6
    s_mov_b32 s70, 0
L_spin_7:
    ds_read_b32 v106, v104
    ds_read_b128 v[128:131], v14 offset:0
    ds_read_b128 v[188:191], v14 offset:4160
    ds_read_b128 v[176:179], v14 offset:8320
    ds_read_b128 v[180:183], v14 offset:12480
    s_waitcnt lgkmcnt(0)
    v_cmp_ne_u32 vcc, 1, v106
    s_cbranch_vccz L_spinok_8
    s_add_u32 s70, s70, 1
    s_cmp_le_u32 s70, 2560000
    s_cbranch_scc1 L_spin_7
L_spinok_8:
L_got_6:
    v_add_f32 v176, v36, v176
    v_add_f32 v177, v37, v177
    v_add_f32 v178, v38, v178
    v_add_f32 v179, v39, v179
    v_add_f32 v180, v40, v180
    v_add_f32 v181, v41, v181
    v_add_f32 v182, v42, v182
    v_add_f32 v183, v43, v183
    v_cvt_pk_bf16_f32 v100, v176, v177
    v_cvt_pk_bf16_f32 v102, v180, v181
    v_cvt_pk_bf16_f32 v101, v178, v179
    v_cvt_pk_bf16_f32 v103, v182, v183
    v_permlane16_swap_b32 v100, v102
    s_nop 0
    v_permlane16_swap_b32 v101, v103
    buffer_store_dwordx4 v[100:103], v12, s[8:11], s34 offen offset:2560 sc1
    v_add_f32 v128, v20, v128
    v_add_f32 v129, v21, v129
    v_add_f32 v130, v22, v130
    v_add_f32 v131, v23, v131
    v_add_f32 v188, v24, v188
    v_add_f32 v189, v25, v189
    v_add_f32 v190, v26, v190
    v_add_f32 v191, v27, v191
    v_cvt_pk_bf16_f32 v96, v128, v129
    v_cvt_pk_bf16_f32 v98, v188, v189
    v_cvt_pk_bf16_f32 v97, v130, v131
    v_cvt_pk_bf16_f32 v99, v190, v191
    v_permlane16_swap_b32 v96, v98
    s_nop 0
    v_permlane16_swap_b32 v97, v99
    buffer_store_dwordx4 v[96:99], v12, s[8:11], s34 offen offset:512 sc1
L_xjoin_2:
    s_setprio 0
    v_lshrrev_b32 v13, 3, v0
    v_and_b32 v14, 7, v0
    v_lshlrev_b32 v6, 4, v14
    v_lshl_add_u32 v6, v13, 12, v6
    s_lshr_b32 s65, s55, 2
    s_lshr_b32 s66, s55, 3
    s_xor_b32 s65, s65, s66
    s_and_b32 s65, s65, 1
    s_lshl_b32 s65, s65, 15
    s_lshl_b32 s66, s56, 12
    s_add_u32 s65, s65, s66
    s_add_u32 s65, s65, s61
    s_add_u32 s65, s65, 131072
    v_bfe_u32 v8, v0, 1, 3
L_stub_GA_4_0:
    s_cbranch_execz L_warm
    v_and_b32 v9, 1, v0
    v_lshlrev_b32 v9, 2, v9
    v_lshl_add_u32 v8, v8, 7, v9
    v_add_u32 v8, s65, v8
    s_add_u32 s20, s8, s65
    s_addc_u32 s21, s9, 0
    s_mov_b32 s22, s47
    s_mov_b32 s23, s47
    s_lshl_b32 s44, s56, 18
    s_lshl_b32 s66, s48, 16
    s_add_u32 s44, s44, s66
    s_lshl_b32 s66, s55, 7
    s_add_u32 s44, s44, s66
    s_add_u32 s44, s44, 3145728
    s_add_u32 s45, s44, 32768
    s_mul_i32 s66, s48, 12320
    s_add_u32 s66, s66, 109568
    v_add_u32 v12, s66, v15
    v_lshlrev_b32 v9, 1, v14
    v_xor_b32 v9, v9, v13
    s_lshl_b32 s65, s48, 11
    s_add_u32 s65, s65, 33792
    v_lshlrev_b32 v44, 8, v13
    v_lshl_add_u32 v44, v9, 4, v44
    v_xor_b32 v45, 16, v44
    v_add_u32 v44, s65, v44
    v_add_u32 v45, s65, v45
    v_lshrrev_b32 v9, 1, v14
    v_mul_u32_u24 v30, 12288, v9
    v_and_b32 v9, 1, v14
    v_lshl_add_u32 v30, v9, 10, v30
    v_lshl_add_u32 v30, v14, 4, v30
    v_lshl_add_u32 v30, v13, 1, v30
    s_lshl_b32 s65, s48, 4
    s_add_u32 s65, s65, 109568
    v_add_u32 v30, s65, v30
    v_mov_b32 v13, 155136
    v_mov_b32 v31, 155184
    v_add_u32 v14, 16, v5
    s_waitcnt vmcnt(0)
    buffer_store_dword v10, v11, s[8:11], s71 offen sc1
    v_mov_b32 v160, 0
    v_mov_b32 v161, 0
    v_mov_b32 v162, 0
    v_mov_b32 v163, 0
    v_mov_b32 v164, 0
    v_mov_b32 v165, 0
    v_mov_b32 v166, 0
    v_mov_b32 v167, 0
    v_mov_b32 v168, 0
    v_mov_b32 v169, 0
    v_mov_b32 v170, 0
    v_mov_b32 v171, 0
    v_mov_b32 v172, 0
    v_mov_b32 v173, 0
    v_mov_b32 v174, 0
    v_mov_b32 v175, 0
    v_lshlrev_b32 v128, 16, v48
    v_and_b32 v129, 0xffff0000, v48
    v_lshlrev_b32 v130, 16, v49
    v_and_b32 v131, 0xffff0000, v49
    v_lshlrev_b32 v132, 16, v50
    v_and_b32 v133, 0xffff0000, v50
    v_lshlrev_b32 v134, 16, v51
    v_and_b32 v135, 0xffff0000, v51
    v_mul_f32 v58, 0xbede652a, v2
    v_mul_f32 v59, v58, v58
    v_mul_f32 v58, v58, v59
    v_mul_f32 v26, 0xbfb8aa3b, v59
    v_mul_f32 v27, 0xbfb8aa3b, v59
    v_sub_f32 v144, v128, v1
    v_sub_f32 v145, v129, v1
    v_sub_f32 v146, v130, v1
    v_sub_f32 v147, v131, v1
    v_sub_f32 v148, v132, v1
    v_sub_f32 v149, v133, v1
    v_sub_f32 v150, v134, v1
    v_sub_f32 v151, v135, v1
    v_mul_f32 v144, v144, v58
    v_mul_f32 v145, v145, v58
    v_mul_f32 v146, v146, v58
    v_mul_f32 v147, v147, v58
    v_mul_f32 v148, v148, v58
    v_mul_f32 v149, v149, v58
    v_mul_f32 v150, v150, v58
    v_mul_f32 v151, v151, v58
    v_lshlrev_b32 v136, 16, v52
    v_and_b32 v137, 0xffff0000, v52
    v_lshlrev_b32 v138, 16, v53
    v_and_b32 v139, 0xffff0000, v53
    v_lshlrev_b32 v140, 16, v54
    v_and_b32 v141, 0xffff0000, v54
    v_lshlrev_b32 v142, 16, v55
    v_and_b32 v143, 0xffff0000, v55
    v_mul_f32 v62, 0xbede652a, v4
    v_mul_f32 v63, v62, v62
    v_mul_f32 v62, v62, v63
    v_mul_f32 v28, 0xbfb8aa3b, v63
    v_mul_f32 v29, 0xbfb8aa3b, v63
    v_sub_f32 v152, v136, v3
    v_sub_f32 v153, v137, v3
    v_sub_f32 v154, v138, v3
    v_sub_f32 v155, v139, v3
    v_sub_f32 v156, v140, v3
    v_sub_f32 v157, v141, v3
    v_sub_f32 v158, v142, v3
    v_sub_f32 v159, v143, v3
    v_mul_f32 v152, v152, v62
    v_mul_f32 v153, v153, v62
    v_mul_f32 v154, v154, v62
    v_mul_f32 v155, v155, v62
    v_mul_f32 v156, v156, v62
    v_mul_f32 v157, v157, v62
    v_mul_f32 v158, v158, v62
    v_mul_f32 v159, v159, v62
    v_mov_b32 v24, 1.0
    v_mov_b32 v25, 1.0
    s_mov_b32 s70, 0
L_spin_9:
    ds_read_b32 v40, v14
    s_waitcnt lgkmcnt(0)
    v_cmp_ne_u32 vcc, 1, v40
    s_cbranch_vccz L_spinok_10
    s_add_u32 s70, s70, 1
    s_cmp_le_u32 s70, 2560000
    s_cbranch_scc1 L_spin_9
L_spinok_10:
    s_setprio 2
    s_mov_b32 s70, 0
L_sp_11_0:
    s_load_dwordx2 s[24:25], s[20:21], 0 glc
L_sp_11_1:
    s_load_dwordx2 s[26:27], s[20:21], 128 glc
L_sp_11_2:
    s_load_dwordx2 s[28:29], s[20:21], 256 glc
L_sp_11_3:
    s_load_dwordx2 s[30:31], s[20:21], 384 glc
L_sp_11_4:
    s_load_dwordx2 s[32:33], s[20:21], 512 glc
L_sp_11_5:
    s_load_dwordx2 s[34:35], s[20:21], 640 glc
L_sp_11_6:
    s_load_dwordx2 s[36:37], s[20:21], 768 glc
L_sp_11_7:
    s_load_dwordx2 s[38:39], s[20:21], 896 glc
    s_add_u32 s70, s70, 1
    s_waitcnt lgkmcnt(0)
    s_cmp_gt_u32 s70, 40000
    s_cbranch_scc1 L_ok_12
    s_cmp_lg_u64 s[24:25], s[22:23]
    s_cbranch_scc1 L_sp_11_0
    s_cmp_lg_u64 s[26:27], s[22:23]
    s_cbranch_scc1 L_sp_11_1
    s_cmp_lg_u64 s[28:29], s[22:23]
    s_cbranch_scc1 L_sp_11_2
    s_cmp_lg_u64 s[30:31], s[22:23]
    s_cbranch_scc1 L_sp_11_3
    s_cmp_lg_u64 s[32:33], s[22:23]
    s_cbranch_scc1 L_sp_11_4
    s_cmp_lg_u64 s[34:35], s[22:23]
    s_cbranch_scc1 L_sp_11_5
    s_cmp_lg_u64 s[36:37], s[22:23]
    s_cbranch_scc1 L_sp_11_6
    s_cmp_lg_u64 s[38:39], s[22:23]
    s_cbranch_scc1 L_sp_11_7
L_ok_12:
    buffer_load_dwordx4 v[64:67], v6, s[8:11], s44 offen sc1
    buffer_load_dwordx4 v[68:71], v6, s[8:11], s45 offen sc1
    s_setprio 0
    s_mov_b32 s70, 0
L_spin_13:
    ds_read_b128 v[40:43], v13
    s_waitcnt lgkmcnt(0)
    v_and_b32 v40, v40, v41
    v_and_b32 v42, v42, v43
    v_and_b32 v40, v40, v42
    v_cmp_ne_u32 vcc, 1, v40
    s_cbranch_vccz L_spinok_14
    s_add_u32 s70, s70, 1
    s_cmp_le_u32 s70, 2560000
    s_cbranch_scc1 L_spin_13
L_spinok_14:
    s_setprio 2
    ds_read_b128 v[192:195], v44 offset:0
    ds_read_b128 v[196:199], v45 offset:0
    ds_read_b128 v[200:203], v44 offset:8192
    ds_read_b128 v[204:207], v45 offset:8192
    ds_read_b128 v[208:211], v44 offset:16384
    ds_read_b128 v[212:215], v45 offset:16384
    ds_read_b128 v[216:219], v44 offset:24576
    ds_read_b128 v[220:223], v45 offset:24576
    s_waitcnt lgkmcnt(4)
    v_add_f32 v176, v192, v200
    v_add_f32 v177, v193, v201
    v_add_f32 v178, v194, v202
    v_add_f32 v179, v195, v203
    v_add_f32 v180, v196, v204
    v_add_f32 v181, v197, v205
    v_add_f32 v182, v198, v206
    v_add_f32 v183, v199, v207
    s_waitcnt lgkmcnt(2)
    v_add_f32 v176, v176, v208
    v_add_f32 v177, v177, v209
    v_add_f32 v178, v178, v210
    v_add_f32 v179, v179, v211
    v_add_f32 v180, v180, v212
    v_add_f32 v181, v181, v213
    v_add_f32 v182, v182, v214
    v_add_f32 v183, v183, v215
    s_waitcnt lgkmcnt(0)
    v_add_f32 v176, v176, v216
    v_add_f32 v177, v177, v217
    v_add_f32 v178, v178, v218
    v_add_f32 v179, v179, v219
    v_add_f32 v180, v180, v220
    v_add_f32 v181, v181, v221
    v_add_f32 v182, v182, v222
    v_add_f32 v183, v183, v223
    v_mul_f32 v224, v176, v26
    v_mul_f32 v225, v177, v26
    v_mul_f32 v226, v178, v26
    v_mul_f32 v227, v179, v26
    v_mul_f32 v228, v180, v26
    v_mul_f32 v229, v181, v26
    v_mul_f32 v230, v182, v26
    v_mul_f32 v231, v183, v26
    v_exp_f32 v224, v224
    v_exp_f32 v225, v225
    v_exp_f32 v226, v226
    v_exp_f32 v227, v227
    v_exp_f32 v228, v228
    v_exp_f32 v229, v229
    v_exp_f32 v230, v230
    v_exp_f32 v231, v231
    v_mul_f32 v176, v176, v144
    v_mul_f32 v177, v177, v145
    v_mul_f32 v178, v178, v146
    v_mul_f32 v179, v179, v147
    v_mul_f32 v180, v180, v148
    v_mul_f32 v181, v181, v149
    v_mul_f32 v182, v182, v150
    v_mul_f32 v183, v183, v151
    v_add_f32 v224, v224, v24
    v_add_f32 v225, v225, v24
    v_add_f32 v226, v226, v24
    v_add_f32 v227, v227, v24
    v_add_f32 v228, v228, v24
    v_add_f32 v229, v229, v24
    v_add_f32 v230, v230, v24
    v_add_f32 v231, v231, v24
    v_rcp_f32 v224, v224
    v_rcp_f32 v225, v225
    v_rcp_f32 v226, v226
    v_rcp_f32 v227, v227
    v_rcp_f32 v228, v228
    v_rcp_f32 v229, v229
    v_rcp_f32 v230, v230
    v_rcp_f32 v231, v231
    v_mul_f32 v176, v176, v224
    v_mul_f32 v177, v177, v225
    v_mul_f32 v178, v178, v226
    v_mul_f32 v179, v179, v227
    v_mul_f32 v180, v180, v228
    v_mul_f32 v181, v181, v229
    v_mul_f32 v182, v182, v230
    v_mul_f32 v183, v183, v231
    s_waitcnt vmcnt(0)
    ds_write_b128 v12, v[64:67] offset:0
    ds_write_b128 v12, v[68:71] offset:1040
    s_waitcnt lgkmcnt(0)
    s_barrier
    ds_read_b128 v[192:195], v44 offset:33792
    ds_read_b128 v[196:199], v45 offset:33792
    ds_read_b128 v[200:203], v44 offset:41984
    ds_read_b128 v[204:207], v45 offset:41984
    ds_read_b128 v[208:211], v44 offset:50176
    ds_read_b128 v[212:215], v45 offset:50176
    ds_read_b128 v[216:219], v44 offset:58368
    ds_read_b128 v[220:223], v45 offset:58368
    ds_read_u16_d16_hi v160, v30 offset:0
    ds_read_u16_d16_hi v161, v30 offset:128
    ds_read_u16_d16_hi v162, v30 offset:256
    ds_read_u16_d16_hi v163, v30 offset:384
    ds_read_u16_d16_hi v164, v30 offset:512
    ds_read_u16_d16_hi v165, v30 offset:640
    ds_read_u16_d16_hi v166, v30 offset:768
    s_waitcnt lgkmcnt(11)
    ds_read_u16_d16_hi v167, v30 offset:896
    ds_read_u16_d16_hi v168, v30 offset:64
    ds_read_u16_d16_hi v169, v30 offset:192
    ds_read_u16_d16_hi v170, v30 offset:320
    s_waitcnt lgkmcnt(11)
    ds_read_u16_d16_hi v171, v30 offset:448
    ds_read_u16_d16_hi v172, v30 offset:576
    ds_read_u16_d16_hi v173, v30 offset:704
    ds_read_u16_d16_hi v174, v30 offset:832
    s_waitcnt lgkmcnt(11)
    ds_read_u16_d16_hi v175, v30 offset:960
    v_pk_add_f32 v[184:185], v[192:193], v[200:201]
    v_pk_add_f32 v[186:187], v[194:195], v[202:203]
    v_pk_add_f32 v[188:189], v[196:197], v[204:205]
    v_pk_add_f32 v[190:191], v[198:199], v[206:207]
    v_pk_add_f32 v[184:185], v[184:185], v[208:209]
    v_pk_add_f32 v[186:187], v[186:187], v[210:211]
    v_pk_add_f32 v[188:189], v[188:189], v[212:213]
    v_pk_add_f32 v[190:191], v[190:191], v[214:215]
    v_pk_add_f32 v[184:185], v[184:185], v[216:217]
    v_pk_add_f32 v[186:187], v[186:187], v[218:219]
    v_pk_add_f32 v[188:189], v[188:189], v[220:221]
    v_pk_add_f32 v[190:191], v[190:191], v[222:223]
    v_pk_mul_f32 v[224:225], v[184:185], v[28:29]
    v_pk_mul_f32 v[226:227], v[186:187], v[28:29]
    v_pk_mul_f32 v[228:229], v[188:189], v[28:29]
    v_pk_mul_f32 v[230:231], v[190:191], v[28:29]
    v_exp_f32 v224, v224
    v_exp_f32 v225, v225
    v_exp_f32 v226, v226
    v_exp_f32 v227, v227
    v_exp_f32 v228, v228
    v_exp_f32 v229, v229
    v_exp_f32 v230, v230
    v_exp_f32 v231, v231
    v_pk_mul_f32 v[184:185], v[184:185], v[152:153]
    v_pk_mul_f32 v[186:187], v[186:187], v[154:155]
    v_pk_mul_f32 v[188:189], v[188:189], v[156:157]
    v_pk_mul_f32 v[190:191], v[190:191], v[158:159]
    v_pk_add_f32 v[224:225], v[224:225], v[24:25]
    v_pk_add_f32 v[226:227], v[226:227], v[24:25]
    v_pk_add_f32 v[228:229], v[228:229], v[24:25]
    v_pk_add_f32 v[230:231], v[230:231], v[24:25]
    v_rcp_f32 v224, v224
    v_rcp_f32 v225, v225
    v_rcp_f32 v226, v226
    v_rcp_f32 v227, v227
    v_rcp_f32 v228, v228
    v_rcp_f32 v229, v229
    v_rcp_f32 v230, v230
    v_rcp_f32 v231, v231
    s_waitcnt lgkmcnt(0)
    v_pk_fma_f32 v[176:177], v[176:177], v[160:161], v[128:129]
    v_pk_fma_f32 v[178:179], v[178:179], v[162:163], v[130:131]
    v_pk_fma_f32 v[180:181], v[180:181], v[164:165], v[132:133]
    v_pk_fma_f32 v[182:183], v[182:183], v[166:167], v[134:135]
    v_cvt_pk_bf16_f32 v32, v176, v177
    v_cvt_pk_bf16_f32 v33, v178, v179
    v_cvt_pk_bf16_f32 v34, v180, v181
    v_cvt_pk_bf16_f32 v35, v182, v183
    buffer_store_dwordx4 v[32:35], v107, s[16:19], s40 offen sc1
    v_pk_mul_f32 v[184:185], v[184:185], v[168:169]
    v_pk_mul_f32 v[186:187], v[186:187], v[170:171]
    v_pk_mul_f32 v[188:189], v[188:189], v[172:173]
    v_pk_mul_f32 v[190:191], v[190:191], v[174:175]
    v_pk_fma_f32 v[184:185], v[184:185], v[224:225], v[136:137]
    v_pk_fma_f32 v[186:187], v[186:187], v[226:227], v[138:139]
    v_pk_fma_f32 v[188:189], v[188:189], v[228:229], v[140:141]
    v_pk_fma_f32 v[190:191], v[190:191], v[230:231], v[142:143]
    v_cvt_pk_bf16_f32 v36, v184, v185
    v_cvt_pk_bf16_f32 v37, v186, v187
    v_cvt_pk_bf16_f32 v38, v188, v189
    v_cvt_pk_bf16_f32 v39, v190, v191
    buffer_store_dwordx4 v[36:39], v107, s[16:19], s41 offen sc1
    s_endpgm
L_role_p:
    s_load_dwordx2 s[28:29], s[0:1], 8
    s_load_dwordx2 s[36:37], s[0:1], 24
    s_load_dwordx2 s[32:33], s[0:1], 16
    s_load_dwordx2 s[8:9], s[0:1], 96
    s_cmp_lt_u32 s49, 4
    s_cbranch_scc1 L_PA
    v_lshlrev_b32 v5, 4, v0
    s_load_dwordx2 s[12:13], s[0:1], 72
    s_load_dwordx2 s[40:41], s[0:1], 32
    s_mov_b32 s30, 2097152
    s_mov_b32 s31, 0x00020000
    s_mov_b32 s34, 2097152
    s_mov_b32 s35, 0x00020000
    s_mov_b32 s38, 4096
    s_mov_b32 s39, 0x00020000
    s_mov_b32 s10, 12582912
    s_mov_b32 s11, 0x00020000
    s_waitcnt lgkmcnt(0)
    s_load_dword s47, s[8:9], 0
    v_lshrrev_b32 v249, 3, v0
    v_and_b32 v250, 7, v0
    v_lshlrev_b32 v251, 4, v250
    v_lshl_add_u32 v251, v249, 13, v251
    s_sub_u32 s53, s2, 224
    s_lshl_b32 s53, s53, 16
    s_lshl_b32 s54, s49, 7
    s_add_u32 s53, s53, s54
    s_add_u32 s54, s53, 4096
    s_sub_u32 s64, s53, 3072
    v_add_u32 v252, s64, v251
    v_lshlrev_b32 v253, 6, v250
    s_lshl_b32 s64, s49, 9
    buffer_load_dwordx4 v[204:207], v253, s[36:39], s64 offen offset:0
    buffer_load_dwordx4 v[208:211], v253, s[36:39], s64 offen offset:16
    buffer_load_dwordx4 v[212:215], v253, s[36:39], s64 offen offset:32
    buffer_load_dwordx4 v[216:219], v253, s[36:39], s64 offen offset:48
    buffer_load_dwordx4 v[160:163], v251, s[28:31], s54 offen offset:1024
    buffer_load_dwordx4 v[128:131], v252, s[28:31], 0 offen offset:0
    buffer_load_dwordx4 v[164:167], v251, s[28:31], s54 offen offset:2048
    buffer_load_dwordx4 v[132:135], v252, s[28:31], 0 offen offset:1024
    buffer_load_dwordx4 v[168:171], v251, s[28:31], s54 offen offset:3072
    buffer_load_dwordx4 v[136:139], v252, s[28:31], 0 offen offset:2048
    buffer_load_dwordx4 v[140:143], v251, s[28:31], s53 offen offset:0
    buffer_load_dwordx4 v[144:147], v251, s[28:31], s53 offen offset:1024
    buffer_load_dwordx4 v[148:151], v251, s[28:31], s53 offen offset:2048
    buffer_load_dwordx4 v[152:155], v251, s[28:31], s53 offen offset:3072
    buffer_load_dwordx4 v[156:159], v251, s[28:31], s54 offen offset:0
    s_waitcnt lgkmcnt(0)
    s_add_u32 s47, s47, 0x9e3779b1
    s_barrier
    v_mov_b32 v11, s47
    v_sub_u32 v252, 7, v250
    v_lshl_add_u32 v252, v252, 3, v249
    v_lshlrev_b32 v252, 2, v252
    v_lshlrev_b32 v253, 4, v250
    v_lshl_add_u32 v253, v249, 15, v253
    s_sub_u32 s70, s2, 224
    s_lshl_b32 s70, s70, 7
    s_lshl_b32 s64, s49, 18
    s_sub_u32 s64, s64, s70
    s_add_u32 s64, s64, 1052544
    buffer_load_dwordx4 v[172:175], v251, s[32:35], s53 offen offset:0
    buffer_load_dwordx4 v[176:179], v251, s[32:35], s53 offen offset:1024
    buffer_load_dwordx4 v[180:183], v251, s[32:35], s53 offen offset:2048
    buffer_load_dwordx4 v[184:187], v251, s[32:35], s53 offen offset:3072
    buffer_load_dwordx4 v[188:191], v251, s[32:35], s54 offen offset:0
    buffer_load_dwordx4 v[192:195], v251, s[32:35], s54 offen offset:1024
    buffer_load_dwordx4 v[196:199], v251, s[32:35], s54 offen offset:2048
    buffer_load_dwordx4 v[200:203], v251, s[32:35], s54 offen offset:3072
    s_waitcnt vmcnt(8)
    v_lshlrev_b32 v100, 16, v204
    v_and_b32 v101, 0xffff0000, v204
    v_lshlrev_b32 v102, 16, v205
    v_and_b32 v103, 0xffff0000, v205
    v_lshlrev_b32 v88, 16, v128
    v_lshlrev_b32 v89, 16, v132
    v_lshlrev_b32 v90, 16, v136
    v_lshlrev_b32 v91, 16, v140
    v_lshlrev_b32 v92, 16, v144
    v_lshlrev_b32 v93, 16, v148
    v_lshlrev_b32 v94, 16, v152
    v_lshlrev_b32 v95, 16, v156
    v_lshlrev_b32 v96, 16, v160
    v_lshlrev_b32 v97, 16, v164
    v_lshlrev_b32 v98, 16, v168
    v_mul_f32 v24, v88, v103
    v_mul_f32 v25, v89, v103
    v_mul_f32 v26, v90, v103
    v_mul_f32 v27, v91, v103
    v_mul_f32 v28, v92, v103
    v_mul_f32 v29, v93, v103
    v_mul_f32 v30, v94, v103
    v_mul_f32 v31, v95, v103
    v_fmac_f32 v24, v89, v102
    v_fmac_f32 v25, v90, v102
    v_fmac_f32 v26, v91, v102
    v_fmac_f32 v27, v92, v102
    v_fmac_f32 v28, v93, v102
    v_fmac_f32 v29, v94, v102
    v_fmac_f32 v30, v95, v102
    v_fmac_f32 v31, v96, v102
    v_fmac_f32 v24, v90, v101
    v_fmac_f32 v25, v91, v101
    v_fmac_f32 v26, v92, v101
    v_fmac_f32 v27, v93, v101
    v_fmac_f32 v28, v94, v101
    v_fmac_f32 v29, v95, v101
    v_fmac_f32 v30, v96, v101
    v_fmac_f32 v31, v97, v101
    v_fmac_f32 v24, v91, v100
    v_fmac_f32 v25, v92, v100
    v_fmac_f32 v26, v93, v100
    v_fmac_f32 v27, v94, v100
    v_fmac_f32 v28, v95, v100
    v_fmac_f32 v29, v96, v100
    v_fmac_f32 v30, v97, v100
    v_fmac_f32 v31, v98, v100
    v_lshlrev_b32 v100, 16, v206
    v_and_b32 v101, 0xffff0000, v206
    v_lshlrev_b32 v102, 16, v207
    v_and_b32 v103, 0xffff0000, v207
    v_and_b32 v88, 0xffff0000, v128
    v_and_b32 v89, 0xffff0000, v132
    v_and_b32 v90, 0xffff0000, v136
    v_and_b32 v91, 0xffff0000, v140
    v_and_b32 v92, 0xffff0000, v144
    v_and_b32 v93, 0xffff0000, v148
    v_and_b32 v94, 0xffff0000, v152
    v_and_b32 v95, 0xffff0000, v156
    v_and_b32 v96, 0xffff0000, v160
    v_and_b32 v97, 0xffff0000, v164
    v_and_b32 v98, 0xffff0000, v168
    v_mul_f32 v32, v88, v103
    v_mul_f32 v33, v89, v103
    v_mul_f32 v34, v90, v103
    v_mul_f32 v35, v91, v103
    v_mul_f32 v36, v92, v103
    v_mul_f32 v37, v93, v103
    v_mul_f32 v38, v94, v103
    v_mul_f32 v39, v95, v103
    v_fmac_f32 v32, v89, v102
    v_fmac_f32 v33, v90, v102
    v_fmac_f32 v34, v91, v102
    v_fmac_f32 v35, v92, v102
    v_fmac_f32 v36, v93, v102
    v_fmac_f32 v37, v94, v102
    v_fmac_f32 v38, v95, v102
    v_fmac_f32 v39, v96, v102
    v_fmac_f32 v32, v90, v101
    v_fmac_f32 v33, v91, v101
    v_fmac_f32 v34, v92, v101
    v_fmac_f32 v35, v93, v101
    v_fmac_f32 v36, v94, v101
    v_fmac_f32 v37, v95, v101
    v_fmac_f32 v38, v96, v101
    v_fmac_f32 v39, v97, v101
    v_fmac_f32 v32, v91, v100
    v_fmac_f32 v33, v92, v100
    v_fmac_f32 v34, v93, v100
    v_fmac_f32 v35, v94, v100
    v_fmac_f32 v36, v95, v100
    v_fmac_f32 v37, v96, v100
    v_fmac_f32 v38, v97, v100
    v_fmac_f32 v39, v98, v100
    v_lshlrev_b32 v100, 16, v208
    v_and_b32 v101, 0xffff0000, v208
    v_lshlrev_b32 v102, 16, v209
    v_and_b32 v103, 0xffff0000, v209
    v_lshlrev_b32 v88, 16, v129
    v_lshlrev_b32 v89, 16, v133
    v_lshlrev_b32 v90, 16, v137
    v_lshlrev_b32 v91, 16, v141
    v_lshlrev_b32 v92, 16, v145
    v_lshlrev_b32 v93, 16, v149
    v_lshlrev_b32 v94, 16, v153
    v_lshlrev_b32 v95, 16, v157
    v_lshlrev_b32 v96, 16, v161
    v_lshlrev_b32 v97, 16, v165
    v_lshlrev_b32 v98, 16, v169
    v_mul_f32 v40, v88, v103
    v_mul_f32 v41, v89, v103
    v_mul_f32 v42, v90, v103
    v_mul_f32 v43, v91, v103
    v_mul_f32 v44, v92, v103
    v_mul_f32 v45, v93, v103
    v_mul_f32 v46, v94, v103
    v_mul_f32 v47, v95, v103
    v_fmac_f32 v40, v89, v102
    v_fmac_f32 v41, v90, v102
    v_fmac_f32 v42, v91, v102
    v_fmac_f32 v43, v92, v102
    v_fmac_f32 v44, v93, v102
    v_fmac_f32 v45, v94, v102
    v_fmac_f32 v46, v95, v102
    v_fmac_f32 v47, v96, v102
    v_fmac_f32 v40, v90, v101
    v_fmac_f32 v41, v91, v101
    v_fmac_f32 v42, v92, v101
    v_fmac_f32 v43, v93, v101
    v_fmac_f32 v44, v94, v101
    v_fmac_f32 v45, v95, v101
    v_fmac_f32 v46, v96, v101
    v_fmac_f32 v47, v97, v101
    v_fmac_f32 v40, v91, v100
    v_fmac_f32 v41, v92, v100
    v_fmac_f32 v42, v93, v100
    v_fmac_f32 v43, v94, v100
    v_fmac_f32 v44, v95, v100
    v_fmac_f32 v45, v96, v100
    v_fmac_f32 v46, v97, v100
    v_fmac_f32 v47, v98, v100
    v_lshlrev_b32 v100, 16, v210
    v_and_b32 v101, 0xffff0000, v210
    v_lshlrev_b32 v102, 16, v211
    v_and_b32 v103, 0xffff0000, v211
    v_and_b32 v88, 0xffff0000, v129
    v_and_b32 v89, 0xffff0000, v133
    v_and_b32 v90, 0xffff0000, v137
    v_and_b32 v91, 0xffff0000, v141
    v_and_b32 v92, 0xffff0000, v145
    v_and_b32 v93, 0xffff0000, v149
    v_and_b32 v94, 0xffff0000, v153
    v_and_b32 v95, 0xffff0000, v157
    v_and_b32 v96, 0xffff0000, v161
    v_and_b32 v97, 0xffff0000, v165
    v_and_b32 v98, 0xffff0000, v169
    v_mul_f32 v48, v88, v103
    v_mul_f32 v49, v89, v103
    v_mul_f32 v50, v90, v103
    v_mul_f32 v51, v91, v103
    v_mul_f32 v52, v92, v103
    v_mul_f32 v53, v93, v103
    v_mul_f32 v54, v94, v103
    v_mul_f32 v55, v95, v103
    v_fmac_f32 v48, v89, v102
    v_fmac_f32 v49, v90, v102
    v_fmac_f32 v50, v91, v102
    v_fmac_f32 v51, v92, v102
    v_fmac_f32 v52, v93, v102
    v_fmac_f32 v53, v94, v102
    v_fmac_f32 v54, v95, v102
    v_fmac_f32 v55, v96, v102
    v_fmac_f32 v48, v90, v101
    v_fmac_f32 v49, v91, v101
    v_fmac_f32 v50, v92, v101
    v_fmac_f32 v51, v93, v101
    v_fmac_f32 v52, v94, v101
    v_fmac_f32 v53, v95, v101
    v_fmac_f32 v54, v96, v101
    v_fmac_f32 v55, v97, v101
    v_fmac_f32 v48, v91, v100
    v_fmac_f32 v49, v92, v100
    v_fmac_f32 v50, v93, v100
    v_fmac_f32 v51, v94, v100
    v_fmac_f32 v52, v95, v100
    v_fmac_f32 v53, v96, v100
    v_fmac_f32 v54, v97, v100
    v_fmac_f32 v55, v98, v100
    v_lshlrev_b32 v100, 16, v212
    v_and_b32 v101, 0xffff0000, v212
    v_lshlrev_b32 v102, 16, v213
    v_and_b32 v103, 0xffff0000, v213
    v_lshlrev_b32 v88, 16, v130
    v_lshlrev_b32 v89, 16, v134
    v_lshlrev_b32 v90, 16, v138
    v_lshlrev_b32 v91, 16, v142
    v_lshlrev_b32 v92, 16, v146
    v_lshlrev_b32 v93, 16, v150
    v_lshlrev_b32 v94, 16, v154
    v_lshlrev_b32 v95, 16, v158
    v_lshlrev_b32 v96, 16, v162
    v_lshlrev_b32 v97, 16, v166
    v_lshlrev_b32 v98, 16, v170
    v_mul_f32 v56, v88, v103
    v_mul_f32 v57, v89, v103
    v_mul_f32 v58, v90, v103
    v_mul_f32 v59, v91, v103
    v_mul_f32 v60, v92, v103
    v_mul_f32 v61, v93, v103
    v_mul_f32 v62, v94, v103
    v_mul_f32 v63, v95, v103
    v_fmac_f32 v56, v89, v102
    v_fmac_f32 v57, v90, v102
    v_fmac_f32 v58, v91, v102
    v_fmac_f32 v59, v92, v102
    v_fmac_f32 v60, v93, v102
    v_fmac_f32 v61, v94, v102
    v_fmac_f32 v62, v95, v102
    v_fmac_f32 v63, v96, v102
    v_fmac_f32 v56, v90, v101
    v_fmac_f32 v57, v91, v101
    v_fmac_f32 v58, v92, v101
    v_fmac_f32 v59, v93, v101
    v_fmac_f32 v60, v94, v101
    v_fmac_f32 v61, v95, v101
    v_fmac_f32 v62, v96, v101
    v_fmac_f32 v63, v97, v101
    v_fmac_f32 v56, v91, v100
    v_fmac_f32 v57, v92, v100
    v_fmac_f32 v58, v93, v100
    v_fmac_f32 v59, v94, v100
    v_fmac_f32 v60, v95, v100
    v_fmac_f32 v61, v96, v100
    v_fmac_f32 v62, v97, v100
    v_fmac_f32 v63, v98, v100
    v_lshlrev_b32 v100, 16, v214
    v_and_b32 v101, 0xffff0000, v214
    v_lshlrev_b32 v102, 16, v215
    v_and_b32 v103, 0xffff0000, v215
    v_and_b32 v88, 0xffff0000, v130
    v_and_b32 v89, 0xffff0000, v134
    v_and_b32 v90, 0xffff0000, v138
    v_and_b32 v91, 0xffff0000, v142
    v_and_b32 v92, 0xffff0000, v146
    v_and_b32 v93, 0xffff0000, v150
    v_and_b32 v94, 0xffff0000, v154
    v_and_b32 v95, 0xffff0000, v158
    v_and_b32 v96, 0xffff0000, v162
    v_and_b32 v97, 0xffff0000, v166
    v_and_b32 v98, 0xffff0000, v170
    v_mul_f32 v64, v88, v103
    v_mul_f32 v65, v89, v103
    v_mul_f32 v66, v90, v103
    v_mul_f32 v67, v91, v103
    v_mul_f32 v68, v92, v103
    v_mul_f32 v69, v93, v103
    v_mul_f32 v70, v94, v103
    v_mul_f32 v71, v95, v103
    v_fmac_f32 v64, v89, v102
    v_fmac_f32 v65, v90, v102
    v_fmac_f32 v66, v91, v102
    v_fmac_f32 v67, v92, v102
    v_fmac_f32 v68, v93, v102
    v_fmac_f32 v69, v94, v102
    v_fmac_f32 v70, v95, v102
    v_fmac_f32 v71, v96, v102
    v_fmac_f32 v64, v90, v101
    v_fmac_f32 v65, v91, v101
    v_fmac_f32 v66, v92, v101
    v_fmac_f32 v67, v93, v101
    v_fmac_f32 v68, v94, v101
    v_fmac_f32 v69, v95, v101
    v_fmac_f32 v70, v96, v101
    v_fmac_f32 v71, v97, v101
    v_fmac_f32 v64, v91, v100
    v_fmac_f32 v65, v92, v100
    v_fmac_f32 v66, v93, v100
    v_fmac_f32 v67, v94, v100
    v_fmac_f32 v68, v95, v100
    v_fmac_f32 v69, v96, v100
    v_fmac_f32 v70, v97, v100
    v_fmac_f32 v71, v98, v100
    v_lshlrev_b32 v100, 16, v216
    v_and_b32 v101, 0xffff0000, v216
    v_lshlrev_b32 v102, 16, v217
    v_and_b32 v103, 0xffff0000, v217
    v_lshlrev_b32 v88, 16, v131
    v_lshlrev_b32 v89, 16, v135
    v_lshlrev_b32 v90, 16, v139
    v_lshlrev_b32 v91, 16, v143
    v_lshlrev_b32 v92, 16, v147
    v_lshlrev_b32 v93, 16, v151
    v_lshlrev_b32 v94, 16, v155
    v_lshlrev_b32 v95, 16, v159
    v_lshlrev_b32 v96, 16, v163
    v_lshlrev_b32 v97, 16, v167
    v_lshlrev_b32 v98, 16, v171
    v_mul_f32 v72, v88, v103
    v_mul_f32 v73, v89, v103
    v_mul_f32 v74, v90, v103
    v_mul_f32 v75, v91, v103
    v_mul_f32 v76, v92, v103
    v_mul_f32 v77, v93, v103
    v_mul_f32 v78, v94, v103
    v_mul_f32 v79, v95, v103
    v_fmac_f32 v72, v89, v102
    v_fmac_f32 v73, v90, v102
    v_fmac_f32 v74, v91, v102
    v_fmac_f32 v75, v92, v102
    v_fmac_f32 v76, v93, v102
    v_fmac_f32 v77, v94, v102
    v_fmac_f32 v78, v95, v102
    v_fmac_f32 v79, v96, v102
    v_fmac_f32 v72, v90, v101
    v_fmac_f32 v73, v91, v101
    v_fmac_f32 v74, v92, v101
    v_fmac_f32 v75, v93, v101
    v_fmac_f32 v76, v94, v101
    v_fmac_f32 v77, v95, v101
    v_fmac_f32 v78, v96, v101
    v_fmac_f32 v79, v97, v101
    v_fmac_f32 v72, v91, v100
    v_fmac_f32 v73, v92, v100
    v_fmac_f32 v74, v93, v100
    v_fmac_f32 v75, v94, v100
    v_fmac_f32 v76, v95, v100
    v_fmac_f32 v77, v96, v100
    v_fmac_f32 v78, v97, v100
    v_fmac_f32 v79, v98, v100
    v_lshlrev_b32 v100, 16, v218
    v_and_b32 v101, 0xffff0000, v218
    v_lshlrev_b32 v102, 16, v219
    v_and_b32 v103, 0xffff0000, v219
    v_and_b32 v88, 0xffff0000, v131
    v_and_b32 v89, 0xffff0000, v135
    v_and_b32 v90, 0xffff0000, v139
    v_and_b32 v91, 0xffff0000, v143
    v_and_b32 v92, 0xffff0000, v147
    v_and_b32 v93, 0xffff0000, v151
    v_and_b32 v94, 0xffff0000, v155
    v_and_b32 v95, 0xffff0000, v159
    v_and_b32 v96, 0xffff0000, v163
    v_and_b32 v97, 0xffff0000, v167
    v_and_b32 v98, 0xffff0000, v171
    v_mul_f32 v80, v88, v103
    v_mul_f32 v81, v89, v103
    v_mul_f32 v82, v90, v103
    v_mul_f32 v83, v91, v103
    v_mul_f32 v84, v92, v103
    v_mul_f32 v85, v93, v103
    v_mul_f32 v86, v94, v103
    v_mul_f32 v87, v95, v103
    v_fmac_f32 v80, v89, v102
    v_fmac_f32 v81, v90, v102
    v_fmac_f32 v82, v91, v102
    v_fmac_f32 v83, v92, v102
    v_fmac_f32 v84, v93, v102
    v_fmac_f32 v85, v94, v102
    v_fmac_f32 v86, v95, v102
    v_fmac_f32 v87, v96, v102
    v_fmac_f32 v80, v90, v101
    v_fmac_f32 v81, v91, v101
    v_fmac_f32 v82, v92, v101
    v_fmac_f32 v83, v93, v101
    v_fmac_f32 v84, v94, v101
    v_fmac_f32 v85, v95, v101
    v_fmac_f32 v86, v96, v101
    v_fmac_f32 v87, v97, v101
    v_fmac_f32 v80, v91, v100
    v_fmac_f32 v81, v92, v100
    v_fmac_f32 v82, v93, v100
    v_fmac_f32 v83, v94, v100
    v_fmac_f32 v84, v95, v100
    v_fmac_f32 v85, v96, v100
    v_fmac_f32 v86, v97, v100
    v_fmac_f32 v87, v98, v100
    s_waitcnt vmcnt(0)
    v_lshlrev_b32 v88, 16, v172
    v_lshlrev_b32 v89, 16, v176
    v_lshlrev_b32 v90, 16, v180
    v_lshlrev_b32 v91, 16, v184
    v_lshlrev_b32 v92, 16, v188
    v_lshlrev_b32 v93, 16, v192
    v_lshlrev_b32 v94, 16, v196
    v_lshlrev_b32 v95, 16, v200
    v_mul_f32 v24, v24, v88
    v_mul_f32 v25, v25, v89
    v_mul_f32 v26, v26, v90
    v_mul_f32 v27, v27, v91
    v_mul_f32 v28, v28, v92
    v_mul_f32 v29, v29, v93
    v_mul_f32 v30, v30, v94
    v_mul_f32 v31, v31, v95
    v_cvt_pk_bf16_f32 v104, v31, v30
    v_cvt_pk_bf16_f32 v105, v29, v28
    v_cvt_pk_bf16_f32 v106, v27, v26
    v_cvt_pk_bf16_f32 v107, v25, v24
    ds_bpermute_b32 v128, v252, v104
    ds_bpermute_b32 v129, v252, v105
    ds_bpermute_b32 v130, v252, v106
    ds_bpermute_b32 v131, v252, v107
    v_and_b32 v88, 0xffff0000, v172
    v_and_b32 v89, 0xffff0000, v176
    v_and_b32 v90, 0xffff0000, v180
    v_and_b32 v91, 0xffff0000, v184
    v_and_b32 v92, 0xffff0000, v188
    v_and_b32 v93, 0xffff0000, v192
    v_and_b32 v94, 0xffff0000, v196
    v_and_b32 v95, 0xffff0000, v200
    v_mul_f32 v32, v32, v88
    v_mul_f32 v33, v33, v89
    v_mul_f32 v34, v34, v90
    v_mul_f32 v35, v35, v91
    v_mul_f32 v36, v36, v92
    v_mul_f32 v37, v37, v93
    v_mul_f32 v38, v38, v94
    v_mul_f32 v39, v39, v95
    v_cvt_pk_bf16_f32 v108, v39, v38
    v_cvt_pk_bf16_f32 v109, v37, v36
    v_cvt_pk_bf16_f32 v110, v35, v34
    v_cvt_pk_bf16_f32 v111, v33, v32
    s_waitcnt lgkmcnt(0)
    buffer_store_dwordx4 v[128:131], v253, s[8:11], s64 offen sc1
    s_add_u32 s64, s64, 4096
    ds_bpermute_b32 v132, v252, v108
    ds_bpermute_b32 v133, v252, v109
    ds_bpermute_b32 v134, v252, v110
    ds_bpermute_b32 v135, v252, v111
    v_lshlrev_b32 v88, 16, v173
    v_lshlrev_b32 v89, 16, v177
    v_lshlrev_b32 v90, 16, v181
    v_lshlrev_b32 v91, 16, v185
    v_lshlrev_b32 v92, 16, v189
    v_lshlrev_b32 v93, 16, v193
    v_lshlrev_b32 v94, 16, v197
    v_lshlrev_b32 v95, 16, v201
    v_mul_f32 v40, v40, v88
    v_mul_f32 v41, v41, v89
    v_mul_f32 v42, v42, v90
    v_mul_f32 v43, v43, v91
    v_mul_f32 v44, v44, v92
    v_mul_f32 v45, v45, v93
    v_mul_f32 v46, v46, v94
    v_mul_f32 v47, v47, v95
    v_cvt_pk_bf16_f32 v104, v47, v46
    v_cvt_pk_bf16_f32 v105, v45, v44
    v_cvt_pk_bf16_f32 v106, v43, v42
    v_cvt_pk_bf16_f32 v107, v41, v40
    s_waitcnt lgkmcnt(0)
    buffer_store_dwordx4 v[132:135], v253, s[8:11], s64 offen sc1
    s_add_u32 s64, s64, 4096
    ds_bpermute_b32 v136, v252, v104
    ds_bpermute_b32 v137, v252, v105
    ds_bpermute_b32 v138, v252, v106
    ds_bpermute_b32 v139, v252, v107
    v_and_b32 v88, 0xffff0000, v173
    v_and_b32 v89, 0xffff0000, v177
    v_and_b32 v90, 0xffff0000, v181
    v_and_b32 v91, 0xffff0000, v185
    v_and_b32 v92, 0xffff0000, v189
    v_and_b32 v93, 0xffff0000, v193
    v_and_b32 v94, 0xffff0000, v197
    v_and_b32 v95, 0xffff0000, v201
    v_mul_f32 v48, v48, v88
    v_mul_f32 v49, v49, v89
    v_mul_f32 v50, v50, v90
    v_mul_f32 v51, v51, v91
    v_mul_f32 v52, v52, v92
    v_mul_f32 v53, v53, v93
    v_mul_f32 v54, v54, v94
    v_mul_f32 v55, v55, v95
    v_cvt_pk_bf16_f32 v108, v55, v54
    v_cvt_pk_bf16_f32 v109, v53, v52
    v_cvt_pk_bf16_f32 v110, v51, v50
    v_cvt_pk_bf16_f32 v111, v49, v48
    s_waitcnt lgkmcnt(0)
    buffer_store_dwordx4 v[136:139], v253, s[8:11], s64 offen sc1
    s_add_u32 s64, s64, 4096
    ds_bpermute_b32 v140, v252, v108
    ds_bpermute_b32 v141, v252, v109
    ds_bpermute_b32 v142, v252, v110
    ds_bpermute_b32 v143, v252, v111
    v_lshlrev_b32 v88, 16, v174
    v_lshlrev_b32 v89, 16, v178
    v_lshlrev_b32 v90, 16, v182
    v_lshlrev_b32 v91, 16, v186
    v_lshlrev_b32 v92, 16, v190
    v_lshlrev_b32 v93, 16, v194
    v_lshlrev_b32 v94, 16, v198
    v_lshlrev_b32 v95, 16, v202
    v_mul_f32 v56, v56, v88
    v_mul_f32 v57, v57, v89
    v_mul_f32 v58, v58, v90
    v_mul_f32 v59, v59, v91
    v_mul_f32 v60, v60, v92
    v_mul_f32 v61, v61, v93
    v_mul_f32 v62, v62, v94
    v_mul_f32 v63, v63, v95
    v_cvt_pk_bf16_f32 v104, v63, v62
    v_cvt_pk_bf16_f32 v105, v61, v60
    v_cvt_pk_bf16_f32 v106, v59, v58
    v_cvt_pk_bf16_f32 v107, v57, v56
    s_waitcnt lgkmcnt(0)
    buffer_store_dwordx4 v[140:143], v253, s[8:11], s64 offen sc1
    s_add_u32 s64, s64, 4096
    ds_bpermute_b32 v144, v252, v104
    ds_bpermute_b32 v145, v252, v105
    ds_bpermute_b32 v146, v252, v106
    ds_bpermute_b32 v147, v252, v107
    v_and_b32 v88, 0xffff0000, v174
    v_and_b32 v89, 0xffff0000, v178
    v_and_b32 v90, 0xffff0000, v182
    v_and_b32 v91, 0xffff0000, v186
    v_and_b32 v92, 0xffff0000, v190
    v_and_b32 v93, 0xffff0000, v194
    v_and_b32 v94, 0xffff0000, v198
    v_and_b32 v95, 0xffff0000, v202
    v_mul_f32 v64, v64, v88
    v_mul_f32 v65, v65, v89
    v_mul_f32 v66, v66, v90
    v_mul_f32 v67, v67, v91
    v_mul_f32 v68, v68, v92
    v_mul_f32 v69, v69, v93
    v_mul_f32 v70, v70, v94
    v_mul_f32 v71, v71, v95
    v_cvt_pk_bf16_f32 v108, v71, v70
    v_cvt_pk_bf16_f32 v109, v69, v68
    v_cvt_pk_bf16_f32 v110, v67, v66
    v_cvt_pk_bf16_f32 v111, v65, v64
    s_waitcnt lgkmcnt(0)
    buffer_store_dwordx4 v[144:147], v253, s[8:11], s64 offen sc1
    s_add_u32 s64, s64, 4096
    ds_bpermute_b32 v148, v252, v108
    ds_bpermute_b32 v149, v252, v109
    ds_bpermute_b32 v150, v252, v110
    ds_bpermute_b32 v151, v252, v111
    v_lshlrev_b32 v88, 16, v175
    v_lshlrev_b32 v89, 16, v179
    v_lshlrev_b32 v90, 16, v183
    v_lshlrev_b32 v91, 16, v187
    v_lshlrev_b32 v92, 16, v191
    v_lshlrev_b32 v93, 16, v195
    v_lshlrev_b32 v94, 16, v199
    v_lshlrev_b32 v95, 16, v203
    v_mul_f32 v72, v72, v88
    v_mul_f32 v73, v73, v89
    v_mul_f32 v74, v74, v90
    v_mul_f32 v75, v75, v91
    v_mul_f32 v76, v76, v92
    v_mul_f32 v77, v77, v93
    v_mul_f32 v78, v78, v94
    v_mul_f32 v79, v79, v95
    v_cvt_pk_bf16_f32 v104, v79, v78
    v_cvt_pk_bf16_f32 v105, v77, v76
    v_cvt_pk_bf16_f32 v106, v75, v74
    v_cvt_pk_bf16_f32 v107, v73, v72
    s_waitcnt lgkmcnt(0)
    buffer_store_dwordx4 v[148:151], v253, s[8:11], s64 offen sc1
    s_add_u32 s64, s64, 4096
    ds_bpermute_b32 v152, v252, v104
    ds_bpermute_b32 v153, v252, v105
    ds_bpermute_b32 v154, v252, v106
    ds_bpermute_b32 v155, v252, v107
    v_and_b32 v88, 0xffff0000, v175
    v_and_b32 v89, 0xffff0000, v179
    v_and_b32 v90, 0xffff0000, v183
    v_and_b32 v91, 0xffff0000, v187
    v_and_b32 v92, 0xffff0000, v191
    v_and_b32 v93, 0xffff0000, v195
    v_and_b32 v94, 0xffff0000, v199
    v_and_b32 v95, 0xffff0000, v203
    v_mul_f32 v80, v80, v88
    v_mul_f32 v81, v81, v89
    v_mul_f32 v82, v82, v90
    v_mul_f32 v83, v83, v91
    v_mul_f32 v84, v84, v92
    v_mul_f32 v85, v85, v93
    v_mul_f32 v86, v86, v94
    v_mul_f32 v87, v87, v95
    v_cvt_pk_bf16_f32 v108, v87, v86
    v_cvt_pk_bf16_f32 v109, v85, v84
    v_cvt_pk_bf16_f32 v110, v83, v82
    v_cvt_pk_bf16_f32 v111, v81, v80
    s_waitcnt lgkmcnt(0)
    buffer_store_dwordx4 v[152:155], v253, s[8:11], s64 offen sc1
    s_add_u32 s64, s64, 4096
    ds_bpermute_b32 v156, v252, v108
    ds_bpermute_b32 v157, v252, v109
    ds_bpermute_b32 v158, v252, v110
    ds_bpermute_b32 v159, v252, v111
    s_waitcnt lgkmcnt(0)
    buffer_store_dwordx4 v[156:159], v253, s[8:11], s64 offen sc1
    s_add_u32 s64, s64, 4096
    s_mov_b32 s14, 1835008
    s_mov_b32 s15, 0x00020000
    s_mov_b32 s42, 2097152
    s_mov_b32 s43, 0x00020000
    s_add_u32 s0, s2, 32
    s_and_b32 s0, s0, 255
    s_lshr_b32 s55, s52, 6
    s_add_u32 s65, s3, 0
    s_and_b32 s65, s65, 3
    s_add_u32 s55, s55, s65
    s_xor_b32 s56, s56, 4
    v_min_u32 v12, 1, v0
    v_lshlrev_b32 v12, 30, v12
    s_and_b32 s68, s50, 1
    s_lshl_b32 s68, s68, 2
    s_mul_i32 s65, s68, 37
    s_lshr_b32 s65, s65, 8
    s_mul_i32 s65, s65, 7
    s_sub_u32 s68, s68, s65
    s_add_u32 s65, s51, 0
    s_and_b32 s65, s65, 3
    s_lshl_b32 s65, s65, 2
    s_add_u32 s65, s65, s48
    s_mul_i32 s66, s65, 37
    s_lshr_b32 s66, s66, 8
    s_mul_i32 s67, s66, 7
    s_sub_u32 s65, s65, s67
    s_add_u32 s65, s65, s68
    s_sub_u32 s67, s65, 7
    s_cmp_ge_u32 s65, 7
    s_cselect_b32 s65, s67, s65
    s_sub_u32 s66, s55, s66
    s_and_b32 s66, s66, 3
    s_mul_i32 s66, s66, 7
    s_add_u32 s57, s65, s66
    s_add_u32 s65, s51, 1
    s_and_b32 s65, s65, 3
    s_lshl_b32 s65, s65, 2
    s_add_u32 s65, s65, s48
    s_mul_i32 s66, s65, 37
    s_lshr_b32 s66, s66, 8
    s_mul_i32 s67, s66, 7
    s_sub_u32 s65, s65, s67
    s_add_u32 s65, s65, s68
    s_sub_u32 s67, s65, 7
    s_cmp_ge_u32 s65, 7
    s_cselect_b32 s65, s67, s65
    s_sub_u32 s66, s55, s66
    s_and_b32 s66, s66, 3
    s_mul_i32 s66, s66, 7
    s_add_u32 s58, s65, s66
    s_add_u32 s65, s51, 2
    s_and_b32 s65, s65, 3
    s_lshl_b32 s65, s65, 2
    s_add_u32 s65, s65, s48
    s_mul_i32 s66, s65, 37
    s_lshr_b32 s66, s66, 8
    s_mul_i32 s67, s66, 7
    s_sub_u32 s65, s65, s67
    s_add_u32 s65, s65, s68
    s_sub_u32 s67, s65, 7
    s_cmp_ge_u32 s65, 7
    s_cselect_b32 s65, s67, s65
    s_sub_u32 s66, s55, s66
    s_and_b32 s66, s66, 3
    s_mul_i32 s66, s66, 7
    s_add_u32 s59, s65, s66
    s_add_u32 s65, s51, 3
    s_and_b32 s65, s65, 3
    s_lshl_b32 s65, s65, 2
    s_add_u32 s65, s65, s48
    s_mul_i32 s66, s65, 37
    s_lshr_b32 s66, s66, 8
    s_mul_i32 s67, s66, 7
    s_sub_u32 s65, s65, s67
    s_add_u32 s65, s65, s68
    s_sub_u32 s67, s65, 7
    s_cmp_ge_u32 s65, 7
    s_cselect_b32 s65, s67, s65
    s_sub_u32 s66, s55, s66
    s_and_b32 s66, s66, 3
    s_mul_i32 s66, s66, 7
    s_add_u32 s60, s65, s66
    s_add_u32 s65, s48, 16
    s_mul_i32 s66, s65, 37
    s_lshr_b32 s66, s66, 8
    s_mul_i32 s67, s66, 7
    s_sub_u32 s65, s65, s67
    s_add_u32 s65, s65, s68
    s_sub_u32 s67, s65, 7
    s_cmp_ge_u32 s65, 7
    s_cselect_b32 s65, s67, s65
    s_sub_u32 s66, s55, s66
    s_and_b32 s66, s66, 3
    s_mul_i32 s66, s66, 7
    s_add_u32 s17, s65, s66
    s_add_u32 s65, s48, 20
    s_mul_i32 s66, s65, 37
    s_lshr_b32 s66, s66, 8
    s_mul_i32 s67, s66, 7
    s_sub_u32 s65, s65, s67
    s_add_u32 s65, s65, s68
    s_sub_u32 s67, s65, 7
    s_cmp_ge_u32 s65, 7
    s_cselect_b32 s65, s67, s65
    s_sub_u32 s66, s55, s66
    s_and_b32 s66, s66, 3
    s_mul_i32 s66, s66, 7
    s_add_u32 s18, s65, s66
    s_add_u32 s65, s48, 24
    s_mul_i32 s66, s65, 37
    s_lshr_b32 s66, s66, 8
    s_mul_i32 s67, s66, 7
    s_sub_u32 s65, s65, s67
    s_add_u32 s65, s65, s68
    s_sub_u32 s67, s65, 7
    s_cmp_ge_u32 s65, 7
    s_cselect_b32 s65, s67, s65
    s_sub_u32 s66, s55, s66
    s_and_b32 s66, s66, 3
    s_mul_i32 s66, s66, 7
    s_add_u32 s19, s65, s66
    s_lshl_b32 s65, s56, 7
    s_sub_u32 s65, s65, 8192
    s_lshl_b32 s20, s57, 16
    s_add_u32 s20, s20, s65
    s_lshl_b32 s21, s58, 16
    s_add_u32 s21, s21, s65
    s_lshl_b32 s22, s59, 16
    s_add_u32 s22, s22, s65
    s_lshl_b32 s23, s60, 16
    s_add_u32 s23, s23, s65
    s_lshl_b32 s24, s17, 16
    s_add_u32 s24, s24, s65
    s_lshl_b32 s25, s18, 16
    s_add_u32 s25, s25, s65
    s_lshl_b32 s26, s19, 16
    s_add_u32 s26, s26, s65
    s_mul_i32 s16, s48, 12288
    v_lshrrev_b32 v13, 3, v0
    v_bfe_u32 v14, v0, 4, 1
    v_lshlrev_b32 v14, 1, v14
    v_and_b32 v8, 7, v0
    v_xor_b32 v8, v8, v14
    v_lshlrev_b32 v8, 4, v8
    v_lshl_add_u32 v8, v13, 10, v8
    v_xor_b32 v6, 64, v8
    s_sub_u32 s65, s2, 224
    s_lshl_b32 s65, s65, 7
    s_lshl_b32 s66, s49, 12
    s_add_u32 s65, s65, s66
    s_add_u32 s65, s65, 65536
    s_waitcnt vmcnt(0)
    buffer_store_dword v11, v12, s[8:11], s65 offen sc1
    s_add_u32 m0, s16, 109568
    s_add_u32 s20, s20, 8192
    buffer_load_dwordx4 v8, s[12:15], s20 offen sc1 lds
    s_add_u32 m0, s16, 110592
    s_add_u32 s20, s20, 8192
    buffer_load_dwordx4 v6, s[12:15], s20 offen sc1 lds
    s_add_u32 m0, s16, 111616
    s_add_u32 s20, s20, 8192
    buffer_load_dwordx4 v8, s[12:15], s20 offen sc1 lds
    s_add_u32 m0, s16, 112640
    s_add_u32 s20, s20, 8192
    buffer_load_dwordx4 v6, s[12:15], s20 offen sc1 lds
    s_add_u32 m0, s16, 105472
    s_add_u32 s20, s20, 8192
    buffer_load_dwordx4 v8, s[12:15], s20 offen sc1 lds
    s_add_u32 m0, s16, 106496
    s_add_u32 s20, s20, 8192
    buffer_load_dwordx4 v6, s[12:15], s20 offen sc1 lds
    s_add_u32 m0, s16, 107520
    s_add_u32 s20, s20, 8192
    buffer_load_dwordx4 v8, s[12:15], s20 offen sc1 lds
    s_add_u32 m0, s16, 108544
    s_add_u32 s20, s20, 8192
    buffer_load_dwordx4 v6, s[12:15], s20 offen sc1 lds
    v_lshrrev_b32 v13, 4, v0
    v_lshlrev_b32 v9, 10, v13
    v_bfe_u32 v13, v0, 2, 2
    v_lshl_add_u32 v9, v13, 7, v9
    v_bfe_u32 v13, v0, 3, 2
    v_lshl_add_u32 v9, v13, 5, v9
    v_and_b32 v13, 3, v0
    v_lshl_add_u32 v9, v13, 3, v9
    s_add_u32 s65, s16, 101376
    v_add_u32 v9, s65, v9
    v_xor_b32 v10, 32, v9
    v_xor_b32 v2, 64, v9
    v_xor_b32 v3, 64, v10
    s_lshr_b32 s65, s48, 1
    s_mul_i32 s65, s65, 5120
    s_add_u32 m0, s65, 154624
    v_mov_b32 v16, 0x40000000
    buffer_load_dwordx4 v16, s[40:43], 0 offen lds
    s_add_u32 m0, s16, 101376
    s_add_u32 s21, s21, 8192
    buffer_load_dwordx4 v8, s[12:15], s21 offen sc1 lds
    s_add_u32 m0, s63, 33792
    s_add_u32 s24, s24, 8192
    buffer_load_dwordx4 v8, s[12:15], s24 offen sc1 lds
    s_add_u32 m0, s16, 102400
    s_add_u32 s21, s21, 8192
    buffer_load_dwordx4 v6, s[12:15], s21 offen sc1 lds
    s_add_u32 m0, s63, 34816
    s_add_u32 s24, s24, 8192
    buffer_load_dwordx4 v6, s[12:15], s24 offen sc1 lds
    s_add_u32 m0, s16, 103424
    s_add_u32 s21, s21, 8192
    buffer_load_dwordx4 v8, s[12:15], s21 offen sc1 lds
    s_add_u32 m0, s16, 104448
    s_add_u32 s21, s21, 8192
    buffer_load_dwordx4 v6, s[12:15], s21 offen sc1 lds
    s_add_u32 m0, s63, 35840
    s_add_u32 s24, s24, 8192
    buffer_load_dwordx4 v8, s[12:15], s24 offen sc1 lds
    s_add_u32 m0, s63, 36864
    s_add_u32 s24, s24, 8192
    buffer_load_dwordx4 v6, s[12:15], s24 offen sc1 lds
    s_lshr_b32 s65, s0, 5
    s_lshl_b32 s65, s65, 12
    s_andn2_b32 s66, 1, s48
    s_lshl_b32 s66, s66, 11
    s_add_u32 s65, s65, s66
    s_add_u32 s65, s65, 65536
    v_and_b32 v21, 15, v0
    v_lshlrev_b32 v21, 7, v21
    v_add_u32 v21, s65, v21
    buffer_load_dword v22, v21, s[8:11], 0 offen sc1
    s_waitcnt vmcnt(14)
    ds_read_b64_tr_b16 v[128:129], v9 offset:8192
    ds_read_b64_tr_b16 v[130:131], v9 offset:8704
    ds_read_b64_tr_b16 v[132:133], v10 offset:8192
    ds_read_b64_tr_b16 v[134:135], v10 offset:8704
    ds_read_b64_tr_b16 v[136:137], v2 offset:8192
    ds_read_b64_tr_b16 v[138:139], v2 offset:8704
    ds_read_b64_tr_b16 v[140:141], v3 offset:8192
    ds_read_b64_tr_b16 v[142:143], v3 offset:8704
    s_add_u32 m0, s63, 37888
    s_add_u32 s24, s24, 8192
    buffer_load_dwordx4 v8, s[12:15], s24 offen sc1 lds
    s_add_u32 m0, s63, 38912
    s_add_u32 s24, s24, 8192
    buffer_load_dwordx4 v6, s[12:15], s24 offen sc1 lds
    s_waitcnt lgkmcnt(0)
    s_add_u32 m0, s16, 109568
    s_add_u32 s21, s21, 8192
    buffer_load_dwordx4 v8, s[12:15], s21 offen sc1 lds
    s_add_u32 m0, s16, 110592
    s_add_u32 s21, s21, 8192
    buffer_load_dwordx4 v6, s[12:15], s21 offen sc1 lds
    s_add_u32 m0, s16, 111616
    s_add_u32 s21, s21, 8192
    buffer_load_dwordx4 v8, s[12:15], s21 offen sc1 lds
    s_add_u32 m0, s16, 112640
    s_add_u32 s21, s21, 8192
    buffer_load_dwordx4 v6, s[12:15], s21 offen sc1 lds
    s_waitcnt vmcnt(6)
    v_cmp_ne_u32 vcc, s47, v22
    s_cbranch_vccz L_ok_36
    s_mov_b32 s70, 0
L_poll_37:
    buffer_load_dword v22, v21, s[8:11], 0 offen sc1
    s_waitcnt vmcnt(0)
    v_cmp_ne_u32 vcc, s47, v22
    s_add_u32 s70, s70, 1
    s_cmp_gt_u32 s70, 40000
    s_cbranch_scc1 L_ok_36
    s_cbranch_vccnz L_poll_37
L_ok_36:
    s_lshl_b32 s65, s0, 13
    s_lshl_b32 s66, s48, 11
    s_add_u32 s65, s65, s66
    s_add_u32 s65, s65, 1048576
    s_lshr_b32 s67, s48, 1
    s_lshl_b32 s67, s67, 10
    s_add_u32 s66, s66, s67
    s_add_u32 m0, s66, 150528
    s_nop 0
    buffer_load_dwordx4 v5, s[8:11], s65 offen offset:0 sc1 lds
    buffer_load_dwordx4 v5, s[8:11], s65 offen offset:1024 sc1 lds
    ds_read_b64_tr_b16 v[144:145], v9 offset:4096
    ds_read_b64_tr_b16 v[146:147], v9 offset:4608
    ds_read_b64_tr_b16 v[148:149], v10 offset:4096
    ds_read_b64_tr_b16 v[150:151], v10 offset:4608
    ds_read_b64_tr_b16 v[152:153], v2 offset:4096
    ds_read_b64_tr_b16 v[154:155], v2 offset:4608
    ds_read_b64_tr_b16 v[156:157], v3 offset:4096
    ds_read_b64_tr_b16 v[158:159], v3 offset:4608
    s_add_u32 m0, s63, 39936
    s_add_u32 s24, s24, 8192
    buffer_load_dwordx4 v8, s[12:15], s24 offen sc1 lds
    s_add_u32 m0, s63, 40960
    s_add_u32 s24, s24, 8192
    buffer_load_dwordx4 v6, s[12:15], s24 offen sc1 lds
    s_waitcnt lgkmcnt(0)
    s_add_u32 m0, s16, 105472
    s_add_u32 s22, s22, 8192
    buffer_load_dwordx4 v8, s[12:15], s22 offen sc1 lds
    s_add_u32 m0, s16, 106496
    s_add_u32 s22, s22, 8192
    buffer_load_dwordx4 v6, s[12:15], s22 offen sc1 lds
    s_add_u32 m0, s16, 107520
    s_add_u32 s22, s22, 8192
    buffer_load_dwordx4 v8, s[12:15], s22 offen sc1 lds
    s_add_u32 m0, s16, 108544
    s_add_u32 s22, s22, 8192
    buffer_load_dwordx4 v6, s[12:15], s22 offen sc1 lds
    s_waitcnt vmcnt(6)
    s_barrier
    ds_read_b64_tr_b16 v[160:161], v9 offset:0
    ds_read_b64_tr_b16 v[162:163], v9 offset:512
    ds_read_b64_tr_b16 v[164:165], v10 offset:0
    ds_read_b64_tr_b16 v[166:167], v10 offset:512
    ds_read_b64_tr_b16 v[168:169], v2 offset:0
    ds_read_b64_tr_b16 v[170:171], v2 offset:512
    ds_read_b64_tr_b16 v[172:173], v3 offset:0
    ds_read_b64_tr_b16 v[174:175], v3 offset:512
    s_add_u32 m0, s63, 67584
    s_add_u32 s25, s25, 8192
    buffer_load_dwordx4 v8, s[12:15], s25 offen sc1 lds
    s_add_u32 m0, s63, 68608
    s_add_u32 s25, s25, 8192
    buffer_load_dwordx4 v6, s[12:15], s25 offen sc1 lds
    s_waitcnt lgkmcnt(0)
    s_add_u32 m0, s16, 101376
    s_add_u32 s22, s22, 8192
    buffer_load_dwordx4 v8, s[12:15], s22 offen sc1 lds
    s_add_u32 m0, s16, 102400
    s_add_u32 s22, s22, 8192
    buffer_load_dwordx4 v6, s[12:15], s22 offen sc1 lds
    s_add_u32 m0, s16, 103424
    s_add_u32 s22, s22, 8192
    buffer_load_dwordx4 v8, s[12:15], s22 offen sc1 lds
    s_add_u32 m0, s16, 104448
    s_add_u32 s22, s22, 8192
    buffer_load_dwordx4 v6, s[12:15], s22 offen sc1 lds
    ds_read_b64_tr_b16 v[176:177], v9 offset:8192
    ds_read_b64_tr_b16 v[178:179], v9 offset:8704
    ds_read_b64_tr_b16 v[180:181], v10 offset:8192
    ds_read_b64_tr_b16 v[182:183], v10 offset:8704
    ds_read_b64_tr_b16 v[184:185], v2 offset:8192
    ds_read_b64_tr_b16 v[186:187], v2 offset:8704
    ds_read_b64_tr_b16 v[188:189], v3 offset:8192
    ds_read_b64_tr_b16 v[190:191], v3 offset:8704
    s_add_u32 m0, s63, 69632
    s_add_u32 s25, s25, 8192
    buffer_load_dwordx4 v8, s[12:15], s25 offen sc1 lds
    s_add_u32 m0, s63, 70656
    s_add_u32 s25, s25, 8192
    buffer_load_dwordx4 v6, s[12:15], s25 offen sc1 lds
    s_waitcnt lgkmcnt(0)
    s_add_u32 m0, s16, 109568
    s_add_u32 s23, s23, 8192
    buffer_load_dwordx4 v8, s[12:15], s23 offen sc1 lds
    s_add_u32 m0, s16, 110592
    s_add_u32 s23, s23, 8192
    buffer_load_dwordx4 v6, s[12:15], s23 offen sc1 lds
    s_add_u32 m0, s16, 111616
    s_add_u32 s23, s23, 8192
    buffer_load_dwordx4 v8, s[12:15], s23 offen sc1 lds
    s_add_u32 m0, s16, 112640
    s_add_u32 s23, s23, 8192
    buffer_load_dwordx4 v6, s[12:15], s23 offen sc1 lds
    s_mul_i32 s46, s55, 7168
    s_add_u32 s46, s46, 262144
    s_lshl_b32 s65, s57, 7
    s_add_u32 s65, s65, s46
    s_load_dword s28, s[8:9], s65 glc
    s_lshl_b32 s65, s58, 7
    s_add_u32 s65, s65, s46
    s_load_dword s29, s[8:9], s65 glc
    s_lshl_b32 s65, s59, 7
    s_add_u32 s65, s65, s46
    s_load_dword s30, s[8:9], s65 glc
    s_waitcnt vmcnt(12)
    ds_read_b64_tr_b16 v[192:193], v9 offset:4096
    ds_read_b64_tr_b16 v[194:195], v9 offset:4608
    ds_read_b64_tr_b16 v[196:197], v10 offset:4096
    ds_read_b64_tr_b16 v[198:199], v10 offset:4608
    ds_read_b64_tr_b16 v[200:201], v2 offset:4096
    ds_read_b64_tr_b16 v[202:203], v2 offset:4608
    ds_read_b64_tr_b16 v[204:205], v3 offset:4096
    ds_read_b64_tr_b16 v[206:207], v3 offset:4608
    s_add_u32 m0, s63, 71680
    s_add_u32 s25, s25, 8192
    buffer_load_dwordx4 v8, s[12:15], s25 offen sc1 lds
    s_add_u32 m0, s63, 72704
    s_add_u32 s25, s25, 8192
    buffer_load_dwordx4 v6, s[12:15], s25 offen sc1 lds
    s_waitcnt lgkmcnt(0)
    s_add_u32 m0, s16, 105472
    s_add_u32 s23, s23, 8192
    buffer_load_dwordx4 v8, s[12:15], s23 offen sc1 lds
    s_add_u32 m0, s16, 106496
    s_add_u32 s23, s23, 8192
    buffer_load_dwordx4 v6, s[12:15], s23 offen sc1 lds
    s_add_u32 m0, s16, 107520
    s_add_u32 s23, s23, 8192
    buffer_load_dwordx4 v8, s[12:15], s23 offen sc1 lds
    s_add_u32 m0, s16, 108544
    s_add_u32 s23, s23, 8192
    buffer_load_dwordx4 v6, s[12:15], s23 offen sc1 lds
    s_add_u32 m0, s63, 73728
    s_add_u32 s25, s25, 8192
    buffer_load_dwordx4 v8, s[12:15], s25 offen sc1 lds
    s_add_u32 m0, s63, 74752
    s_add_u32 s25, s25, 8192
    buffer_load_dwordx4 v6, s[12:15], s25 offen sc1 lds
    s_mul_i32 s1, s55, 229376
    s_add_u32 s1, s1, 5242880
    v_and_b32 v4, 48, v0
    v_add_lshl_u32 v4, v4, v0, 4
    s_mov_b32 s70, 0
L_schk_38:
    s_waitcnt lgkmcnt(0)
    s_cmp_lg_u32 s28, s47
    s_cbranch_scc1 L_sp_39
    s_cmp_lg_u32 s29, s47
    s_cbranch_scc1 L_sp_39
    s_cmp_eq_u32 s30, s47
    s_cbranch_scc1 L_ok_40
L_sp_39:
    s_add_u32 s70, s70, 1
    s_cmp_gt_u32 s70, 40000
    s_cbranch_scc1 L_ok_40
    s_lshl_b32 s65, s57, 7
    s_add_u32 s65, s65, s46
    s_load_dword s28, s[8:9], s65 glc
    s_lshl_b32 s65, s58, 7
    s_add_u32 s65, s65, s46
    s_load_dword s29, s[8:9], s65 glc
    s_lshl_b32 s65, s59, 7
    s_add_u32 s65, s65, s46
    s_load_dword s30, s[8:9], s65 glc
    s_branch L_schk_38
L_ok_40:
    s_waitcnt vmcnt(14)
    ds_read_b64_tr_b16 v[208:209], v9 offset:0
    ds_read_b64_tr_b16 v[210:211], v9 offset:512
    ds_read_b64_tr_b16 v[212:213], v10 offset:0
    ds_read_b64_tr_b16 v[214:215], v10 offset:512
    ds_read_b64_tr_b16 v[216:217], v2 offset:0
    ds_read_b64_tr_b16 v[218:219], v2 offset:512
    ds_read_b64_tr_b16 v[220:221], v3 offset:0
    ds_read_b64_tr_b16 v[222:223], v3 offset:512
    s_lshl_b32 s65, s57, 12
    s_add_u32 s67, s65, s1
    buffer_load_dwordx4 v[24:27], v4, s[8:11], s67 offen offset:0 sc1
    buffer_load_dwordx4 v[28:31], v4, s[8:11], s67 offen offset:2048 sc1
    s_waitcnt lgkmcnt(0)
    s_waitcnt vmcnt(10)
    ds_read_b64_tr_b16 v[224:225], v9 offset:8192
    ds_read_b64_tr_b16 v[226:227], v9 offset:8704
    ds_read_b64_tr_b16 v[228:229], v10 offset:8192
    ds_read_b64_tr_b16 v[230:231], v10 offset:8704
    ds_read_b64_tr_b16 v[232:233], v2 offset:8192
    ds_read_b64_tr_b16 v[234:235], v2 offset:8704
    ds_read_b64_tr_b16 v[236:237], v3 offset:8192
    ds_read_b64_tr_b16 v[238:239], v3 offset:8704
    buffer_load_dwordx4 v[32:35], v4, s[8:11], s67 offen offset:256 sc1
    buffer_load_dwordx4 v[36:39], v4, s[8:11], s67 offen offset:2304 sc1
    s_waitcnt lgkmcnt(0)
    s_waitcnt vmcnt(6)
    ds_read_b64_tr_b16 v[240:241], v9 offset:4096
    ds_read_b64_tr_b16 v[242:243], v9 offset:4608
    ds_read_b64_tr_b16 v[244:245], v10 offset:4096
    ds_read_b64_tr_b16 v[246:247], v10 offset:4608
    ds_read_b64_tr_b16 v[248:249], v2 offset:4096
    ds_read_b64_tr_b16 v[250:251], v2 offset:4608
    ds_read_b64_tr_b16 v[252:253], v3 offset:4096
    ds_read_b64_tr_b16 v[254:255], v3 offset:4608
    s_lshl_b32 s65, s58, 12
    s_add_u32 s67, s65, s1
    buffer_load_dwordx4 v[40:43], v4, s[8:11], s67 offen offset:0 sc1
    buffer_load_dwordx4 v[44:47], v4, s[8:11], s67 offen offset:2048 sc1
    s_waitcnt lgkmcnt(0)
    s_add_u32 m0, s16, 101376
    s_add_u32 s26, s26, 8192
    buffer_load_dwordx4 v8, s[12:15], s26 offen sc1 lds
    buffer_load_dwordx4 v[48:51], v4, s[8:11], s67 offen offset:256 sc1
    s_add_u32 m0, s16, 102400
    s_add_u32 s26, s26, 8192
    buffer_load_dwordx4 v6, s[12:15], s26 offen sc1 lds
    buffer_load_dwordx4 v[52:55], v4, s[8:11], s67 offen offset:2304 sc1
    s_add_u32 m0, s16, 103424
    s_add_u32 s26, s26, 8192
    buffer_load_dwordx4 v8, s[12:15], s26 offen sc1 lds
    s_lshl_b32 s65, s59, 12
    s_add_u32 s67, s65, s1
    buffer_load_dwordx4 v[56:59], v4, s[8:11], s67 offen offset:0 sc1
    s_lshl_b32 s65, s60, 7
    s_add_u32 s65, s65, s46
    s_load_dword s28, s[8:9], s65 glc
    s_lshl_b32 s65, s57, 7
    s_add_u32 s65, s65, s46
    s_add_u32 s65, s65, 3584
    s_load_dword s29, s[8:9], s65 glc
    s_lshl_b32 s65, s58, 7
    s_add_u32 s65, s65, s46
    s_add_u32 s65, s65, 3584
    s_load_dword s30, s[8:9], s65 glc
    s_lshl_b32 s65, s59, 7
    s_add_u32 s65, s65, s46
    s_add_u32 s65, s65, 3584
    s_load_dword s31, s[8:9], s65 glc
    s_lshl_b32 s65, s17, 7
    s_add_u32 s65, s65, s46
    s_load_dword s32, s[8:9], s65 glc
    s_lshl_b32 s65, s60, 7
    s_add_u32 s65, s65, s46
    s_add_u32 s65, s65, 3584
    s_load_dword s33, s[8:9], s65 glc
    s_lshl_b32 s65, s17, 7
    s_add_u32 s65, s65, s46
    s_add_u32 s65, s65, 3584
    s_load_dword s34, s[8:9], s65 glc
    s_add_u32 m0, s16, 104448
    s_add_u32 s26, s26, 8192
    buffer_load_dwordx4 v6, s[12:15], s26 offen sc1 lds
    buffer_load_dwordx4 v[60:63], v4, s[8:11], s67 offen offset:2048 sc1
    s_add_u32 m0, s16, 105472
    s_add_u32 s26, s26, 8192
    buffer_load_dwordx4 v8, s[12:15], s26 offen sc1 lds
    buffer_load_dwordx4 v[96:99], v4, s[8:11], s67 offen offset:256 sc1
    s_add_u32 m0, s16, 106496
    s_add_u32 s26, s26, 8192
    buffer_load_dwordx4 v6, s[12:15], s26 offen sc1 lds
    buffer_load_dwordx4 v[100:103], v4, s[8:11], s67 offen offset:2304 sc1
    s_add_u32 m0, s16, 107520
    s_add_u32 s26, s26, 8192
    buffer_load_dwordx4 v8, s[12:15], s26 offen sc1 lds
    s_add_u32 m0, s16, 108544
    s_add_u32 s26, s26, 8192
    buffer_load_dwordx4 v6, s[12:15], s26 offen sc1 lds
    s_mov_b32 s70, 0
L_schk_41:
    s_waitcnt lgkmcnt(0)
    s_cmp_lg_u32 s28, s47
    s_cbranch_scc1 L_sp_42
    s_cmp_lg_u32 s29, s47
    s_cbranch_scc1 L_sp_42
    s_cmp_lg_u32 s30, s47
    s_cbranch_scc1 L_sp_42
    s_cmp_lg_u32 s31, s47
    s_cbranch_scc1 L_sp_42
    s_cmp_lg_u32 s32, s47
    s_cbranch_scc1 L_sp_42
    s_cmp_lg_u32 s33, s47
    s_cbranch_scc1 L_sp_42
    s_cmp_eq_u32 s34, s47
    s_cbranch_scc1 L_ok_43
L_sp_42:
    s_add_u32 s70, s70, 1
    s_cmp_gt_u32 s70, 40000
    s_cbranch_scc1 L_ok_43
    s_lshl_b32 s65, s60, 7
    s_add_u32 s65, s65, s46
    s_load_dword s28, s[8:9], s65 glc
    s_lshl_b32 s65, s57, 7
    s_add_u32 s65, s65, s46
    s_add_u32 s65, s65, 3584
    s_load_dword s29, s[8:9], s65 glc
    s_lshl_b32 s65, s58, 7
    s_add_u32 s65, s65, s46
    s_add_u32 s65, s65, 3584
    s_load_dword s30, s[8:9], s65 glc
    s_lshl_b32 s65, s59, 7
    s_add_u32 s65, s65, s46
    s_add_u32 s65, s65, 3584
    s_load_dword s31, s[8:9], s65 glc
    s_lshl_b32 s65, s17, 7
    s_add_u32 s65, s65, s46
    s_load_dword s32, s[8:9], s65 glc
    s_lshl_b32 s65, s60, 7
    s_add_u32 s65, s65, s46
    s_add_u32 s65, s65, 3584
    s_load_dword s33, s[8:9], s65 glc
    s_lshl_b32 s65, s17, 7
    s_add_u32 s65, s65, s46
    s_add_u32 s65, s65, 3584
    s_load_dword s34, s[8:9], s65 glc
    s_branch L_schk_41
L_ok_43:
    s_lshl_b32 s65, s60, 12
    s_add_u32 s67, s65, s1
    buffer_load_dwordx4 v[104:107], v4, s[8:11], s67 offen offset:0 sc1
    buffer_load_dwordx4 v[108:111], v4, s[8:11], s67 offen offset:2048 sc1
    buffer_load_dwordx4 v[112:115], v4, s[8:11], s67 offen offset:256 sc1
    buffer_load_dwordx4 v[116:119], v4, s[8:11], s67 offen offset:2304 sc1
    s_lshl_b32 s65, s57, 12
    s_add_u32 s67, s65, s1
    s_add_u32 s67, s67, 114688
    buffer_load_dwordx4 v[120:123], v4, s[8:11], s67 offen offset:0 sc1
    buffer_load_dwordx4 v[124:127], v4, s[8:11], s67 offen offset:2048 sc1
    buffer_load_dwordx4 v[12:15], v4, s[8:11], s67 offen offset:256 sc1
    buffer_load_dwordx4 v[16:19], v4, s[8:11], s67 offen offset:2304 sc1
    v_and_b32 v20, 15, v0
    v_lshlrev_b32 v20, 8, v20
    v_add_u32 v20, s63, v20
    v_lshrrev_b32 v21, 4, v0
    v_and_b32 v22, 7, v0
    v_xor_b32 v21, v21, v22
    v_lshl_add_u32 v7, v21, 4, v20
    v_add_u32 v7, 33792, v7
    v_xor_b32 v11, 64, v7
    s_lshl_b32 s65, s48, 2
    s_add_u32 s65, s65, 155136
    v_mov_b32 v0, s65
    v_mov_b32 v5, 1
    s_setprio 1
    s_waitcnt vmcnt(26)
    v_mfma_f32_16x16x32_bf16 v[64:67], v[128:131], v[24:27], 0
    v_mfma_f32_16x16x32_bf16 v[64:67], v[144:147], v[28:31], v[64:67]
    v_mfma_f32_16x16x32_bf16 v[68:71], v[148:151], v[28:31], 0
    v_mfma_f32_16x16x32_bf16 v[68:71], v[132:135], v[24:27], v[68:71]
    v_mfma_f32_16x16x32_bf16 v[72:75], v[136:139], v[24:27], 0
    v_mfma_f32_16x16x32_bf16 v[72:75], v[152:155], v[28:31], v[72:75]
    v_mfma_f32_16x16x32_bf16 v[76:79], v[156:159], v[28:31], 0
    v_mfma_f32_16x16x32_bf16 v[76:79], v[140:143], v[24:27], v[76:79]
    s_waitcnt vmcnt(24)
    v_mfma_f32_16x16x32_bf16 v[80:83], v[128:131], v[32:35], 0
    v_mfma_f32_16x16x32_bf16 v[80:83], v[144:147], v[36:39], v[80:83]
    v_mfma_f32_16x16x32_bf16 v[84:87], v[148:151], v[36:39], 0
    v_mfma_f32_16x16x32_bf16 v[84:87], v[132:135], v[32:35], v[84:87]
    v_mfma_f32_16x16x32_bf16 v[88:91], v[136:139], v[32:35], 0
    v_mfma_f32_16x16x32_bf16 v[88:91], v[152:155], v[36:39], v[88:91]
    v_mfma_f32_16x16x32_bf16 v[92:95], v[156:159], v[36:39], 0
    v_mfma_f32_16x16x32_bf16 v[92:95], v[140:143], v[32:35], v[92:95]
    s_waitcnt vmcnt(22)
    v_mfma_f32_16x16x32_bf16 v[64:67], v[160:163], v[40:43], v[64:67]
    s_lshl_b32 s65, s18, 7
    s_add_u32 s65, s65, s46
    s_load_dwordx4 s[28:31], s[8:9], s65 glc
    s_lshl_b32 s65, s19, 7
    s_add_u32 s65, s65, s46
    s_load_dwordx4 s[32:35], s[8:9], s65 glc
    v_mfma_f32_16x16x32_bf16 v[64:67], v[176:179], v[44:47], v[64:67]
    v_mfma_f32_16x16x32_bf16 v[68:71], v[180:183], v[44:47], v[68:71]
    v_mfma_f32_16x16x32_bf16 v[68:71], v[164:167], v[40:43], v[68:71]
    v_mfma_f32_16x16x32_bf16 v[72:75], v[168:171], v[40:43], v[72:75]
    v_mfma_f32_16x16x32_bf16 v[72:75], v[184:187], v[44:47], v[72:75]
    v_mfma_f32_16x16x32_bf16 v[76:79], v[188:191], v[44:47], v[76:79]
    v_mfma_f32_16x16x32_bf16 v[76:79], v[172:175], v[40:43], v[76:79]
    s_waitcnt vmcnt(18)
    v_mfma_f32_16x16x32_bf16 v[80:83], v[160:163], v[48:51], v[80:83]
    s_lshl_b32 s65, s58, 12
    s_add_u32 s67, s65, s1
    s_add_u32 s67, s67, 114688
    buffer_load_dwordx4 v[24:27], v4, s[8:11], s67 offen offset:0 sc1
    v_mfma_f32_16x16x32_bf16 v[80:83], v[176:179], v[52:55], v[80:83]
    buffer_load_dwordx4 v[28:31], v4, s[8:11], s67 offen offset:2048 sc1
    v_mfma_f32_16x16x32_bf16 v[84:87], v[180:183], v[52:55], v[84:87]
    v_mfma_f32_16x16x32_bf16 v[84:87], v[164:167], v[48:51], v[84:87]
    v_mfma_f32_16x16x32_bf16 v[88:91], v[168:171], v[48:51], v[88:91]
    v_mfma_f32_16x16x32_bf16 v[88:91], v[184:187], v[52:55], v[88:91]
    v_mfma_f32_16x16x32_bf16 v[92:95], v[188:191], v[52:55], v[92:95]
    v_mfma_f32_16x16x32_bf16 v[92:95], v[172:175], v[48:51], v[92:95]
    s_waitcnt vmcnt(16)
    v_mfma_f32_16x16x32_bf16 v[64:67], v[192:195], v[56:59], v[64:67]
    buffer_load_dwordx4 v[32:35], v4, s[8:11], s67 offen offset:256 sc1
    v_mfma_f32_16x16x32_bf16 v[64:67], v[208:211], v[60:63], v[64:67]
    buffer_load_dwordx4 v[36:39], v4, s[8:11], s67 offen offset:2304 sc1
    v_mfma_f32_16x16x32_bf16 v[68:71], v[212:215], v[60:63], v[68:71]
    v_mfma_f32_16x16x32_bf16 v[68:71], v[196:199], v[56:59], v[68:71]
    v_mfma_f32_16x16x32_bf16 v[72:75], v[200:203], v[56:59], v[72:75]
    v_mfma_f32_16x16x32_bf16 v[72:75], v[216:219], v[60:63], v[72:75]
    v_mfma_f32_16x16x32_bf16 v[76:79], v[220:223], v[60:63], v[76:79]
    v_mfma_f32_16x16x32_bf16 v[76:79], v[204:207], v[56:59], v[76:79]
    s_waitcnt vmcnt(14)
    v_mfma_f32_16x16x32_bf16 v[80:83], v[192:195], v[96:99], v[80:83]
    s_lshl_b32 s65, s59, 12
    s_add_u32 s67, s65, s1
    s_add_u32 s67, s67, 114688
    buffer_load_dwordx4 v[40:43], v4, s[8:11], s67 offen offset:0 sc1
    v_mfma_f32_16x16x32_bf16 v[80:83], v[208:211], v[100:103], v[80:83]
    buffer_load_dwordx4 v[44:47], v4, s[8:11], s67 offen offset:2048 sc1
    v_mfma_f32_16x16x32_bf16 v[84:87], v[212:215], v[100:103], v[84:87]
    v_mfma_f32_16x16x32_bf16 v[84:87], v[196:199], v[96:99], v[84:87]
    v_mfma_f32_16x16x32_bf16 v[88:91], v[200:203], v[96:99], v[88:91]
    v_mfma_f32_16x16x32_bf16 v[88:91], v[216:219], v[100:103], v[88:91]
    v_mfma_f32_16x16x32_bf16 v[92:95], v[220:223], v[100:103], v[92:95]
    v_mfma_f32_16x16x32_bf16 v[92:95], v[204:207], v[96:99], v[92:95]
    s_waitcnt vmcnt(12)
    v_mfma_f32_16x16x32_bf16 v[64:67], v[224:227], v[104:107], v[64:67]
    buffer_load_dwordx4 v[48:51], v4, s[8:11], s67 offen offset:256 sc1
    v_mfma_f32_16x16x32_bf16 v[64:67], v[240:243], v[108:111], v[64:67]
    buffer_load_dwordx4 v[52:55], v4, s[8:11], s67 offen offset:2304 sc1
    v_mfma_f32_16x16x32_bf16 v[68:71], v[244:247], v[108:111], v[68:71]
    v_mfma_f32_16x16x32_bf16 v[68:71], v[228:231], v[104:107], v[68:71]
    v_mfma_f32_16x16x32_bf16 v[72:75], v[232:235], v[104:107], v[72:75]
    v_mfma_f32_16x16x32_bf16 v[72:75], v[248:251], v[108:111], v[72:75]
    v_mfma_f32_16x16x32_bf16 v[76:79], v[252:255], v[108:111], v[76:79]
    v_mfma_f32_16x16x32_bf16 v[76:79], v[236:239], v[104:107], v[76:79]
    s_waitcnt vmcnt(12)
    v_mfma_f32_16x16x32_bf16 v[80:83], v[224:227], v[112:115], v[80:83]
    s_lshl_b32 s65, s17, 12
    s_add_u32 s67, s65, s1
    buffer_load_dwordx4 v[56:59], v4, s[8:11], s67 offen offset:0 sc1
    v_mfma_f32_16x16x32_bf16 v[80:83], v[240:243], v[116:119], v[80:83]
    buffer_load_dwordx4 v[60:63], v4, s[8:11], s67 offen offset:2048 sc1
    v_mfma_f32_16x16x32_bf16 v[84:87], v[244:247], v[116:119], v[84:87]
    v_mfma_f32_16x16x32_bf16 v[84:87], v[228:231], v[112:115], v[84:87]
    v_mfma_f32_16x16x32_bf16 v[88:91], v[232:235], v[112:115], v[88:91]
    v_mfma_f32_16x16x32_bf16 v[88:91], v[248:251], v[116:119], v[88:91]
    v_mfma_f32_16x16x32_bf16 v[92:95], v[252:255], v[116:119], v[92:95]
    v_mfma_f32_16x16x32_bf16 v[92:95], v[236:239], v[112:115], v[92:95]
    s_waitcnt vmcnt(12)
    v_mfma_f32_16x16x32_bf16 v[96:99], v[128:131], v[120:123], 0
    v_mfma_f32_16x16x32_bf16 v[96:99], v[144:147], v[124:127], v[96:99]
    v_mfma_f32_16x16x32_bf16 v[100:103], v[148:151], v[124:127], 0
    v_mfma_f32_16x16x32_bf16 v[100:103], v[132:135], v[120:123], v[100:103]
    v_mfma_f32_16x16x32_bf16 v[104:107], v[136:139], v[120:123], 0
    v_mfma_f32_16x16x32_bf16 v[104:107], v[152:155], v[124:127], v[104:107]
    v_mfma_f32_16x16x32_bf16 v[108:111], v[156:159], v[124:127], 0
    v_mfma_f32_16x16x32_bf16 v[108:111], v[140:143], v[120:123], v[108:111]
    s_waitcnt vmcnt(10)
    v_mfma_f32_16x16x32_bf16 v[112:115], v[128:131], v[12:15], 0
    s_mov_b32 s70, 0
L_schk_44:
    s_waitcnt lgkmcnt(0)
    s_cmp_lg_u32 s28, s47
    s_cbranch_scc1 L_sp_45
    s_cmp_lg_u32 s29, s47
    s_cbranch_scc1 L_sp_45
    s_cmp_lg_u32 s30, s47
    s_cbranch_scc1 L_sp_45
    s_cmp_lg_u32 s31, s47
    s_cbranch_scc1 L_sp_45
    s_cmp_lg_u32 s32, s47
    s_cbranch_scc1 L_sp_45
    s_cmp_lg_u32 s33, s47
    s_cbranch_scc1 L_sp_45
    s_cmp_lg_u32 s34, s47
    s_cbranch_scc1 L_sp_45
    s_cmp_eq_u32 s35, s47
    s_cbranch_scc1 L_ok_46
L_sp_45:
    s_add_u32 s70, s70, 1
    s_cmp_gt_u32 s70, 40000
    s_cbranch_scc1 L_ok_46
    s_lshl_b32 s65, s18, 7
    s_add_u32 s65, s65, s46
    s_load_dwordx4 s[28:31], s[8:9], s65 glc
    s_lshl_b32 s65, s19, 7
    s_add_u32 s65, s65, s46
    s_load_dwordx4 s[32:35], s[8:9], s65 glc
    s_branch L_schk_44
L_ok_46:
    v_mfma_f32_16x16x32_bf16 v[112:115], v[144:147], v[16:19], v[112:115]
    v_mfma_f32_16x16x32_bf16 v[116:119], v[148:151], v[16:19], 0
    v_mfma_f32_16x16x32_bf16 v[116:119], v[132:135], v[12:15], v[116:119]
    v_mfma_f32_16x16x32_bf16 v[120:123], v[136:139], v[12:15], 0
    v_mfma_f32_16x16x32_bf16 v[120:123], v[152:155], v[16:19], v[120:123]
    v_mfma_f32_16x16x32_bf16 v[124:127], v[156:159], v[16:19], 0
    v_mfma_f32_16x16x32_bf16 v[124:127], v[140:143], v[12:15], v[124:127]
    s_waitcnt vmcnt(8)
    v_mfma_f32_16x16x32_bf16 v[96:99], v[160:163], v[24:27], v[96:99]
    buffer_load_dwordx4 v[12:15], v4, s[8:11], s67 offen offset:256 sc1
    buffer_load_dwordx4 v[16:19], v4, s[8:11], s67 offen offset:2304 sc1
    s_lshl_b32 s65, s18, 7
    s_add_u32 s65, s65, s46
    s_add_u32 s65, s65, 3584
    s_load_dwordx4 s[28:31], s[8:9], s65 glc
    s_lshl_b32 s65, s19, 7
    s_add_u32 s65, s65, s46
    s_add_u32 s65, s65, 3584
    s_load_dwordx4 s[32:35], s[8:9], s65 glc
    v_mfma_f32_16x16x32_bf16 v[96:99], v[176:179], v[28:31], v[96:99]
    s_add_u32 s66, s62, 67584
    v_subrev_u32 v9, s66, v9
    v_subrev_u32 v10, s66, v10
    v_mfma_f32_16x16x32_bf16 v[100:103], v[180:183], v[28:31], v[100:103]
    v_subrev_u32 v2, s66, v2
    v_subrev_u32 v3, s66, v3
    ds_read_b64_tr_b16 v[128:129], v9 offset:0
    v_mfma_f32_16x16x32_bf16 v[100:103], v[164:167], v[24:27], v[100:103]
    ds_read_b64_tr_b16 v[130:131], v9 offset:512
    ds_read_b64_tr_b16 v[132:133], v10 offset:0
    ds_read_b64_tr_b16 v[134:135], v10 offset:512
    v_mfma_f32_16x16x32_bf16 v[104:107], v[168:171], v[24:27], v[104:107]
    ds_read_b64_tr_b16 v[136:137], v2 offset:0
    ds_read_b64_tr_b16 v[138:139], v2 offset:512
    ds_read_b64_tr_b16 v[140:141], v3 offset:0
    v_mfma_f32_16x16x32_bf16 v[104:107], v[184:187], v[28:31], v[104:107]
    ds_read_b64_tr_b16 v[142:143], v3 offset:512
    ds_write_b32 v0, v5 offset:16
    v_mfma_f32_16x16x32_bf16 v[108:111], v[188:191], v[28:31], v[108:111]
    v_mfma_f32_16x16x32_bf16 v[108:111], v[172:175], v[24:27], v[108:111]
    s_waitcnt vmcnt(8)
    v_mfma_f32_16x16x32_bf16 v[112:115], v[160:163], v[32:35], v[112:115]
    s_lshl_b32 s65, s18, 12
    s_add_u32 s67, s65, s1
    buffer_load_dwordx4 v[24:27], v4, s[8:11], s67 offen offset:0 sc1
    buffer_load_dwordx4 v[28:31], v4, s[8:11], s67 offen offset:2048 sc1
    v_mfma_f32_16x16x32_bf16 v[112:115], v[176:179], v[36:39], v[112:115]
    ds_read_b64_tr_b16 v[144:145], v9 offset:4096
    ds_read_b64_tr_b16 v[146:147], v9 offset:4608
    v_mfma_f32_16x16x32_bf16 v[116:119], v[180:183], v[36:39], v[116:119]
    ds_read_b64_tr_b16 v[148:149], v10 offset:4096
    ds_read_b64_tr_b16 v[150:151], v10 offset:4608
    v_mfma_f32_16x16x32_bf16 v[116:119], v[164:167], v[32:35], v[116:119]
    ds_read_b64_tr_b16 v[152:153], v2 offset:4096
    ds_read_b64_tr_b16 v[154:155], v2 offset:4608
    v_mfma_f32_16x16x32_bf16 v[120:123], v[168:171], v[32:35], v[120:123]
    s_waitcnt lgkmcnt(11)
    ds_read_b64_tr_b16 v[156:157], v3 offset:4096
    ds_read_b64_tr_b16 v[158:159], v3 offset:4608
    v_mfma_f32_16x16x32_bf16 v[120:123], v[184:187], v[36:39], v[120:123]
    v_mfma_f32_16x16x32_bf16 v[124:127], v[188:191], v[36:39], v[124:127]
    v_mfma_f32_16x16x32_bf16 v[124:127], v[172:175], v[32:35], v[124:127]
    s_waitcnt vmcnt(8)
    v_mfma_f32_16x16x32_bf16 v[96:99], v[192:195], v[40:43], v[96:99]
    buffer_load_dwordx4 v[32:35], v4, s[8:11], s67 offen offset:256 sc1
    buffer_load_dwordx4 v[36:39], v4, s[8:11], s67 offen offset:2304 sc1
    v_mfma_f32_16x16x32_bf16 v[96:99], v[208:211], v[44:47], v[96:99]
    ds_read_b64_tr_b16 v[160:161], v9 offset:33792
    ds_read_b64_tr_b16 v[162:163], v9 offset:34304
    v_mfma_f32_16x16x32_bf16 v[100:103], v[212:215], v[44:47], v[100:103]
    s_waitcnt lgkmcnt(11)
    ds_read_b64_tr_b16 v[164:165], v10 offset:33792
    ds_read_b64_tr_b16 v[166:167], v10 offset:34304
    v_mfma_f32_16x16x32_bf16 v[100:103], v[196:199], v[40:43], v[100:103]
    ds_read_b64_tr_b16 v[168:169], v2 offset:33792
    ds_read_b64_tr_b16 v[170:171], v2 offset:34304
    v_mfma_f32_16x16x32_bf16 v[104:107], v[200:203], v[40:43], v[104:107]
    s_waitcnt lgkmcnt(11)
    ds_read_b64_tr_b16 v[172:173], v3 offset:33792
    ds_read_b64_tr_b16 v[174:175], v3 offset:34304
    v_mfma_f32_16x16x32_bf16 v[104:107], v[216:219], v[44:47], v[104:107]
    v_mfma_f32_16x16x32_bf16 v[108:111], v[220:223], v[44:47], v[108:111]
    v_mfma_f32_16x16x32_bf16 v[108:111], v[204:207], v[40:43], v[108:111]
    s_waitcnt vmcnt(8)
    v_mfma_f32_16x16x32_bf16 v[112:115], v[192:195], v[48:51], v[112:115]
    s_lshl_b32 s65, s19, 12
    s_add_u32 s67, s65, s1
    buffer_load_dwordx4 v[40:43], v4, s[8:11], s67 offen offset:0 sc1
    buffer_load_dwordx4 v[44:47], v4, s[8:11], s67 offen offset:2048 sc1
    v_mfma_f32_16x16x32_bf16 v[112:115], v[208:211], v[52:55], v[112:115]
    ds_read_b64_tr_b16 v[176:177], v9 offset:37888
    ds_read_b64_tr_b16 v[178:179], v9 offset:38400
    v_mfma_f32_16x16x32_bf16 v[116:119], v[212:215], v[52:55], v[116:119]
    s_waitcnt lgkmcnt(11)
    ds_read_b64_tr_b16 v[180:181], v10 offset:37888
    ds_read_b64_tr_b16 v[182:183], v10 offset:38400
    v_mfma_f32_16x16x32_bf16 v[116:119], v[196:199], v[48:51], v[116:119]
    ds_read_b64_tr_b16 v[184:185], v2 offset:37888
    ds_read_b64_tr_b16 v[186:187], v2 offset:38400
    v_mfma_f32_16x16x32_bf16 v[120:123], v[200:203], v[48:51], v[120:123]
    s_waitcnt lgkmcnt(11)
    ds_read_b64_tr_b16 v[188:189], v3 offset:37888
    ds_read_b64_tr_b16 v[190:191], v3 offset:38400
    v_mfma_f32_16x16x32_bf16 v[120:123], v[216:219], v[52:55], v[120:123]
    v_mfma_f32_16x16x32_bf16 v[124:127], v[220:223], v[52:55], v[124:127]
    v_mfma_f32_16x16x32_bf16 v[124:127], v[204:207], v[48:51], v[124:127]
    s_waitcnt vmcnt(8)
    v_mfma_f32_16x16x32_bf16 v[64:67], v[128:131], v[56:59], v[64:67]
    buffer_load_dwordx4 v[48:51], v4, s[8:11], s67 offen offset:256 sc1
    buffer_load_dwordx4 v[52:55], v4, s[8:11], s67 offen offset:2304 sc1
    v_mfma_f32_16x16x32_bf16 v[64:67], v[144:147], v[60:63], v[64:67]
    v_add_u32 v9, s66, v9
    v_add_u32 v10, s66, v10
    v_mfma_f32_16x16x32_bf16 v[68:71], v[148:151], v[60:63], v[68:71]
    v_add_u32 v2, s66, v2
    v_add_u32 v3, s66, v3
    v_mfma_f32_16x16x32_bf16 v[68:71], v[132:135], v[56:59], v[68:71]
    ds_read_b64_tr_b16 v[192:193], v9 offset:0
    ds_read_b64_tr_b16 v[194:195], v9 offset:512
    v_mfma_f32_16x16x32_bf16 v[72:75], v[136:139], v[56:59], v[72:75]
    s_waitcnt lgkmcnt(11)
    ds_read_b64_tr_b16 v[196:197], v10 offset:0
    ds_read_b64_tr_b16 v[198:199], v10 offset:512
    v_mfma_f32_16x16x32_bf16 v[72:75], v[152:155], v[60:63], v[72:75]
    ds_read_b64_tr_b16 v[200:201], v2 offset:0
    ds_read_b64_tr_b16 v[202:203], v2 offset:512
    v_mfma_f32_16x16x32_bf16 v[76:79], v[156:159], v[60:63], v[76:79]
    s_waitcnt lgkmcnt(11)
    ds_read_b64_tr_b16 v[204:205], v3 offset:0
    ds_read_b64_tr_b16 v[206:207], v3 offset:512
    v_mfma_f32_16x16x32_bf16 v[76:79], v[140:143], v[56:59], v[76:79]
    s_waitcnt vmcnt(8)
    v_mfma_f32_16x16x32_bf16 v[80:83], v[128:131], v[12:15], v[80:83]
    s_lshl_b32 s65, s60, 12
    s_add_u32 s67, s65, s1
    s_add_u32 s67, s67, 114688
    buffer_load_dwordx4 v[56:59], v4, s[8:11], s67 offen offset:0 sc1
    buffer_load_dwordx4 v[60:63], v4, s[8:11], s67 offen offset:2048 sc1
    v_mfma_f32_16x16x32_bf16 v[80:83], v[144:147], v[16:19], v[80:83]
    ds_read_b64_tr_b16 v[208:209], v9 offset:4096
    ds_read_b64_tr_b16 v[210:211], v9 offset:4608
    v_mfma_f32_16x16x32_bf16 v[84:87], v[148:151], v[16:19], v[84:87]
    s_waitcnt lgkmcnt(11)
    ds_read_b64_tr_b16 v[212:213], v10 offset:4096
    ds_read_b64_tr_b16 v[214:215], v10 offset:4608
    v_mfma_f32_16x16x32_bf16 v[84:87], v[132:135], v[12:15], v[84:87]
    ds_read_b64_tr_b16 v[216:217], v2 offset:4096
    ds_read_b64_tr_b16 v[218:219], v2 offset:4608
    v_mfma_f32_16x16x32_bf16 v[88:91], v[136:139], v[12:15], v[88:91]
    s_waitcnt lgkmcnt(11)
    ds_read_b64_tr_b16 v[220:221], v3 offset:4096
    ds_read_b64_tr_b16 v[222:223], v3 offset:4608
    v_mfma_f32_16x16x32_bf16 v[88:91], v[152:155], v[16:19], v[88:91]
    v_mfma_f32_16x16x32_bf16 v[92:95], v[156:159], v[16:19], v[92:95]
    v_mfma_f32_16x16x32_bf16 v[92:95], v[140:143], v[12:15], v[92:95]
    s_waitcnt vmcnt(8)
    v_mfma_f32_16x16x32_bf16 v[64:67], v[160:163], v[24:27], v[64:67]
    buffer_load_dwordx4 v[12:15], v4, s[8:11], s67 offen offset:256 sc1
    v_mfma_f32_16x16x32_bf16 v[64:67], v[176:179], v[28:31], v[64:67]
    buffer_load_dwordx4 v[16:19], v4, s[8:11], s67 offen offset:2304 sc1
    v_mfma_f32_16x16x32_bf16 v[68:71], v[180:183], v[28:31], v[68:71]
    v_mfma_f32_16x16x32_bf16 v[68:71], v[164:167], v[24:27], v[68:71]
    v_mfma_f32_16x16x32_bf16 v[72:75], v[168:171], v[24:27], v[72:75]
    v_mfma_f32_16x16x32_bf16 v[72:75], v[184:187], v[28:31], v[72:75]
    v_mfma_f32_16x16x32_bf16 v[76:79], v[188:191], v[28:31], v[76:79]
    v_mfma_f32_16x16x32_bf16 v[76:79], v[172:175], v[24:27], v[76:79]
    s_waitcnt vmcnt(8)
    v_mfma_f32_16x16x32_bf16 v[80:83], v[160:163], v[32:35], v[80:83]
    s_lshl_b32 s65, s17, 12
    s_add_u32 s67, s65, s1
    s_add_u32 s67, s67, 114688
    buffer_load_dwordx4 v[24:27], v4, s[8:11], s67 offen offset:0 sc1
    v_mfma_f32_16x16x32_bf16 v[80:83], v[176:179], v[36:39], v[80:83]
    buffer_load_dwordx4 v[28:31], v4, s[8:11], s67 offen offset:2048 sc1
    v_mfma_f32_16x16x32_bf16 v[84:87], v[180:183], v[36:39], v[84:87]
    v_mfma_f32_16x16x32_bf16 v[84:87], v[164:167], v[32:35], v[84:87]
    v_mfma_f32_16x16x32_bf16 v[88:91], v[168:171], v[32:35], v[88:91]
    v_mfma_f32_16x16x32_bf16 v[88:91], v[184:187], v[36:39], v[88:91]
    v_mfma_f32_16x16x32_bf16 v[92:95], v[188:191], v[36:39], v[92:95]
    v_mfma_f32_16x16x32_bf16 v[92:95], v[172:175], v[32:35], v[92:95]
    s_waitcnt vmcnt(8) lgkmcnt(0)
    v_mfma_f32_16x16x32_bf16 v[64:67], v[192:195], v[40:43], v[64:67]
    buffer_load_dwordx4 v[32:35], v4, s[8:11], s67 offen offset:256 sc1
    v_mfma_f32_16x16x32_bf16 v[64:67], v[208:211], v[44:47], v[64:67]
    buffer_load_dwordx4 v[36:39], v4, s[8:11], s67 offen offset:2304 sc1
    v_mfma_f32_16x16x32_bf16 v[68:71], v[212:215], v[44:47], v[68:71]
    v_mfma_f32_16x16x32_bf16 v[68:71], v[196:199], v[40:43], v[68:71]
    v_mfma_f32_16x16x32_bf16 v[72:75], v[200:203], v[40:43], v[72:75]
    v_mfma_f32_16x16x32_bf16 v[72:75], v[216:219], v[44:47], v[72:75]
    v_mfma_f32_16x16x32_bf16 v[76:79], v[220:223], v[44:47], v[76:79]
    v_mfma_f32_16x16x32_bf16 v[76:79], v[204:207], v[40:43], v[76:79]
    s_waitcnt vmcnt(8)
    v_mfma_f32_16x16x32_bf16 v[80:83], v[192:195], v[48:51], v[80:83]
    s_mov_b32 s70, 0
L_schk_47:
    s_waitcnt lgkmcnt(0)
    s_cmp_lg_u32 s28, s47
    s_cbranch_scc1 L_sp_48
    s_cmp_lg_u32 s29, s47
    s_cbranch_scc1 L_sp_48
    s_cmp_lg_u32 s30, s47
    s_cbranch_scc1 L_sp_48
    s_cmp_lg_u32 s31, s47
    s_cbranch_scc1 L_sp_48
    s_cmp_lg_u32 s32, s47
    s_cbranch_scc1 L_sp_48
    s_cmp_lg_u32 s33, s47
    s_cbranch_scc1 L_sp_48
    s_cmp_lg_u32 s34, s47
    s_cbranch_scc1 L_sp_48
    s_cmp_eq_u32 s35, s47
    s_cbranch_scc1 L_ok_49
L_sp_48:
    s_add_u32 s70, s70, 1
    s_cmp_gt_u32 s70, 40000
    s_cbranch_scc1 L_ok_49
    s_lshl_b32 s65, s18, 7
    s_add_u32 s65, s65, s46
    s_add_u32 s65, s65, 3584
    s_load_dwordx4 s[28:31], s[8:9], s65 glc
    s_lshl_b32 s65, s19, 7
    s_add_u32 s65, s65, s46
    s_add_u32 s65, s65, 3584
    s_load_dwordx4 s[32:35], s[8:9], s65 glc
    s_branch L_schk_47
L_ok_49:
    v_mfma_f32_16x16x32_bf16 v[80:83], v[208:211], v[52:55], v[80:83]
    s_lshl_b32 s65, s18, 12
    s_add_u32 s67, s65, s1
    s_add_u32 s67, s67, 114688
    buffer_load_dwordx4 v[40:43], v4, s[8:11], s67 offen offset:0 sc1
    v_mfma_f32_16x16x32_bf16 v[84:87], v[212:215], v[52:55], v[84:87]
    buffer_load_dwordx4 v[44:47], v4, s[8:11], s67 offen offset:2048 sc1
    v_mfma_f32_16x16x32_bf16 v[84:87], v[196:199], v[48:51], v[84:87]
    v_mfma_f32_16x16x32_bf16 v[88:91], v[200:203], v[48:51], v[88:91]
    v_mfma_f32_16x16x32_bf16 v[88:91], v[216:219], v[52:55], v[88:91]
    v_mfma_f32_16x16x32_bf16 v[92:95], v[220:223], v[52:55], v[92:95]
    v_mfma_f32_16x16x32_bf16 v[92:95], v[204:207], v[48:51], v[92:95]
    s_waitcnt vmcnt(8)
    v_mfma_f32_16x16x32_bf16 v[96:99], v[224:227], v[56:59], v[96:99]
    s_lshl_b32 s65, s19, 12
    s_add_u32 s67, s65, s1
    s_add_u32 s67, s67, 114688
    buffer_load_dwordx4 v[48:51], v4, s[8:11], s67 offen offset:0 sc1
    v_mfma_f32_16x16x32_bf16 v[96:99], v[240:243], v[60:63], v[96:99]
    buffer_load_dwordx4 v[52:55], v4, s[8:11], s67 offen offset:2048 sc1
    v_mfma_f32_16x16x32_bf16 v[100:103], v[244:247], v[60:63], v[100:103]
    v_mfma_f32_16x16x32_bf16 v[100:103], v[228:231], v[56:59], v[100:103]
    ds_write_b128 v7, v[64:67] offset:0
    v_mfma_f32_16x16x32_bf16 v[104:107], v[232:235], v[56:59], v[104:107]
    ds_write_b128 v11, v[68:71] offset:0
    v_mfma_f32_16x16x32_bf16 v[104:107], v[248:251], v[60:63], v[104:107]
    ds_write_b128 v7, v[72:75] offset:128
    v_mfma_f32_16x16x32_bf16 v[108:111], v[252:255], v[60:63], v[108:111]
    ds_write_b128 v11, v[76:79] offset:128
    v_mfma_f32_16x16x32_bf16 v[108:111], v[236:239], v[56:59], v[108:111]
    s_waitcnt vmcnt(8)
    v_mfma_f32_16x16x32_bf16 v[112:115], v[224:227], v[12:15], v[112:115]
    s_lshl_b32 s65, s18, 12
    s_add_u32 s67, s65, s1
    s_add_u32 s67, s67, 114688
    buffer_load_dwordx4 v[56:59], v4, s[8:11], s67 offen offset:256 sc1
    v_mfma_f32_16x16x32_bf16 v[112:115], v[240:243], v[16:19], v[112:115]
    buffer_load_dwordx4 v[60:63], v4, s[8:11], s67 offen offset:2304 sc1
    v_mfma_f32_16x16x32_bf16 v[116:119], v[244:247], v[16:19], v[116:119]
    v_mfma_f32_16x16x32_bf16 v[116:119], v[228:231], v[12:15], v[116:119]
    ds_write_b128 v7, v[80:83] offset:4096
    v_mfma_f32_16x16x32_bf16 v[120:123], v[232:235], v[12:15], v[120:123]
    ds_write_b128 v11, v[84:87] offset:4096
    v_mfma_f32_16x16x32_bf16 v[120:123], v[248:251], v[16:19], v[120:123]
    ds_write_b128 v7, v[88:91] offset:4224
    v_mfma_f32_16x16x32_bf16 v[124:127], v[252:255], v[16:19], v[124:127]
    ds_write_b128 v11, v[92:95] offset:4224
    v_mfma_f32_16x16x32_bf16 v[124:127], v[236:239], v[12:15], v[124:127]
    ds_write_b32 v0, v5
    s_waitcnt vmcnt(8)
    v_mfma_f32_16x16x32_bf16 v[96:99], v[128:131], v[24:27], v[96:99]
    s_lshl_b32 s65, s19, 12
    s_add_u32 s67, s65, s1
    s_add_u32 s67, s67, 114688
    buffer_load_dwordx4 v[12:15], v4, s[8:11], s67 offen offset:256 sc1
    v_mfma_f32_16x16x32_bf16 v[96:99], v[144:147], v[28:31], v[96:99]
    buffer_load_dwordx4 v[16:19], v4, s[8:11], s67 offen offset:2304 sc1
    v_mfma_f32_16x16x32_bf16 v[100:103], v[148:151], v[28:31], v[100:103]
    v_mfma_f32_16x16x32_bf16 v[100:103], v[132:135], v[24:27], v[100:103]
    v_mfma_f32_16x16x32_bf16 v[104:107], v[136:139], v[24:27], v[104:107]
    v_mfma_f32_16x16x32_bf16 v[104:107], v[152:155], v[28:31], v[104:107]
    v_mfma_f32_16x16x32_bf16 v[108:111], v[156:159], v[28:31], v[108:111]
    v_mfma_f32_16x16x32_bf16 v[108:111], v[140:143], v[24:27], v[108:111]
    s_waitcnt vmcnt(8)
    v_mfma_f32_16x16x32_bf16 v[112:115], v[128:131], v[32:35], v[112:115]
    v_mfma_f32_16x16x32_bf16 v[112:115], v[144:147], v[36:39], v[112:115]
    v_mfma_f32_16x16x32_bf16 v[116:119], v[148:151], v[36:39], v[116:119]
    v_mfma_f32_16x16x32_bf16 v[116:119], v[132:135], v[32:35], v[116:119]
    v_mfma_f32_16x16x32_bf16 v[120:123], v[136:139], v[32:35], v[120:123]
    v_mfma_f32_16x16x32_bf16 v[120:123], v[152:155], v[36:39], v[120:123]
    v_mfma_f32_16x16x32_bf16 v[124:127], v[156:159], v[36:39], v[124:127]
    v_mfma_f32_16x16x32_bf16 v[124:127], v[140:143], v[32:35], v[124:127]
    s_waitcnt vmcnt(6)
    v_mfma_f32_16x16x32_bf16 v[96:99], v[160:163], v[40:43], v[96:99]
    v_mfma_f32_16x16x32_bf16 v[96:99], v[176:179], v[44:47], v[96:99]
    v_mfma_f32_16x16x32_bf16 v[100:103], v[180:183], v[44:47], v[100:103]
    v_mfma_f32_16x16x32_bf16 v[100:103], v[164:167], v[40:43], v[100:103]
    v_mfma_f32_16x16x32_bf16 v[104:107], v[168:171], v[40:43], v[104:107]
    v_mfma_f32_16x16x32_bf16 v[104:107], v[184:187], v[44:47], v[104:107]
    v_mfma_f32_16x16x32_bf16 v[108:111], v[188:191], v[44:47], v[108:111]
    v_mfma_f32_16x16x32_bf16 v[108:111], v[172:175], v[40:43], v[108:111]
    s_waitcnt vmcnt(4)
    v_mfma_f32_16x16x32_bf16 v[96:99], v[192:195], v[48:51], v[96:99]
    v_mfma_f32_16x16x32_bf16 v[96:99], v[208:211], v[52:55], v[96:99]
    v_mfma_f32_16x16x32_bf16 v[100:103], v[212:215], v[52:55], v[100:103]
    v_mfma_f32_16x16x32_bf16 v[100:103], v[196:199], v[48:51], v[100:103]
    v_mfma_f32_16x16x32_bf16 v[104:107], v[200:203], v[48:51], v[104:107]
    v_mfma_f32_16x16x32_bf16 v[104:107], v[216:219], v[52:55], v[104:107]
    v_mfma_f32_16x16x32_bf16 v[108:111], v[220:223], v[52:55], v[108:111]
    v_mfma_f32_16x16x32_bf16 v[108:111], v[204:207], v[48:51], v[108:111]
    s_waitcnt vmcnt(0)
    v_mfma_f32_16x16x32_bf16 v[112:115], v[160:163], v[56:59], v[112:115]
    v_mfma_f32_16x16x32_bf16 v[112:115], v[176:179], v[60:63], v[112:115]
    v_mfma_f32_16x16x32_bf16 v[112:115], v[192:195], v[12:15], v[112:115]
    ds_write_b128 v7, v[96:99] offset:33792
    v_mfma_f32_16x16x32_bf16 v[112:115], v[208:211], v[16:19], v[112:115]
    v_mfma_f32_16x16x32_bf16 v[116:119], v[164:167], v[56:59], v[116:119]
    ds_write_b128 v11, v[100:103] offset:33792
    v_mfma_f32_16x16x32_bf16 v[116:119], v[180:183], v[60:63], v[116:119]
    v_mfma_f32_16x16x32_bf16 v[116:119], v[196:199], v[12:15], v[116:119]
    ds_write_b128 v7, v[104:107] offset:33920
    v_mfma_f32_16x16x32_bf16 v[116:119], v[212:215], v[16:19], v[116:119]
    v_mfma_f32_16x16x32_bf16 v[120:123], v[168:171], v[56:59], v[120:123]
    ds_write_b128 v11, v[108:111] offset:33920
    v_mfma_f32_16x16x32_bf16 v[120:123], v[184:187], v[60:63], v[120:123]
    v_mfma_f32_16x16x32_bf16 v[120:123], v[200:203], v[12:15], v[120:123]
    ds_write_b128 v7, v[112:115] offset:37888
    v_mfma_f32_16x16x32_bf16 v[120:123], v[216:219], v[16:19], v[120:123]
    v_mfma_f32_16x16x32_bf16 v[124:127], v[172:175], v[56:59], v[124:127]
    v_mfma_f32_16x16x32_bf16 v[124:127], v[188:191], v[60:63], v[124:127]
    v_mfma_f32_16x16x32_bf16 v[124:127], v[204:207], v[12:15], v[124:127]
    ds_write_b128 v11, v[116:119] offset:37888
    v_mfma_f32_16x16x32_bf16 v[124:127], v[220:223], v[16:19], v[124:127]
    s_waitcnt lgkmcnt(11)
    s_nop 1
    ds_write_b128 v7, v[120:123] offset:38016
    s_nop 3
    ds_write_b128 v11, v[124:127] offset:38016
    s_waitcnt lgkmcnt(0)
    s_barrier
    s_endpgm
L_exit:
    s_endpgm
L_PA:
    s_load_dwordx2 s[44:45], s[0:1], 40
    s_load_dwordx2 s[16:17], s[0:1], 80
    s_load_dwordx2 s[40:41], s[0:1], 32
    s_mov_b32 s30, 2097152
    s_mov_b32 s31, 0x00020000
    s_mov_b32 s34, 2097152
    s_mov_b32 s35, 0x00020000
    s_mov_b32 s38, 4096
    s_mov_b32 s39, 0x00020000
    v_lshrrev_b32 v22, 5, v0
    v_and_b32 v23, 31, v0
    v_lshlrev_b32 v23, 4, v23
    v_lshl_add_u32 v23, v22, 10, v23
    s_lshl_b32 s65, s3, 3
    s_add_u32 s65, s65, s56
    s_lshl_b32 s65, s65, 2
    s_add_u32 s65, s65, s48
    s_lshl_b32 s65, s65, 1
    s_add_u32 s65, s65, s52
    s_lshl_b32 s66, s65, 10
    s_lshl_b32 s65, s65, 4
    s_add_u32 s65, s65, 32768
    v_lshlrev_b32 v22, 4, v22
    v_add_u32 v22, s65, v22
    s_waitcnt lgkmcnt(0)
    s_add_u32 s0, s2, 32
    s_and_b32 s0, s0, 255
    s_lshl_b32 s65, s0, 2
    s_load_dword s47, s[8:9], 0
    s_load_dword s46, s[44:45], s65
    buffer_load_dwordx4 v[224:227], v23, s[4:7], s66 offen sc1
    buffer_load_dwordx4 v[228:231], v23, s[4:7], s66 offen offset:512 sc1
    v_and_b32 v248, 31, v0
    v_min_u32 v248, 1, v248
    v_lshl_add_u32 v248, v248, 30, v22
    s_mov_b32 s10, 12582912
    s_mov_b32 s11, 0x00020000
    v_lshrrev_b32 v249, 3, v0
    v_and_b32 v250, 7, v0
    v_lshlrev_b32 v251, 4, v250
    v_lshl_add_u32 v251, v249, 13, v251
    s_sub_u32 s53, s2, 224
    s_lshl_b32 s53, s53, 16
    s_lshl_b32 s54, s49, 7
    s_add_u32 s53, s53, s54
    s_add_u32 s54, s53, 4096
    s_sub_u32 s64, s53, 3072
    v_add_u32 v252, s64, v251
    v_lshlrev_b32 v253, 6, v250
    s_lshl_b32 s64, s49, 9
    buffer_load_dwordx4 v[204:207], v253, s[36:39], s64 offen offset:0
    buffer_load_dwordx4 v[208:211], v253, s[36:39], s64 offen offset:16
    buffer_load_dwordx4 v[212:215], v253, s[36:39], s64 offen offset:32
    buffer_load_dwordx4 v[216:219], v253, s[36:39], s64 offen offset:48
    buffer_load_dwordx4 v[160:163], v251, s[28:31], s54 offen offset:1024
    buffer_load_dwordx4 v[128:131], v252, s[28:31], 0 offen offset:0
    buffer_load_dwordx4 v[164:167], v251, s[28:31], s54 offen offset:2048
    buffer_load_dwordx4 v[132:135], v252, s[28:31], 0 offen offset:1024
    buffer_load_dwordx4 v[168:171], v251, s[28:31], s54 offen offset:3072
    buffer_load_dwordx4 v[136:139], v252, s[28:31], 0 offen offset:2048
    buffer_load_dwordx4 v[140:143], v251, s[28:31], s53 offen offset:0
    buffer_load_dwordx4 v[144:147], v251, s[28:31], s53 offen offset:1024
    buffer_load_dwordx4 v[148:151], v251, s[28:31], s53 offen offset:2048
    buffer_load_dwordx4 v[152:155], v251, s[28:31], s53 offen offset:3072
    buffer_load_dwordx4 v[156:159], v251, s[28:31], s54 offen offset:0
    s_waitcnt vmcnt(15)
    v_lshlrev_b32 v232, 16, v224
    v_and_b32 v233, 0xffff0000, v224
    v_lshlrev_b32 v234, 16, v225
    v_and_b32 v235, 0xffff0000, v225
    v_lshlrev_b32 v236, 16, v226
    v_and_b32 v237, 0xffff0000, v226
    v_lshlrev_b32 v238, 16, v227
    v_and_b32 v239, 0xffff0000, v227
    v_lshlrev_b32 v240, 16, v228
    v_and_b32 v241, 0xffff0000, v228
    v_lshlrev_b32 v242, 16, v229
    v_and_b32 v243, 0xffff0000, v229
    v_lshlrev_b32 v244, 16, v230
    v_and_b32 v245, 0xffff0000, v230
    v_lshlrev_b32 v246, 16, v231
    v_and_b32 v247, 0xffff0000, v231
    v_add_f32 v224, v232, v233
    v_add_f32 v225, v234, v235
    v_add_f32 v226, v236, v237
    v_add_f32 v227, v238, v239
    v_add_f32 v228, v240, v241
    v_add_f32 v229, v242, v243
    v_add_f32 v230, v244, v245
    v_add_f32 v231, v246, v247
    v_add_f32 v224, v224, v228
    v_add_f32 v225, v225, v229
    v_add_f32 v226, v226, v230
    v_add_f32 v227, v227, v231
    v_add_f32 v224, v224, v226
    v_add_f32 v225, v225, v227
    v_add_f32 v224, v224, v225
    s_nop 1
    v_add_f32_dpp v224, v224, v224 row_ror:8 row_mask:0xf bank_mask:0xf
    s_nop 1
    v_add_f32_dpp v224, v224, v224 row_ror:4 row_mask:0xf bank_mask:0xf
    s_nop 1
    v_add_f32_dpp v224, v224, v224 row_ror:2 row_mask:0xf bank_mask:0xf
    s_nop 1
    v_add_f32_dpp v224, v224, v224 row_ror:1 row_mask:0xf bank_mask:0xf
    v_mov_b32 v225, v224
    s_nop 1
    v_permlane16_swap_b32 v224, v225
    v_add_f32 v224, v224, v225
    v_mul_f32 v224, 0x3b000000, v224
    v_sub_f32 v232, v232, v224
    v_sub_f32 v233, v233, v224
    v_sub_f32 v234, v234, v224
    v_sub_f32 v235, v235, v224
    v_sub_f32 v236, v236, v224
    v_sub_f32 v237, v237, v224
    v_sub_f32 v238, v238, v224
    v_sub_f32 v239, v239, v224
    v_sub_f32 v240, v240, v224
    v_sub_f32 v241, v241, v224
    v_sub_f32 v242, v242, v224
    v_sub_f32 v243, v243, v224
    v_sub_f32 v244, v244, v224
    v_sub_f32 v245, v245, v224
    v_sub_f32 v246, v246, v224
    v_sub_f32 v247, v247, v224
    v_mul_f32 v226, v232, v232
    v_mul_f32 v227, v233, v233
    v_fmac_f32 v226, v234, v234
    v_fmac_f32 v227, v235, v235
    v_fmac_f32 v226, v236, v236
    v_fmac_f32 v227, v237, v237
    v_fmac_f32 v226, v238, v238
    v_fmac_f32 v227, v239, v239
    v_fmac_f32 v226, v240, v240
    v_fmac_f32 v227, v241, v241
    v_fmac_f32 v226, v242, v242
    v_fmac_f32 v227, v243, v243
    v_fmac_f32 v226, v244, v244
    v_fmac_f32 v227, v245, v245
    v_fmac_f32 v226, v246, v246
    v_fmac_f32 v227, v247, v247
    v_add_f32 v226, v226, v227
    s_nop 1
    v_add_f32_dpp v226, v226, v226 row_ror:8 row_mask:0xf bank_mask:0xf
    s_nop 1
    v_add_f32_dpp v226, v226, v226 row_ror:4 row_mask:0xf bank_mask:0xf
    s_nop 1
    v_add_f32_dpp v226, v226, v226 row_ror:2 row_mask:0xf bank_mask:0xf
    s_nop 1
    v_add_f32_dpp v226, v226, v226 row_ror:1 row_mask:0xf bank_mask:0xf
    v_mov_b32 v227, v226
    s_nop 1
    v_permlane16_swap_b32 v226, v227
    v_add_f32 v226, v226, v227
    v_mul_f32 v226, 0x3b000000, v226
    v_cvt_pk_bf16_f32 v226, v226, v226
    v_and_b32 v226, 0xffff0000, v226
    v_add_f32 v226, 0x3727c5ac, v226
    v_cvt_pk_bf16_f32 v226, v226, v226
    v_and_b32 v226, 0xffff0000, v226
    v_sqrt_f32 v226, v226
    s_nop 0
    v_cvt_pk_bf16_f32 v226, v224, v226
    v_lshlrev_b32 v229, 16, v226
    v_and_b32 v226, 0xffff0000, v226
    v_rcp_f32 v226, v226
    s_nop 0
    v_mul_f32 v230, 0xc0135761, v226
    v_mul_f32 v226, v226, v226
    v_mul_f32 v226, 0x3d372713, v226
    v_mul_f32 v231, v226, v230
    s_waitcnt lgkmcnt(0)
    s_add_u32 s47, s47, 0x9e3779b1
    s_barrier
    v_mov_b32 v228, s47
    buffer_store_dwordx4 v[228:231], v248, s[8:11], 0 offen sc1
    v_mov_b32 v10, s47
    s_mov_b32 s42, 2097152
    s_mov_b32 s43, 0x00020000
    v_lshlrev_b32 v5, 4, v0
    v_sub_u32 v252, 7, v250
    v_lshl_add_u32 v252, v252, 3, v249
    v_lshlrev_b32 v252, 2, v252
    v_lshlrev_b32 v253, 4, v250
    v_lshl_add_u32 v253, v249, 15, v253
    s_sub_u32 s70, s2, 224
    s_lshl_b32 s70, s70, 7
    s_lshl_b32 s64, s49, 18
    s_sub_u32 s64, s64, s70
    s_add_u32 s64, s64, 1052544
    buffer_load_dwordx4 v[172:175], v251, s[32:35], s53 offen offset:0
    buffer_load_dwordx4 v[176:179], v251, s[32:35], s53 offen offset:1024
    buffer_load_dwordx4 v[180:183], v251, s[32:35], s53 offen offset:2048
    buffer_load_dwordx4 v[184:187], v251, s[32:35], s53 offen offset:3072
    buffer_load_dwordx4 v[188:191], v251, s[32:35], s54 offen offset:0
    buffer_load_dwordx4 v[192:195], v251, s[32:35], s54 offen offset:1024
    buffer_load_dwordx4 v[196:199], v251, s[32:35], s54 offen offset:2048
    buffer_load_dwordx4 v[200:203], v251, s[32:35], s54 offen offset:3072
    s_waitcnt vmcnt(9)
    v_lshlrev_b32 v100, 16, v204
    v_and_b32 v101, 0xffff0000, v204
    v_lshlrev_b32 v102, 16, v205
    v_and_b32 v103, 0xffff0000, v205
    v_lshlrev_b32 v88, 16, v128
    v_lshlrev_b32 v89, 16, v132
    v_lshlrev_b32 v90, 16, v136
    v_lshlrev_b32 v91, 16, v140
    v_lshlrev_b32 v92, 16, v144
    v_lshlrev_b32 v93, 16, v148
    v_lshlrev_b32 v94, 16, v152
    v_lshlrev_b32 v95, 16, v156
    v_lshlrev_b32 v96, 16, v160
    v_lshlrev_b32 v97, 16, v164
    v_lshlrev_b32 v98, 16, v168
    v_mul_f32 v24, v88, v103
    v_mul_f32 v25, v89, v103
    v_mul_f32 v26, v90, v103
    v_mul_f32 v27, v91, v103
    v_mul_f32 v28, v92, v103
    v_mul_f32 v29, v93, v103
    v_mul_f32 v30, v94, v103
    v_mul_f32 v31, v95, v103
    v_fmac_f32 v24, v89, v102
    v_fmac_f32 v25, v90, v102
    v_fmac_f32 v26, v91, v102
    v_fmac_f32 v27, v92, v102
    v_fmac_f32 v28, v93, v102
    v_fmac_f32 v29, v94, v102
    v_fmac_f32 v30, v95, v102
    v_fmac_f32 v31, v96, v102
    v_fmac_f32 v24, v90, v101
    v_fmac_f32 v25, v91, v101
    v_fmac_f32 v26, v92, v101
    v_fmac_f32 v27, v93, v101
    v_fmac_f32 v28, v94, v101
    v_fmac_f32 v29, v95, v101
    v_fmac_f32 v30, v96, v101
    v_fmac_f32 v31, v97, v101
    v_fmac_f32 v24, v91, v100
    v_fmac_f32 v25, v92, v100
    v_fmac_f32 v26, v93, v100
    v_fmac_f32 v27, v94, v100
    v_fmac_f32 v28, v95, v100
    v_fmac_f32 v29, v96, v100
    v_fmac_f32 v30, v97, v100
    v_fmac_f32 v31, v98, v100
    v_lshlrev_b32 v100, 16, v206
    v_and_b32 v101, 0xffff0000, v206
    v_lshlrev_b32 v102, 16, v207
    v_and_b32 v103, 0xffff0000, v207
    v_and_b32 v88, 0xffff0000, v128
    v_and_b32 v89, 0xffff0000, v132
    v_and_b32 v90, 0xffff0000, v136
    v_and_b32 v91, 0xffff0000, v140
    v_and_b32 v92, 0xffff0000, v144
    v_and_b32 v93, 0xffff0000, v148
    v_and_b32 v94, 0xffff0000, v152
    v_and_b32 v95, 0xffff0000, v156
    v_and_b32 v96, 0xffff0000, v160
    v_and_b32 v97, 0xffff0000, v164
    v_and_b32 v98, 0xffff0000, v168
    v_mul_f32 v32, v88, v103
    v_mul_f32 v33, v89, v103
    v_mul_f32 v34, v90, v103
    v_mul_f32 v35, v91, v103
    v_mul_f32 v36, v92, v103
    v_mul_f32 v37, v93, v103
    v_mul_f32 v38, v94, v103
    v_mul_f32 v39, v95, v103
    v_fmac_f32 v32, v89, v102
    v_fmac_f32 v33, v90, v102
    v_fmac_f32 v34, v91, v102
    v_fmac_f32 v35, v92, v102
    v_fmac_f32 v36, v93, v102
    v_fmac_f32 v37, v94, v102
    v_fmac_f32 v38, v95, v102
    v_fmac_f32 v39, v96, v102
    v_fmac_f32 v32, v90, v101
    v_fmac_f32 v33, v91, v101
    v_fmac_f32 v34, v92, v101
    v_fmac_f32 v35, v93, v101
    v_fmac_f32 v36, v94, v101
    v_fmac_f32 v37, v95, v101
    v_fmac_f32 v38, v96, v101
    v_fmac_f32 v39, v97, v101
    v_fmac_f32 v32, v91, v100
    v_fmac_f32 v33, v92, v100
    v_fmac_f32 v34, v93, v100
    v_fmac_f32 v35, v94, v100
    v_fmac_f32 v36, v95, v100
    v_fmac_f32 v37, v96, v100
    v_fmac_f32 v38, v97, v100
    v_fmac_f32 v39, v98, v100
    v_lshlrev_b32 v100, 16, v208
    v_and_b32 v101, 0xffff0000, v208
    v_lshlrev_b32 v102, 16, v209
    v_and_b32 v103, 0xffff0000, v209
    v_lshlrev_b32 v88, 16, v129
    v_lshlrev_b32 v89, 16, v133
    v_lshlrev_b32 v90, 16, v137
    v_lshlrev_b32 v91, 16, v141
    v_lshlrev_b32 v92, 16, v145
    v_lshlrev_b32 v93, 16, v149
    v_lshlrev_b32 v94, 16, v153
    v_lshlrev_b32 v95, 16, v157
    v_lshlrev_b32 v96, 16, v161
    v_lshlrev_b32 v97, 16, v165
    v_lshlrev_b32 v98, 16, v169
    v_mul_f32 v40, v88, v103
    v_mul_f32 v41, v89, v103
    v_mul_f32 v42, v90, v103
    v_mul_f32 v43, v91, v103
    v_mul_f32 v44, v92, v103
    v_mul_f32 v45, v93, v103
    v_mul_f32 v46, v94, v103
    v_mul_f32 v47, v95, v103
    v_fmac_f32 v40, v89, v102
    v_fmac_f32 v41, v90, v102
    v_fmac_f32 v42, v91, v102
    v_fmac_f32 v43, v92, v102
    v_fmac_f32 v44, v93, v102
    v_fmac_f32 v45, v94, v102
    v_fmac_f32 v46, v95, v102
    v_fmac_f32 v47, v96, v102
    v_fmac_f32 v40, v90, v101
    v_fmac_f32 v41, v91, v101
    v_fmac_f32 v42, v92, v101
    v_fmac_f32 v43, v93, v101
    v_fmac_f32 v44, v94, v101
    v_fmac_f32 v45, v95, v101
    v_fmac_f32 v46, v96, v101
    v_fmac_f32 v47, v97, v101
    v_fmac_f32 v40, v91, v100
    v_fmac_f32 v41, v92, v100
    v_fmac_f32 v42, v93, v100
    v_fmac_f32 v43, v94, v100
    v_fmac_f32 v44, v95, v100
    v_fmac_f32 v45, v96, v100
    v_fmac_f32 v46, v97, v100
    v_fmac_f32 v47, v98, v100
    v_lshlrev_b32 v100, 16, v210
    v_and_b32 v101, 0xffff0000, v210
    v_lshlrev_b32 v102, 16, v211
    v_and_b32 v103, 0xffff0000, v211
    v_and_b32 v88, 0xffff0000, v129
    v_and_b32 v89, 0xffff0000, v133
    v_and_b32 v90, 0xffff0000, v137
    v_and_b32 v91, 0xffff0000, v141
    v_and_b32 v92, 0xffff0000, v145
    v_and_b32 v93, 0xffff0000, v149
    v_and_b32 v94, 0xffff0000, v153
    v_and_b32 v95, 0xffff0000, v157
    v_and_b32 v96, 0xffff0000, v161
    v_and_b32 v97, 0xffff0000, v165
    v_and_b32 v98, 0xffff0000, v169
    v_mul_f32 v48, v88, v103
    v_mul_f32 v49, v89, v103
    v_mul_f32 v50, v90, v103
    v_mul_f32 v51, v91, v103
    v_mul_f32 v52, v92, v103
    v_mul_f32 v53, v93, v103
    v_mul_f32 v54, v94, v103
    v_mul_f32 v55, v95, v103
    v_fmac_f32 v48, v89, v102
    v_fmac_f32 v49, v90, v102
    v_fmac_f32 v50, v91, v102
    v_fmac_f32 v51, v92, v102
    v_fmac_f32 v52, v93, v102
    v_fmac_f32 v53, v94, v102
    v_fmac_f32 v54, v95, v102
    v_fmac_f32 v55, v96, v102
    v_fmac_f32 v48, v90, v101
    v_fmac_f32 v49, v91, v101
    v_fmac_f32 v50, v92, v101
    v_fmac_f32 v51, v93, v101
    v_fmac_f32 v52, v94, v101
    v_fmac_f32 v53, v95, v101
    v_fmac_f32 v54, v96, v101
    v_fmac_f32 v55, v97, v101
    v_fmac_f32 v48, v91, v100
    v_fmac_f32 v49, v92, v100
    v_fmac_f32 v50, v93, v100
    v_fmac_f32 v51, v94, v100
    v_fmac_f32 v52, v95, v100
    v_fmac_f32 v53, v96, v100
    v_fmac_f32 v54, v97, v100
    v_fmac_f32 v55, v98, v100
    v_lshlrev_b32 v100, 16, v212
    v_and_b32 v101, 0xffff0000, v212
    v_lshlrev_b32 v102, 16, v213
    v_and_b32 v103, 0xffff0000, v213
    v_lshlrev_b32 v88, 16, v130
    v_lshlrev_b32 v89, 16, v134
    v_lshlrev_b32 v90, 16, v138
    v_lshlrev_b32 v91, 16, v142
    v_lshlrev_b32 v92, 16, v146
    v_lshlrev_b32 v93, 16, v150
    v_lshlrev_b32 v94, 16, v154
    v_lshlrev_b32 v95, 16, v158
    v_lshlrev_b32 v96, 16, v162
    v_lshlrev_b32 v97, 16, v166
    v_lshlrev_b32 v98, 16, v170
    v_mul_f32 v56, v88, v103
    v_mul_f32 v57, v89, v103
    v_mul_f32 v58, v90, v103
    v_mul_f32 v59, v91, v103
    v_mul_f32 v60, v92, v103
    v_mul_f32 v61, v93, v103
    v_mul_f32 v62, v94, v103
    v_mul_f32 v63, v95, v103
    v_fmac_f32 v56, v89, v102
    v_fmac_f32 v57, v90, v102
    v_fmac_f32 v58, v91, v102
    v_fmac_f32 v59, v92, v102
    v_fmac_f32 v60, v93, v102
    v_fmac_f32 v61, v94, v102
    v_fmac_f32 v62, v95, v102
    v_fmac_f32 v63, v96, v102
    v_fmac_f32 v56, v90, v101
    v_fmac_f32 v57, v91, v101
    v_fmac_f32 v58, v92, v101
    v_fmac_f32 v59, v93, v101
    v_fmac_f32 v60, v94, v101
    v_fmac_f32 v61, v95, v101
    v_fmac_f32 v62, v96, v101
    v_fmac_f32 v63, v97, v101
    v_fmac_f32 v56, v91, v100
    v_fmac_f32 v57, v92, v100
    v_fmac_f32 v58, v93, v100
    v_fmac_f32 v59, v94, v100
    v_fmac_f32 v60, v95, v100
    v_fmac_f32 v61, v96, v100
    v_fmac_f32 v62, v97, v100
    v_fmac_f32 v63, v98, v100
    v_lshlrev_b32 v100, 16, v214
    v_and_b32 v101, 0xffff0000, v214
    v_lshlrev_b32 v102, 16, v215
    v_and_b32 v103, 0xffff0000, v215
    v_and_b32 v88, 0xffff0000, v130
    v_and_b32 v89, 0xffff0000, v134
    v_and_b32 v90, 0xffff0000, v138
    v_and_b32 v91, 0xffff0000, v142
    v_and_b32 v92, 0xffff0000, v146
    v_and_b32 v93, 0xffff0000, v150
    v_and_b32 v94, 0xffff0000, v154
    v_and_b32 v95, 0xffff0000, v158
    v_and_b32 v96, 0xffff0000, v162
    v_and_b32 v97, 0xffff0000, v166
    v_and_b32 v98, 0xffff0000, v170
    v_mul_f32 v64, v88, v103
    v_mul_f32 v65, v89, v103
    v_mul_f32 v66, v90, v103
    v_mul_f32 v67, v91, v103
    v_mul_f32 v68, v92, v103
    v_mul_f32 v69, v93, v103
    v_mul_f32 v70, v94, v103
    v_mul_f32 v71, v95, v103
    v_fmac_f32 v64, v89, v102
    v_fmac_f32 v65, v90, v102
    v_fmac_f32 v66, v91, v102
    v_fmac_f32 v67, v92, v102
    v_fmac_f32 v68, v93, v102
    v_fmac_f32 v69, v94, v102
    v_fmac_f32 v70, v95, v102
    v_fmac_f32 v71, v96, v102
    v_fmac_f32 v64, v90, v101
    v_fmac_f32 v65, v91, v101
    v_fmac_f32 v66, v92, v101
    v_fmac_f32 v67, v93, v101
    v_fmac_f32 v68, v94, v101
    v_fmac_f32 v69, v95, v101
    v_fmac_f32 v70, v96, v101
    v_fmac_f32 v71, v97, v101
    v_fmac_f32 v64, v91, v100
    v_fmac_f32 v65, v92, v100
    v_fmac_f32 v66, v93, v100
    v_fmac_f32 v67, v94, v100
    v_fmac_f32 v68, v95, v100
    v_fmac_f32 v69, v96, v100
    v_fmac_f32 v70, v97, v100
    v_fmac_f32 v71, v98, v100
    v_lshlrev_b32 v100, 16, v216
    v_and_b32 v101, 0xffff0000, v216
    v_lshlrev_b32 v102, 16, v217
    v_and_b32 v103, 0xffff0000, v217
    v_lshlrev_b32 v88, 16, v131
    v_lshlrev_b32 v89, 16, v135
    v_lshlrev_b32 v90, 16, v139
    v_lshlrev_b32 v91, 16, v143
    v_lshlrev_b32 v92, 16, v147
    v_lshlrev_b32 v93, 16, v151
    v_lshlrev_b32 v94, 16, v155
    v_lshlrev_b32 v95, 16, v159
    v_lshlrev_b32 v96, 16, v163
    v_lshlrev_b32 v97, 16, v167
    v_lshlrev_b32 v98, 16, v171
    v_mul_f32 v72, v88, v103
    v_mul_f32 v73, v89, v103
    v_mul_f32 v74, v90, v103
    v_mul_f32 v75, v91, v103
    v_mul_f32 v76, v92, v103
    v_mul_f32 v77, v93, v103
    v_mul_f32 v78, v94, v103
    v_mul_f32 v79, v95, v103
    v_fmac_f32 v72, v89, v102
    v_fmac_f32 v73, v90, v102
    v_fmac_f32 v74, v91, v102
    v_fmac_f32 v75, v92, v102
    v_fmac_f32 v76, v93, v102
    v_fmac_f32 v77, v94, v102
    v_fmac_f32 v78, v95, v102
    v_fmac_f32 v79, v96, v102
    v_fmac_f32 v72, v90, v101
    v_fmac_f32 v73, v91, v101
    v_fmac_f32 v74, v92, v101
    v_fmac_f32 v75, v93, v101
    v_fmac_f32 v76, v94, v101
    v_fmac_f32 v77, v95, v101
    v_fmac_f32 v78, v96, v101
    v_fmac_f32 v79, v97, v101
    v_fmac_f32 v72, v91, v100
    v_fmac_f32 v73, v92, v100
    v_fmac_f32 v74, v93, v100
    v_fmac_f32 v75, v94, v100
    v_fmac_f32 v76, v95, v100
    v_fmac_f32 v77, v96, v100
    v_fmac_f32 v78, v97, v100
    v_fmac_f32 v79, v98, v100
    v_lshlrev_b32 v100, 16, v218
    v_and_b32 v101, 0xffff0000, v218
    v_lshlrev_b32 v102, 16, v219
    v_and_b32 v103, 0xffff0000, v219
    v_and_b32 v88, 0xffff0000, v131
    v_and_b32 v89, 0xffff0000, v135
    v_and_b32 v90, 0xffff0000, v139
    v_and_b32 v91, 0xffff0000, v143
    v_and_b32 v92, 0xffff0000, v147
    v_and_b32 v93, 0xffff0000, v151
    v_and_b32 v94, 0xffff0000, v155
    v_and_b32 v95, 0xffff0000, v159
    v_and_b32 v96, 0xffff0000, v163
    v_and_b32 v97, 0xffff0000, v167
    v_and_b32 v98, 0xffff0000, v171
    v_mul_f32 v80, v88, v103
    v_mul_f32 v81, v89, v103
    v_mul_f32 v82, v90, v103
    v_mul_f32 v83, v91, v103
    v_mul_f32 v84, v92, v103
    v_mul_f32 v85, v93, v103
    v_mul_f32 v86, v94, v103
    v_mul_f32 v87, v95, v103
    v_fmac_f32 v80, v89, v102
    v_fmac_f32 v81, v90, v102
    v_fmac_f32 v82, v91, v102
    v_fmac_f32 v83, v92, v102
    v_fmac_f32 v84, v93, v102
    v_fmac_f32 v85, v94, v102
    v_fmac_f32 v86, v95, v102
    v_fmac_f32 v87, v96, v102
    v_fmac_f32 v80, v90, v101
    v_fmac_f32 v81, v91, v101
    v_fmac_f32 v82, v92, v101
    v_fmac_f32 v83, v93, v101
    v_fmac_f32 v84, v94, v101
    v_fmac_f32 v85, v95, v101
    v_fmac_f32 v86, v96, v101
    v_fmac_f32 v87, v97, v101
    v_fmac_f32 v80, v91, v100
    v_fmac_f32 v81, v92, v100
    v_fmac_f32 v82, v93, v100
    v_fmac_f32 v83, v94, v100
    v_fmac_f32 v84, v95, v100
    v_fmac_f32 v85, v96, v100
    v_fmac_f32 v86, v97, v100
    v_fmac_f32 v87, v98, v100
    s_and_b32 s65, s48, 1
    s_lshl_b32 s65, s65, 11
    v_add_u32 v13, s65, v5
    v_subrev_u32 v14, 8, v13
    v_add_u32 v15, 1016, v13
    s_lshr_b32 s65, s48, 1
    s_lshl_b32 s66, s0, 1
    s_add_u32 s65, s65, s66
    s_lshl_b32 s65, s65, 12
    buffer_load_dwordx4 v[114:117], v13, s[40:43], s65 offen
    buffer_load_dwordx2 v[112:113], v14, s[40:43], s65 offen
    buffer_load_dwordx4 v[120:123], v13, s[40:43], s65 offen offset:1024
    buffer_load_dwordx2 v[118:119], v15, s[40:43], s65 offen
    s_waitcnt vmcnt(4)
    v_lshlrev_b32 v88, 16, v172
    v_lshlrev_b32 v89, 16, v176
    v_lshlrev_b32 v90, 16, v180
    v_lshlrev_b32 v91, 16, v184
    v_lshlrev_b32 v92, 16, v188
    v_lshlrev_b32 v93, 16, v192
    v_lshlrev_b32 v94, 16, v196
    v_lshlrev_b32 v95, 16, v200
    v_mul_f32 v24, v24, v88
    v_mul_f32 v25, v25, v89
    v_mul_f32 v26, v26, v90
    v_mul_f32 v27, v27, v91
    v_mul_f32 v28, v28, v92
    v_mul_f32 v29, v29, v93
    v_mul_f32 v30, v30, v94
    v_mul_f32 v31, v31, v95
    v_cvt_pk_bf16_f32 v104, v31, v30
    v_cvt_pk_bf16_f32 v105, v29, v28
    v_cvt_pk_bf16_f32 v106, v27, v26
    v_cvt_pk_bf16_f32 v107, v25, v24
    ds_bpermute_b32 v128, v252, v104
    ds_bpermute_b32 v129, v252, v105
    ds_bpermute_b32 v130, v252, v106
    ds_bpermute_b32 v131, v252, v107
    v_and_b32 v88, 0xffff0000, v172
    v_and_b32 v89, 0xffff0000, v176
    v_and_b32 v90, 0xffff0000, v180
    v_and_b32 v91, 0xffff0000, v184
    v_and_b32 v92, 0xffff0000, v188
    v_and_b32 v93, 0xffff0000, v192
    v_and_b32 v94, 0xffff0000, v196
    v_and_b32 v95, 0xffff0000, v200
    v_mul_f32 v32, v32, v88
    v_mul_f32 v33, v33, v89
    v_mul_f32 v34, v34, v90
    v_mul_f32 v35, v35, v91
    v_mul_f32 v36, v36, v92
    v_mul_f32 v37, v37, v93
    v_mul_f32 v38, v38, v94
    v_mul_f32 v39, v39, v95
    v_cvt_pk_bf16_f32 v108, v39, v38
    v_cvt_pk_bf16_f32 v109, v37, v36
    v_cvt_pk_bf16_f32 v110, v35, v34
    v_cvt_pk_bf16_f32 v111, v33, v32
    s_waitcnt lgkmcnt(0)
    buffer_store_dwordx4 v[128:131], v253, s[8:11], s64 offen sc1
    s_add_u32 s64, s64, 4096
    ds_bpermute_b32 v132, v252, v108
    ds_bpermute_b32 v133, v252, v109
    ds_bpermute_b32 v134, v252, v110
    ds_bpermute_b32 v135, v252, v111
    v_lshlrev_b32 v88, 16, v173
    v_lshlrev_b32 v89, 16, v177
    v_lshlrev_b32 v90, 16, v181
    v_lshlrev_b32 v91, 16, v185
    v_lshlrev_b32 v92, 16, v189
    v_lshlrev_b32 v93, 16, v193
    v_lshlrev_b32 v94, 16, v197
    v_lshlrev_b32 v95, 16, v201
    v_mul_f32 v40, v40, v88
    v_mul_f32 v41, v41, v89
    v_mul_f32 v42, v42, v90
    v_mul_f32 v43, v43, v91
    v_mul_f32 v44, v44, v92
    v_mul_f32 v45, v45, v93
    v_mul_f32 v46, v46, v94
    v_mul_f32 v47, v47, v95
    v_cvt_pk_bf16_f32 v104, v47, v46
    v_cvt_pk_bf16_f32 v105, v45, v44
    v_cvt_pk_bf16_f32 v106, v43, v42
    v_cvt_pk_bf16_f32 v107, v41, v40
    s_waitcnt lgkmcnt(0)
    buffer_store_dwordx4 v[132:135], v253, s[8:11], s64 offen sc1
    s_add_u32 s64, s64, 4096
    ds_bpermute_b32 v136, v252, v104
    ds_bpermute_b32 v137, v252, v105
    ds_bpermute_b32 v138, v252, v106
    ds_bpermute_b32 v139, v252, v107
    v_and_b32 v88, 0xffff0000, v173
    v_and_b32 v89, 0xffff0000, v177
    v_and_b32 v90, 0xffff0000, v181
    v_and_b32 v91, 0xffff0000, v185
    v_and_b32 v92, 0xffff0000, v189
    v_and_b32 v93, 0xffff0000, v193
    v_and_b32 v94, 0xffff0000, v197
    v_and_b32 v95, 0xffff0000, v201
    v_mul_f32 v48, v48, v88
    v_mul_f32 v49, v49, v89
    v_mul_f32 v50, v50, v90
    v_mul_f32 v51, v51, v91
    v_mul_f32 v52, v52, v92
    v_mul_f32 v53, v53, v93
    v_mul_f32 v54, v54, v94
    v_mul_f32 v55, v55, v95
    v_cvt_pk_bf16_f32 v108, v55, v54
    v_cvt_pk_bf16_f32 v109, v53, v52
    v_cvt_pk_bf16_f32 v110, v51, v50
    v_cvt_pk_bf16_f32 v111, v49, v48
    s_waitcnt lgkmcnt(0)
    buffer_store_dwordx4 v[136:139], v253, s[8:11], s64 offen sc1
    s_add_u32 s64, s64, 4096
    ds_bpermute_b32 v140, v252, v108
    ds_bpermute_b32 v141, v252, v109
    ds_bpermute_b32 v142, v252, v110
    ds_bpermute_b32 v143, v252, v111
    v_lshlrev_b32 v88, 16, v174
    v_lshlrev_b32 v89, 16, v178
    v_lshlrev_b32 v90, 16, v182
    v_lshlrev_b32 v91, 16, v186
    v_lshlrev_b32 v92, 16, v190
    v_lshlrev_b32 v93, 16, v194
    v_lshlrev_b32 v94, 16, v198
    v_lshlrev_b32 v95, 16, v202
    v_mul_f32 v56, v56, v88
    v_mul_f32 v57, v57, v89
    v_mul_f32 v58, v58, v90
    v_mul_f32 v59, v59, v91
    v_mul_f32 v60, v60, v92
    v_mul_f32 v61, v61, v93
    v_mul_f32 v62, v62, v94
    v_mul_f32 v63, v63, v95
    v_cvt_pk_bf16_f32 v104, v63, v62
    v_cvt_pk_bf16_f32 v105, v61, v60
    v_cvt_pk_bf16_f32 v106, v59, v58
    v_cvt_pk_bf16_f32 v107, v57, v56
    s_waitcnt lgkmcnt(0)
    buffer_store_dwordx4 v[140:143], v253, s[8:11], s64 offen sc1
    s_add_u32 s64, s64, 4096
    ds_bpermute_b32 v144, v252, v104
    ds_bpermute_b32 v145, v252, v105
    ds_bpermute_b32 v146, v252, v106
    ds_bpermute_b32 v147, v252, v107
    v_and_b32 v88, 0xffff0000, v174
    v_and_b32 v89, 0xffff0000, v178
    v_and_b32 v90, 0xffff0000, v182
    v_and_b32 v91, 0xffff0000, v186
    v_and_b32 v92, 0xffff0000, v190
    v_and_b32 v93, 0xffff0000, v194
    v_and_b32 v94, 0xffff0000, v198
    v_and_b32 v95, 0xffff0000, v202
    v_mul_f32 v64, v64, v88
    v_mul_f32 v65, v65, v89
    v_mul_f32 v66, v66, v90
    v_mul_f32 v67, v67, v91
    v_mul_f32 v68, v68, v92
    v_mul_f32 v69, v69, v93
    v_mul_f32 v70, v70, v94
    v_mul_f32 v71, v71, v95
    v_cvt_pk_bf16_f32 v108, v71, v70
    v_cvt_pk_bf16_f32 v109, v69, v68
    v_cvt_pk_bf16_f32 v110, v67, v66
    v_cvt_pk_bf16_f32 v111, v65, v64
    s_waitcnt lgkmcnt(0)
    buffer_store_dwordx4 v[144:147], v253, s[8:11], s64 offen sc1
    s_add_u32 s64, s64, 4096
    ds_bpermute_b32 v148, v252, v108
    ds_bpermute_b32 v149, v252, v109
    ds_bpermute_b32 v150, v252, v110
    ds_bpermute_b32 v151, v252, v111
    v_lshlrev_b32 v88, 16, v175
    v_lshlrev_b32 v89, 16, v179
    v_lshlrev_b32 v90, 16, v183
    v_lshlrev_b32 v91, 16, v187
    v_lshlrev_b32 v92, 16, v191
    v_lshlrev_b32 v93, 16, v195
    v_lshlrev_b32 v94, 16, v199
    v_lshlrev_b32 v95, 16, v203
    v_mul_f32 v72, v72, v88
    v_mul_f32 v73, v73, v89
    v_mul_f32 v74, v74, v90
    v_mul_f32 v75, v75, v91
    v_mul_f32 v76, v76, v92
    v_mul_f32 v77, v77, v93
    v_mul_f32 v78, v78, v94
    v_mul_f32 v79, v79, v95
    v_cvt_pk_bf16_f32 v104, v79, v78
    v_cvt_pk_bf16_f32 v105, v77, v76
    v_cvt_pk_bf16_f32 v106, v75, v74
    v_cvt_pk_bf16_f32 v107, v73, v72
    s_waitcnt lgkmcnt(0)
    buffer_store_dwordx4 v[148:151], v253, s[8:11], s64 offen sc1
    s_add_u32 s64, s64, 4096
    ds_bpermute_b32 v152, v252, v104
    ds_bpermute_b32 v153, v252, v105
    ds_bpermute_b32 v154, v252, v106
    ds_bpermute_b32 v155, v252, v107
    v_and_b32 v88, 0xffff0000, v175
    v_and_b32 v89, 0xffff0000, v179
    v_and_b32 v90, 0xffff0000, v183
    v_and_b32 v91, 0xffff0000, v187
    v_and_b32 v92, 0xffff0000, v191
    v_and_b32 v93, 0xffff0000, v195
    v_and_b32 v94, 0xffff0000, v199
    v_and_b32 v95, 0xffff0000, v203
    v_mul_f32 v80, v80, v88
    v_mul_f32 v81, v81, v89
    v_mul_f32 v82, v82, v90
    v_mul_f32 v83, v83, v91
    v_mul_f32 v84, v84, v92
    v_mul_f32 v85, v85, v93
    v_mul_f32 v86, v86, v94
    v_mul_f32 v87, v87, v95
    v_cvt_pk_bf16_f32 v108, v87, v86
    v_cvt_pk_bf16_f32 v109, v85, v84
    v_cvt_pk_bf16_f32 v110, v83, v82
    v_cvt_pk_bf16_f32 v111, v81, v80
    s_waitcnt lgkmcnt(0)
    buffer_store_dwordx4 v[152:155], v253, s[8:11], s64 offen sc1
    s_add_u32 s64, s64, 4096
    ds_bpermute_b32 v156, v252, v108
    ds_bpermute_b32 v157, v252, v109
    ds_bpermute_b32 v158, v252, v110
    ds_bpermute_b32 v159, v252, v111
    s_waitcnt lgkmcnt(0)
    buffer_store_dwordx4 v[156:159], v253, s[8:11], s64 offen sc1
    s_add_u32 s64, s64, 4096
    s_waitcnt vmcnt(8)
    s_lshr_b32 s65, s48, 1
    s_mul_i32 s65, s65, 16640
    s_add_u32 s65, s65, 32
    v_add_u32 v13, s65, v13
    v_alignbyte_b32 v76, v114, v113, 2
    v_alignbyte_b32 v77, v115, v114, 2
    v_alignbyte_b32 v78, v116, v115, 2
    v_alignbyte_b32 v79, v117, v116, 2
    v_mov_b32 v104, v113
    v_mov_b32 v105, v114
    v_mov_b32 v106, v115
    v_mov_b32 v107, v116
    v_alignbyte_b32 v84, v113, v112, 2
    v_alignbyte_b32 v85, v114, v113, 2
    v_alignbyte_b32 v86, v115, v114, 2
    v_alignbyte_b32 v87, v116, v115, 2
    v_alignbyte_b32 v80, v120, v119, 2
    v_alignbyte_b32 v81, v121, v120, 2
    v_alignbyte_b32 v82, v122, v121, 2
    v_alignbyte_b32 v83, v123, v122, 2
    v_mov_b32 v108, v119
    v_mov_b32 v109, v120
    v_mov_b32 v110, v121
    v_mov_b32 v111, v122
    v_alignbyte_b32 v88, v119, v118, 2
    v_alignbyte_b32 v89, v120, v119, 2
    v_alignbyte_b32 v90, v121, v120, 2
    v_alignbyte_b32 v91, v122, v121, 2
    ds_write_b128 v13, v[114:117] offset:0
    ds_write_b128 v13, v[76:79] offset:4160
    ds_write_b128 v13, v[104:107] offset:8320
    ds_write_b128 v13, v[84:87] offset:12480
    ds_write_b128 v13, v[120:123] offset:1024
    ds_write_b128 v13, v[80:83] offset:5184
    ds_write_b128 v13, v[108:111] offset:9344
    ds_write_b128 v13, v[88:91] offset:13504
    v_min_u32 v11, 1, v0
    v_lshlrev_b32 v11, 30, v11
    s_sub_u32 s65, s2, 224
    s_lshl_b32 s65, s65, 7
    s_lshl_b32 s66, s49, 12
    s_add_u32 s65, s65, s66
    s_add_u32 s65, s65, 65536
    s_waitcnt vmcnt(0)
    buffer_store_dword v10, v11, s[8:11], s65 offen sc1
    s_waitcnt lgkmcnt(0)
    s_lshr_b32 s55, s52, 6
    s_add_u32 s65, s3, 0
    s_and_b32 s65, s65, 3
    s_add_u32 s55, s55, s65
    s_xor_b32 s56, s56, 4
    v_and_b32 v16, 15, v0
    v_sub_u32 v17, 15, v16
    v_and_b32 v17, 3, v17
    v_add_u32 v8, v16, v17
    v_lshlrev_b32 v8, 1, v8
    v_mul_u32_u24 v17, 4160, v17
    v_add_u32 v8, v8, v17
    v_lshrrev_b32 v17, 4, v0
    v_lshl_add_u32 v8, v17, 4, v8
    s_lshr_b32 s65, s48, 1
    s_mul_i32 s66, s65, 16640
    s_and_b32 s67, s48, 1
    s_lshl_b32 s67, s67, 8
    s_add_u32 s66, s66, s67
    s_add_u32 s66, s66, 2
    v_add_u32 v8, s66, v8
    v_lshlrev_b32 v9, 4, v17
    v_lshlrev_b32 v16, 5, v16
    v_sub_u32 v9, v9, v16
    s_mul_i32 s66, s65, 5120
    s_add_u32 s66, s66, s67
    s_add_u32 s66, s66, 151008
    v_add_u32 v9, s66, v9
    v_lshlrev_b32 v15, 4, v0
    v_min_u32 v11, 1, v0
    v_lshlrev_b32 v11, 30, v11
    v_bfe_u32 v16, v0, 4, 1
    v_lshlrev_b32 v12, 9, v16
    v_lshrrev_b32 v16, 5, v0
    v_lshl_add_u32 v12, v16, 4, v12
    v_and_b32 v16, 15, v0
    v_lshl_add_u32 v12, v16, 5, v12
    s_lshl_b32 s34, s0, 13
    s_lshr_b32 s66, s48, 1
    s_lshl_b32 s66, s66, 12
    s_add_u32 s34, s34, s66
    s_add_u32 s34, s34, 3145728
    v_lshrrev_b32 v16, 3, v0
    v_mul_u32_u24 v16, 384, v16
    v_add_u32 v16, v16, v15
    s_lshr_b32 s66, s48, 1
    s_mul_i32 s66, s66, 16640
    s_add_u32 s66, s66, 96
    v_add_u32 v16, s66, v16
    v_add_u32 v13, s67, v16
    s_xor_b32 s67, s67, 256
    v_add_u32 v14, s67, v16
    s_lshr_b32 s67, s67, 8
    s_lshl_b32 s67, s67, 10
    v_bfe_u32 v16, v0, 4, 1
    v_mad_u32_u24 v12, v16, s67, v12
    s_lshl_b32 s66, s48, 2
    s_add_u32 s66, s66, 155136
    v_mov_b32 v5, s66
    s_mov_b32 s18, 2097152
    s_mov_b32 s19, 0x00020000
    s_and_b32 s65, s48, 1
    s_lshl_b32 s65, s65, 15
    s_lshr_b32 s66, s48, 1
    s_lshl_b32 s66, s66, 2
    s_add_u32 s65, s65, s66
    s_lshl_b32 s66, s0, 7
    s_add_u32 s65, s65, s66
    s_add_u32 s71, s65, 131072
    s_lshr_b32 s66, s48, 1
    s_lshl_b32 s66, s66, 4
    s_lshr_b32 s66, s46, s66
    s_and_b32 s66, s66, 0xffff
    v_and_b32 v110, 15, v0
    v_lshrrev_b32 v111, 4, v0
    v_lshl_add_u32 v110, v111, 3, v110
    s_and_b32 s67, s48, 1
    s_lshl_b32 s67, s67, 6
    s_sub_u32 s67, 15, s67
    v_sub_u32 v110, s67, v110
    v_subrev_u32 v111, 0, v110
    v_med3_i32 v111, v111, 0, 2
    v_lshlrev_b32 v111, 3, v111
    v_lshlrev_b32 v100, v111, -1
    v_lshlrev_b32 v100, v111, v100
    v_subrev_u32 v111, 2, v110
    v_med3_i32 v111, v111, 0, 2
    v_lshlrev_b32 v111, 3, v111
    v_lshlrev_b32 v101, v111, -1
    v_lshlrev_b32 v101, v111, v101
    v_subrev_u32 v111, 4, v110
    v_med3_i32 v111, v111, 0, 2
    v_lshlrev_b32 v111, 3, v111
    v_lshlrev_b32 v102, v111, -1
    v_lshlrev_b32 v102, v111, v102
    v_subrev_u32 v111, 6, v110
    v_med3_i32 v111, v111, 0, 2
    v_lshlrev_b32 v111, 3, v111
    v_lshlrev_b32 v103, v111, -1
    v_lshlrev_b32 v103, v111, v103
    v_and_b32 v111, 1, v110
    v_lshlrev_b32 v111, 4, v111
    v_lshlrev_b32 v111, v111, s66
    v_ashrrev_i32 v110, 1, v110
    v_cmp_eq_u32 s[68:69], 0, v110
    s_nop 1
    v_cndmask_b32 v96, 0, v111, s[68:69]
    v_cmp_eq_u32 s[68:69], 1, v110
    s_nop 1
    v_cndmask_b32 v97, 0, v111, s[68:69]
    v_cmp_eq_u32 s[68:69], 2, v110
    s_nop 1
    v_cndmask_b32 v98, 0, v111, s[68:69]
    v_cmp_eq_u32 s[68:69], 3, v110
    s_nop 1
    v_cndmask_b32 v99, 0, v111, s[68:69]
    v_xor_b32 v104, 36, v5
    v_mov_b32 v105, 1
    s_setprio 2
    s_barrier
    ds_read_b64 v[128:129], v8 offset:64
    ds_read_b64 v[130:131], v8 offset:72
    ds_read_b128 v[132:135], v9 offset:3648
    ds_read_b128 v[136:139], v9 offset:3136
    ds_read_b64 v[140:141], v8 offset:576
    ds_read_b64 v[142:143], v8 offset:584
    ds_read_b128 v[144:147], v9 offset:2624
    ds_read_b64 v[148:149], v8 offset:1088
    ds_read_b64 v[150:151], v8 offset:1096
    ds_read_b128 v[152:155], v9 offset:2112
    ds_read_b64 v[156:157], v8 offset:1600
    ds_read_b64 v[158:159], v8 offset:1608
    ds_read_b128 v[160:163], v9 offset:1600
    s_lshl_b32 s40, s55, 16
    s_waitcnt lgkmcnt(7)
    v_mfma_f32_16x16x32_bf16 v[16:19], v[128:131], v[132:135], 0
    s_add_u32 s40, s40, s63
    v_mfma_f32_16x16x32_bf16 v[20:23], v[128:131], v[136:139], 0
    s_lshl_b32 s65, s56, 7
    v_mfma_f32_16x16x32_bf16 v[20:23], v[140:143], v[132:135], v[20:23]
    s_add_u32 s40, s40, s65
    s_waitcnt lgkmcnt(4)
    v_mfma_f32_16x16x32_bf16 v[24:27], v[128:131], v[144:147], 0
    ds_read_b64 v[164:165], v8 offset:2112
    ds_read_b64 v[166:167], v8 offset:2120
    s_add_u32 s41, s40, 32768
    v_mfma_f32_16x16x32_bf16 v[24:27], v[140:143], v[136:139], v[24:27]
    ds_read_b128 v[168:171], v9 offset:1088
    s_lshl_b32 s42, s55, 10
    v_mfma_f32_16x16x32_bf16 v[24:27], v[148:151], v[132:135], v[24:27]
    s_lshl_b32 s65, s48, 7
    s_waitcnt lgkmcnt(6)
    v_mfma_f32_16x16x32_bf16 v[28:31], v[128:131], v[152:155], 0
    s_add_u32 s42, s42, s65
    v_mfma_f32_16x16x32_bf16 v[28:31], v[140:143], v[144:147], v[28:31]
    s_add_u32 s42, s42, 32768
    v_mfma_f32_16x16x32_bf16 v[28:31], v[148:151], v[136:139], v[28:31]
    v_lshrrev_b32 v108, 3, v0
    s_waitcnt lgkmcnt(3)
    v_mfma_f32_16x16x32_bf16 v[28:31], v[156:159], v[132:135], v[28:31]
    ds_read_b64 v[172:173], v8 offset:2624
    ds_read_b64 v[174:175], v8 offset:2632
    v_and_b32 v107, 7, v0
    v_mfma_f32_16x16x32_bf16 v[32:35], v[128:131], v[160:163], 0
    ds_read_b128 v[176:179], v9 offset:576
    v_lshlrev_b32 v107, 4, v107
    v_mfma_f32_16x16x32_bf16 v[32:35], v[140:143], v[152:155], v[32:35]
    v_lshl_add_u32 v107, v108, 10, v107
    v_mfma_f32_16x16x32_bf16 v[32:35], v[148:151], v[144:147], v[32:35]
    ds_read_b64 v[180:181], v8 offset:3136
    ds_read_b64 v[182:183], v8 offset:3144
    v_lshlrev_b32 v108, 4, v108
    v_mfma_f32_16x16x32_bf16 v[32:35], v[156:159], v[136:139], v[32:35]
    s_waitcnt lgkmcnt(5)
    v_mfma_f32_16x16x32_bf16 v[32:35], v[164:167], v[132:135], v[32:35]
    v_mfma_f32_16x16x32_bf16 v[36:39], v[128:131], v[168:171], 0
    ds_read_b128 v[184:187], v9 offset:64
    v_mfma_f32_16x16x32_bf16 v[36:39], v[140:143], v[160:163], v[36:39]
    ds_read_b64 v[188:189], v8 offset:3648
    ds_read_b64 v[190:191], v8 offset:3656
    v_mfma_f32_16x16x32_bf16 v[36:39], v[148:151], v[152:155], v[36:39]
    v_mfma_f32_16x16x32_bf16 v[36:39], v[156:159], v[144:147], v[36:39]
    v_mfma_f32_16x16x32_bf16 v[36:39], v[164:167], v[136:139], v[36:39]
    ds_read_b64 v[192:193], v8 offset:128
    ds_read_b64 v[194:195], v8 offset:136
    s_waitcnt lgkmcnt(7)
    v_mfma_f32_16x16x32_bf16 v[36:39], v[172:175], v[132:135], v[36:39]
    v_mfma_f32_16x16x32_bf16 v[40:43], v[128:131], v[176:179], 0
    ds_read_b128 v[196:199], v9 offset:3712
    v_mfma_f32_16x16x32_bf16 v[40:43], v[140:143], v[168:171], v[40:43]
    ds_read_b128 v[200:203], v9 offset:3200
    v_mfma_f32_16x16x32_bf16 v[40:43], v[148:151], v[160:163], v[40:43]
    ds_read_b64 v[204:205], v8 offset:640
    ds_read_b64 v[206:207], v8 offset:648
    v_mfma_f32_16x16x32_bf16 v[40:43], v[156:159], v[152:155], v[40:43]
    v_mfma_f32_16x16x32_bf16 v[40:43], v[164:167], v[144:147], v[40:43]
    v_mfma_f32_16x16x32_bf16 v[40:43], v[172:175], v[136:139], v[40:43]
    ds_read_b128 v[208:211], v9 offset:2688
    s_waitcnt lgkmcnt(9)
    v_mfma_f32_16x16x32_bf16 v[40:43], v[180:183], v[132:135], v[40:43]
    ds_read_b64 v[212:213], v8 offset:1152
    ds_read_b64 v[214:215], v8 offset:1160
    v_mfma_f32_16x16x32_bf16 v[44:47], v[128:131], v[184:187], 0
    v_mfma_f32_16x16x32_bf16 v[44:47], v[140:143], v[176:179], v[44:47]
    ds_read_b128 v[216:219], v9 offset:2176
    v_mfma_f32_16x16x32_bf16 v[44:47], v[148:151], v[168:171], v[44:47]
    v_mfma_f32_16x16x32_bf16 v[44:47], v[156:159], v[160:163], v[44:47]
    ds_read_b64 v[220:221], v8 offset:1664
    ds_read_b64 v[222:223], v8 offset:1672
    v_mfma_f32_16x16x32_bf16 v[44:47], v[164:167], v[152:155], v[44:47]
    v_mfma_f32_16x16x32_bf16 v[44:47], v[172:175], v[144:147], v[44:47]
    v_mfma_f32_16x16x32_bf16 v[44:47], v[180:183], v[136:139], v[44:47]
    s_waitcnt lgkmcnt(8)
    v_mfma_f32_16x16x32_bf16 v[44:47], v[188:191], v[132:135], v[44:47]
    ds_read_b128 v[224:227], v9 offset:1664
    ds_read_b64 v[228:229], v8 offset:2176
    ds_read_b64 v[230:231], v8 offset:2184
    v_mfma_f32_16x16x32_bf16 v[16:19], v[192:195], v[196:199], v[16:19]
    v_mfma_f32_16x16x32_bf16 v[20:23], v[192:195], v[200:203], v[20:23]
    ds_read_b128 v[232:235], v9 offset:1152
    s_waitcnt lgkmcnt(9)
    v_mfma_f32_16x16x32_bf16 v[20:23], v[204:207], v[196:199], v[20:23]
    ds_read_b64 v[236:237], v8 offset:2688
    ds_read_b64 v[238:239], v8 offset:2696
    v_mfma_f32_16x16x32_bf16 v[24:27], v[192:195], v[208:211], v[24:27]
    v_mfma_f32_16x16x32_bf16 v[24:27], v[204:207], v[200:203], v[24:27]
    ds_read_b128 v[240:243], v9 offset:640
    s_waitcnt lgkmcnt(9)
    v_mfma_f32_16x16x32_bf16 v[24:27], v[212:215], v[196:199], v[24:27]
    ds_read_b64 v[244:245], v8 offset:3200
    ds_read_b64 v[246:247], v8 offset:3208
    v_mfma_f32_16x16x32_bf16 v[28:31], v[192:195], v[216:219], v[28:31]
    v_mfma_f32_16x16x32_bf16 v[28:31], v[204:207], v[208:211], v[28:31]
    v_mfma_f32_16x16x32_bf16 v[28:31], v[212:215], v[200:203], v[28:31]
    ds_read_b128 v[248:251], v9 offset:128
    s_waitcnt lgkmcnt(9)
    v_mfma_f32_16x16x32_bf16 v[28:31], v[220:223], v[196:199], v[28:31]
    ds_read_b64 v[252:253], v8 offset:3712
    ds_read_b64 v[254:255], v8 offset:3720
    v_mfma_f32_16x16x32_bf16 v[32:35], v[192:195], v[224:227], v[32:35]
    v_mfma_f32_16x16x32_bf16 v[32:35], v[204:207], v[216:219], v[32:35]
    v_mfma_f32_16x16x32_bf16 v[32:35], v[212:215], v[208:211], v[32:35]
    ds_read_b64 v[128:129], v8 offset:192
    ds_read_b64 v[130:131], v8 offset:200
    v_mfma_f32_16x16x32_bf16 v[32:35], v[220:223], v[200:203], v[32:35]
    s_waitcnt lgkmcnt(10)
    v_mfma_f32_16x16x32_bf16 v[32:35], v[228:231], v[196:199], v[32:35]
    ds_read_b128 v[184:187], v9 offset:3776
    v_mfma_f32_16x16x32_bf16 v[36:39], v[192:195], v[232:235], v[36:39]
    ds_read_b128 v[140:143], v9 offset:3264
    v_mfma_f32_16x16x32_bf16 v[36:39], v[204:207], v[224:227], v[36:39]
    ds_read_b64 v[176:177], v8 offset:704
    ds_read_b64 v[178:179], v8 offset:712
    v_mfma_f32_16x16x32_bf16 v[36:39], v[212:215], v[216:219], v[36:39]
    v_mfma_f32_16x16x32_bf16 v[36:39], v[220:223], v[208:211], v[36:39]
    v_mfma_f32_16x16x32_bf16 v[36:39], v[228:231], v[200:203], v[36:39]
    s_waitcnt lgkmcnt(11)
    v_mfma_f32_16x16x32_bf16 v[36:39], v[236:239], v[196:199], v[36:39]
    ds_read_b128 v[148:151], v9 offset:2752
    ds_read_b64 v[168:169], v8 offset:1216
    ds_read_b64 v[170:171], v8 offset:1224
    v_mfma_f32_16x16x32_bf16 v[40:43], v[192:195], v[240:243], v[40:43]
    v_mfma_f32_16x16x32_bf16 v[40:43], v[204:207], v[232:235], v[40:43]
    v_mfma_f32_16x16x32_bf16 v[40:43], v[212:215], v[224:227], v[40:43]
    v_mfma_f32_16x16x32_bf16 v[40:43], v[220:223], v[216:219], v[40:43]
    v_mfma_f32_16x16x32_bf16 v[40:43], v[228:231], v[208:211], v[40:43]
    v_mfma_f32_16x16x32_bf16 v[40:43], v[236:239], v[200:203], v[40:43]
    s_waitcnt lgkmcnt(11)
    v_mfma_f32_16x16x32_bf16 v[40:43], v[244:247], v[196:199], v[40:43]
    ds_read_b128 v[156:159], v9 offset:2240
    ds_read_b64 v[160:161], v8 offset:1728
    ds_read_b64 v[162:163], v8 offset:1736
    v_mfma_f32_16x16x32_bf16 v[44:47], v[192:195], v[248:251], v[44:47]
    v_mfma_f32_16x16x32_bf16 v[44:47], v[204:207], v[240:243], v[44:47]
    v_mfma_f32_16x16x32_bf16 v[44:47], v[212:215], v[232:235], v[44:47]
    v_mfma_f32_16x16x32_bf16 v[44:47], v[220:223], v[224:227], v[44:47]
    v_mfma_f32_16x16x32_bf16 v[44:47], v[228:231], v[216:219], v[44:47]
    v_mfma_f32_16x16x32_bf16 v[44:47], v[236:239], v[208:211], v[44:47]
    v_mfma_f32_16x16x32_bf16 v[44:47], v[244:247], v[200:203], v[44:47]
    s_waitcnt lgkmcnt(8)
    v_mfma_f32_16x16x32_bf16 v[44:47], v[252:255], v[196:199], v[44:47]
    ds_read_b128 v[164:167], v9 offset:1728
    ds_read_b64 v[152:153], v8 offset:2240
    ds_read_b64 v[154:155], v8 offset:2248
    ds_read_b128 v[172:175], v9 offset:1216
    ds_read_b64 v[144:145], v8 offset:2752
    ds_read_b64 v[146:147], v8 offset:2760
    v_mfma_f32_16x16x32_bf16 v[16:19], v[128:131], v[184:187], v[16:19]
    v_mfma_f32_16x16x32_bf16 v[20:23], v[128:131], v[140:143], v[20:23]
    s_waitcnt lgkmcnt(11)
    v_mfma_f32_16x16x32_bf16 v[20:23], v[176:179], v[184:187], v[20:23]
    ds_read_b128 v[180:183], v9 offset:704
    ds_read_b64 v[136:137], v8 offset:3264
    ds_read_b64 v[138:139], v8 offset:3272
    v_mfma_f32_16x16x32_bf16 v[24:27], v[128:131], v[148:151], v[24:27]
    v_mfma_f32_16x16x32_bf16 v[24:27], v[176:179], v[140:143], v[24:27]
    s_waitcnt lgkmcnt(11)
    v_mfma_f32_16x16x32_bf16 v[24:27], v[168:171], v[184:187], v[24:27]
    ds_read_b128 v[188:191], v9 offset:192
    ds_read_b64 v[132:133], v8 offset:3776
    ds_read_b64 v[134:135], v8 offset:3784
    v_mfma_f32_16x16x32_bf16 v[28:31], v[128:131], v[156:159], v[28:31]
    v_mfma_f32_16x16x32_bf16 v[28:31], v[176:179], v[148:151], v[28:31]
    v_mfma_f32_16x16x32_bf16 v[28:31], v[168:171], v[140:143], v[28:31]
    s_waitcnt lgkmcnt(11)
    v_mfma_f32_16x16x32_bf16 v[28:31], v[160:163], v[184:187], v[28:31]
    ds_read_b64 v[192:193], v8 offset:0
    ds_read_b64 v[194:195], v8 offset:8
    ds_read_b128 v[248:251], v9 offset:3584
    v_mfma_f32_16x16x32_bf16 v[32:35], v[128:131], v[164:167], v[32:35]
    v_mfma_f32_16x16x32_bf16 v[32:35], v[176:179], v[156:159], v[32:35]
    v_mfma_f32_16x16x32_bf16 v[32:35], v[168:171], v[148:151], v[32:35]
    v_mfma_f32_16x16x32_bf16 v[32:35], v[160:163], v[140:143], v[32:35]
    s_waitcnt lgkmcnt(11)
    v_mfma_f32_16x16x32_bf16 v[32:35], v[152:155], v[184:187], v[32:35]
    ds_read_b64 v[204:205], v8 offset:512
    ds_read_b64 v[206:207], v8 offset:520
    ds_read_b128 v[240:243], v9 offset:3072
    v_mfma_f32_16x16x32_bf16 v[36:39], v[128:131], v[172:175], v[36:39]
    v_mfma_f32_16x16x32_bf16 v[36:39], v[176:179], v[164:167], v[36:39]
    v_mfma_f32_16x16x32_bf16 v[36:39], v[168:171], v[156:159], v[36:39]
    v_mfma_f32_16x16x32_bf16 v[36:39], v[160:163], v[148:151], v[36:39]
    v_mfma_f32_16x16x32_bf16 v[36:39], v[152:155], v[140:143], v[36:39]
    s_waitcnt lgkmcnt(11)
    v_mfma_f32_16x16x32_bf16 v[36:39], v[144:147], v[184:187], v[36:39]
    ds_read_b64 v[212:213], v8 offset:1024
    ds_read_b64 v[214:215], v8 offset:1032
    ds_read_b128 v[232:235], v9 offset:2560
    v_mfma_f32_16x16x32_bf16 v[40:43], v[128:131], v[180:183], v[40:43]
    v_mfma_f32_16x16x32_bf16 v[40:43], v[176:179], v[172:175], v[40:43]
    v_mfma_f32_16x16x32_bf16 v[40:43], v[168:171], v[164:167], v[40:43]
    v_mfma_f32_16x16x32_bf16 v[40:43], v[160:163], v[156:159], v[40:43]
    v_mfma_f32_16x16x32_bf16 v[40:43], v[152:155], v[148:151], v[40:43]
    v_mfma_f32_16x16x32_bf16 v[40:43], v[144:147], v[140:143], v[40:43]
    s_waitcnt lgkmcnt(11)
    v_mfma_f32_16x16x32_bf16 v[40:43], v[136:139], v[184:187], v[40:43]
    ds_read_b64 v[220:221], v8 offset:1536
    ds_read_b64 v[222:223], v8 offset:1544
    ds_read_b128 v[224:227], v9 offset:2048
    v_mfma_f32_16x16x32_bf16 v[44:47], v[128:131], v[188:191], v[44:47]
    v_mfma_f32_16x16x32_bf16 v[44:47], v[176:179], v[180:183], v[44:47]
    v_mfma_f32_16x16x32_bf16 v[44:47], v[168:171], v[172:175], v[44:47]
    v_mfma_f32_16x16x32_bf16 v[44:47], v[160:163], v[164:167], v[44:47]
    v_mfma_f32_16x16x32_bf16 v[44:47], v[152:155], v[156:159], v[44:47]
    v_mfma_f32_16x16x32_bf16 v[44:47], v[144:147], v[148:151], v[44:47]
    v_mfma_f32_16x16x32_bf16 v[44:47], v[136:139], v[140:143], v[44:47]
    s_waitcnt lgkmcnt(12)
    v_mfma_f32_16x16x32_bf16 v[44:47], v[132:135], v[184:187], v[44:47]
    ds_read_b64 v[228:229], v8 offset:2048
    ds_read_b64 v[230:231], v8 offset:2056
    ds_read_b128 v[216:219], v9 offset:1536
    s_waitcnt lgkmcnt(11)
    ds_read_b64 v[236:237], v8 offset:2560
    ds_read_b64 v[238:239], v8 offset:2568
    ds_read_b128 v[208:211], v9 offset:1024
    ds_read_b64 v[244:245], v8 offset:3072
    s_waitcnt lgkmcnt(11)
    ds_read_b64 v[246:247], v8 offset:3080
    ds_read_b128 v[200:203], v9 offset:512
    ds_read_b64 v[252:253], v8 offset:3584
    ds_read_b64 v[254:255], v8 offset:3592
    s_waitcnt lgkmcnt(11)
    ds_read_b128 v[196:199], v9 offset:0
    buffer_load_dwordx4 v[48:51], v107, s[4:7], s40 offen sc1
    buffer_load_dwordx4 v[52:55], v107, s[4:7], s41 offen sc1
    buffer_load_dwordx4 v[56:59], v108, s[8:11], s42 offen offset:0 sc1
    buffer_load_dwordx4 v[60:63], v108, s[8:11], s42 offen offset:512 sc1
    v_and_b32 v192, v192, v100
    v_and_b32 v193, v193, v101
    v_and_b32 v194, v194, v102
    v_and_b32 v195, v195, v103
    s_bitcmp1_b32 s48, 0
    s_cbranch_scc1 L_odd_50
    v_mfma_f32_16x16x32_bf16 v[20:23], v[192:195], v[240:243], v[20:23]
    v_mfma_f32_16x16x32_bf16 v[20:23], v[204:207], v[248:251], v[20:23]
    v_mfma_f32_16x16x32_bf16 v[20:23], v[96:99], v[240:243], v[20:23]
    v_mfma_f32_16x16x32_bf16 v[24:27], v[192:195], v[232:235], v[24:27]
    v_mfma_f32_16x16x32_bf16 v[24:27], v[204:207], v[240:243], v[24:27]
    v_mfma_f32_16x16x32_bf16 v[24:27], v[212:215], v[248:251], v[24:27]
    v_mfma_f32_16x16x32_bf16 v[24:27], v[96:99], v[232:235], v[24:27]
    s_waitcnt lgkmcnt(6)
    v_mfma_f32_16x16x32_bf16 v[36:39], v[192:195], v[208:211], v[36:39]
    v_mfma_f32_16x16x32_bf16 v[36:39], v[204:207], v[216:219], v[36:39]
    v_mfma_f32_16x16x32_bf16 v[36:39], v[212:215], v[224:227], v[36:39]
    v_mfma_f32_16x16x32_bf16 v[36:39], v[220:223], v[232:235], v[36:39]
    v_mfma_f32_16x16x32_bf16 v[36:39], v[228:231], v[240:243], v[36:39]
    v_mfma_f32_16x16x32_bf16 v[36:39], v[236:239], v[248:251], v[36:39]
    v_mfma_f32_16x16x32_bf16 v[36:39], v[96:99], v[208:211], v[36:39]
    s_waitcnt lgkmcnt(3)
    v_mfma_f32_16x16x32_bf16 v[40:43], v[192:195], v[200:203], v[40:43]
    v_mfma_f32_16x16x32_bf16 v[40:43], v[204:207], v[208:211], v[40:43]
    v_mfma_f32_16x16x32_bf16 v[40:43], v[212:215], v[216:219], v[40:43]
    v_mfma_f32_16x16x32_bf16 v[40:43], v[220:223], v[224:227], v[40:43]
    v_mfma_f32_16x16x32_bf16 v[40:43], v[228:231], v[232:235], v[40:43]
    v_mfma_f32_16x16x32_bf16 v[40:43], v[236:239], v[240:243], v[40:43]
    v_mfma_f32_16x16x32_bf16 v[40:43], v[244:247], v[248:251], v[40:43]
    v_mfma_f32_16x16x32_bf16 v[40:43], v[96:99], v[200:203], v[40:43]
    s_waitcnt lgkmcnt(0)
    v_mfma_f32_16x16x32_bf16 v[44:47], v[192:195], v[196:199], v[44:47]
    v_mfma_f32_16x16x32_bf16 v[44:47], v[204:207], v[200:203], v[44:47]
    ds_write_b128 v13, v[20:23] offset:0
    v_mfma_f32_16x16x32_bf16 v[44:47], v[212:215], v[208:211], v[44:47]
    v_mfma_f32_16x16x32_bf16 v[44:47], v[220:223], v[216:219], v[44:47]
    ds_write_b128 v13, v[24:27] offset:4160
    v_mfma_f32_16x16x32_bf16 v[44:47], v[228:231], v[224:227], v[44:47]
    v_mfma_f32_16x16x32_bf16 v[44:47], v[236:239], v[232:235], v[44:47]
    ds_write_b128 v13, v[36:39] offset:8320
    v_mfma_f32_16x16x32_bf16 v[44:47], v[244:247], v[240:243], v[44:47]
    v_mfma_f32_16x16x32_bf16 v[44:47], v[252:255], v[248:251], v[44:47]
    ds_write_b128 v13, v[40:43] offset:12480
    v_mfma_f32_16x16x32_bf16 v[44:47], v[96:99], v[196:199], v[44:47]
    ds_write_b32 v5, v105 offset:32
    v_mfma_f32_16x16x32_bf16 v[32:35], v[192:195], v[216:219], v[32:35]
    v_mfma_f32_16x16x32_bf16 v[32:35], v[204:207], v[224:227], v[32:35]
    v_mfma_f32_16x16x32_bf16 v[32:35], v[212:215], v[232:235], v[32:35]
    v_mfma_f32_16x16x32_bf16 v[32:35], v[220:223], v[240:243], v[32:35]
    v_mfma_f32_16x16x32_bf16 v[32:35], v[228:231], v[248:251], v[32:35]
    v_mfma_f32_16x16x32_bf16 v[32:35], v[96:99], v[216:219], v[32:35]
    ds_read_b32 v106, v104
    ds_read_b128 v[128:131], v14 offset:0
    ds_read_b128 v[188:191], v14 offset:4160
    ds_read_b128 v[176:179], v14 offset:8320
    ds_read_b128 v[180:183], v14 offset:12480
    v_mfma_f32_16x16x32_bf16 v[28:31], v[192:195], v[224:227], v[28:31]
    v_mfma_f32_16x16x32_bf16 v[28:31], v[204:207], v[232:235], v[28:31]
    v_mfma_f32_16x16x32_bf16 v[28:31], v[212:215], v[240:243], v[28:31]
    v_mfma_f32_16x16x32_bf16 v[28:31], v[220:223], v[248:251], v[28:31]
    v_mfma_f32_16x16x32_bf16 v[28:31], v[96:99], v[224:227], v[28:31]
    v_mfma_f32_16x16x32_bf16 v[16:19], v[192:195], v[248:251], v[16:19]
    v_mfma_f32_16x16x32_bf16 v[16:19], v[96:99], v[248:251], v[16:19]
    s_waitcnt lgkmcnt(0)
    v_cmp_ne_u32 vcc, 1, v106
    s_cbranch_vccz L_got_52
    s_mov_b32 s70, 0
L_spin_53:
    ds_read_b32 v106, v104
    ds_read_b128 v[128:131], v14 offset:0
    ds_read_b128 v[188:191], v14 offset:4160
    ds_read_b128 v[176:179], v14 offset:8320
    ds_read_b128 v[180:183], v14 offset:12480
    s_waitcnt lgkmcnt(0)
    v_cmp_ne_u32 vcc, 1, v106
    s_cbranch_vccz L_spinok_54
    s_add_u32 s70, s70, 1
    s_cmp_le_u32 s70, 2560000
    s_cbranch_scc1 L_spin_53
L_spinok_54:
L_got_52:
    v_add_f32 v176, v32, v176
    v_add_f32 v177, v33, v177
    v_add_f32 v178, v34, v178
    v_add_f32 v179, v35, v179
    v_add_f32 v180, v44, v180
    v_add_f32 v181, v45, v181
    v_add_f32 v182, v46, v182
    v_add_f32 v183, v47, v183
    v_cvt_pk_bf16_f32 v100, v176, v177
    v_cvt_pk_bf16_f32 v102, v180, v181
    v_cvt_pk_bf16_f32 v101, v178, v179
    v_cvt_pk_bf16_f32 v103, v182, v183
    v_permlane16_swap_b32 v100, v102
    s_nop 0
    v_permlane16_swap_b32 v101, v103
    buffer_store_dwordx4 v[100:103], v12, s[8:11], s34 offen offset:2048 sc1
    v_add_f32 v128, v16, v128
    v_add_f32 v129, v17, v129
    v_add_f32 v130, v18, v130
    v_add_f32 v131, v19, v131
    v_add_f32 v188, v28, v188
    v_add_f32 v189, v29, v189
    v_add_f32 v190, v30, v190
    v_add_f32 v191, v31, v191
    v_cvt_pk_bf16_f32 v96, v128, v129
    v_cvt_pk_bf16_f32 v98, v188, v189
    v_cvt_pk_bf16_f32 v97, v130, v131
    v_cvt_pk_bf16_f32 v99, v190, v191
    v_permlane16_swap_b32 v96, v98
    s_nop 0
    v_permlane16_swap_b32 v97, v99
    buffer_store_dwordx4 v[96:99], v12, s[8:11], s34 offen offset:0 sc1
    s_branch L_xjoin_51
L_odd_50:
    s_nop 1
    v_mfma_f32_16x16x32_bf16 v[16:19], v[192:195], v[248:251], v[16:19]
    v_mfma_f32_16x16x32_bf16 v[28:31], v[192:195], v[224:227], v[28:31]
    v_mfma_f32_16x16x32_bf16 v[28:31], v[204:207], v[232:235], v[28:31]
    v_mfma_f32_16x16x32_bf16 v[28:31], v[212:215], v[240:243], v[28:31]
    v_mfma_f32_16x16x32_bf16 v[28:31], v[220:223], v[248:251], v[28:31]
    s_waitcnt lgkmcnt(9)
    v_mfma_f32_16x16x32_bf16 v[32:35], v[192:195], v[216:219], v[32:35]
    v_mfma_f32_16x16x32_bf16 v[32:35], v[204:207], v[224:227], v[32:35]
    v_mfma_f32_16x16x32_bf16 v[32:35], v[212:215], v[232:235], v[32:35]
    v_mfma_f32_16x16x32_bf16 v[32:35], v[220:223], v[240:243], v[32:35]
    v_mfma_f32_16x16x32_bf16 v[32:35], v[228:231], v[248:251], v[32:35]
    s_waitcnt lgkmcnt(0)
    v_mfma_f32_16x16x32_bf16 v[44:47], v[192:195], v[196:199], v[44:47]
    v_mfma_f32_16x16x32_bf16 v[44:47], v[204:207], v[200:203], v[44:47]
    v_mfma_f32_16x16x32_bf16 v[44:47], v[212:215], v[208:211], v[44:47]
    v_mfma_f32_16x16x32_bf16 v[44:47], v[220:223], v[216:219], v[44:47]
    v_mfma_f32_16x16x32_bf16 v[44:47], v[228:231], v[224:227], v[44:47]
    v_mfma_f32_16x16x32_bf16 v[44:47], v[236:239], v[232:235], v[44:47]
    v_mfma_f32_16x16x32_bf16 v[44:47], v[244:247], v[240:243], v[44:47]
    v_mfma_f32_16x16x32_bf16 v[44:47], v[252:255], v[248:251], v[44:47]
    v_mfma_f32_16x16x32_bf16 v[40:43], v[192:195], v[200:203], v[40:43]
    v_mfma_f32_16x16x32_bf16 v[40:43], v[204:207], v[208:211], v[40:43]
    ds_write_b128 v13, v[16:19] offset:0
    v_mfma_f32_16x16x32_bf16 v[40:43], v[212:215], v[216:219], v[40:43]
    v_mfma_f32_16x16x32_bf16 v[40:43], v[220:223], v[224:227], v[40:43]
    ds_write_b128 v13, v[28:31] offset:4160
    v_mfma_f32_16x16x32_bf16 v[40:43], v[228:231], v[232:235], v[40:43]
    v_mfma_f32_16x16x32_bf16 v[40:43], v[236:239], v[240:243], v[40:43]
    ds_write_b128 v13, v[32:35] offset:8320
    v_mfma_f32_16x16x32_bf16 v[40:43], v[244:247], v[248:251], v[40:43]
    v_mfma_f32_16x16x32_bf16 v[36:39], v[192:195], v[208:211], v[36:39]
    ds_write_b128 v13, v[44:47] offset:12480
    v_mfma_f32_16x16x32_bf16 v[36:39], v[204:207], v[216:219], v[36:39]
    ds_write_b32 v5, v105 offset:32
    v_mfma_f32_16x16x32_bf16 v[36:39], v[212:215], v[224:227], v[36:39]
    v_mfma_f32_16x16x32_bf16 v[36:39], v[220:223], v[232:235], v[36:39]
    ds_read_b32 v106, v104
    ds_read_b128 v[128:131], v14 offset:0
    ds_read_b128 v[188:191], v14 offset:4160
    ds_read_b128 v[176:179], v14 offset:8320
    ds_read_b128 v[180:183], v14 offset:12480
    v_mfma_f32_16x16x32_bf16 v[36:39], v[228:231], v[240:243], v[36:39]
    v_mfma_f32_16x16x32_bf16 v[36:39], v[236:239], v[248:251], v[36:39]
    v_mfma_f32_16x16x32_bf16 v[24:27], v[192:195], v[232:235], v[24:27]
    v_mfma_f32_16x16x32_bf16 v[24:27], v[204:207], v[240:243], v[24:27]
    v_mfma_f32_16x16x32_bf16 v[24:27], v[212:215], v[248:251], v[24:27]
    v_mfma_f32_16x16x32_bf16 v[20:23], v[192:195], v[240:243], v[20:23]
    v_mfma_f32_16x16x32_bf16 v[20:23], v[204:207], v[248:251], v[20:23]
    s_waitcnt lgkmcnt(0)
    v_cmp_ne_u32 vcc, 1, v106
    s_cbranch_vccz L_got_55
    s_mov_b32 s70, 0
L_spin_56:
    ds_read_b32 v106, v104
    ds_read_b128 v[128:131], v14 offset:0
    ds_read_b128 v[188:191], v14 offset:4160
    ds_read_b128 v[176:179], v14 offset:8320
    ds_read_b128 v[180:183], v14 offset:12480
    s_waitcnt lgkmcnt(0)
    v_cmp_ne_u32 vcc, 1, v106
    s_cbranch_vccz L_spinok_57
    s_add_u32 s70, s70, 1
    s_cmp_le_u32 s70, 2560000
    s_cbranch_scc1 L_spin_56
L_spinok_57:
L_got_55:
    v_add_f32 v176, v36, v176
    v_add_f32 v177, v37, v177
    v_add_f32 v178, v38, v178
    v_add_f32 v179, v39, v179
    v_add_f32 v180, v40, v180
    v_add_f32 v181, v41, v181
    v_add_f32 v182, v42, v182
    v_add_f32 v183, v43, v183
    v_cvt_pk_bf16_f32 v100, v176, v177
    v_cvt_pk_bf16_f32 v102, v180, v181
    v_cvt_pk_bf16_f32 v101, v178, v179
    v_cvt_pk_bf16_f32 v103, v182, v183
    v_permlane16_swap_b32 v100, v102
    s_nop 0
    v_permlane16_swap_b32 v101, v103
    buffer_store_dwordx4 v[100:103], v12, s[8:11], s34 offen offset:2560 sc1
    v_add_f32 v128, v20, v128
    v_add_f32 v129, v21, v129
    v_add_f32 v130, v22, v130
    v_add_f32 v131, v23, v131
    v_add_f32 v188, v24, v188
    v_add_f32 v189, v25, v189
    v_add_f32 v190, v26, v190
    v_add_f32 v191, v27, v191
    v_cvt_pk_bf16_f32 v96, v128, v129
    v_cvt_pk_bf16_f32 v98, v188, v189
    v_cvt_pk_bf16_f32 v97, v130, v131
    v_cvt_pk_bf16_f32 v99, v190, v191
    v_permlane16_swap_b32 v96, v98
    s_nop 0
    v_permlane16_swap_b32 v97, v99
    buffer_store_dwordx4 v[96:99], v12, s[8:11], s34 offen offset:512 sc1
L_xjoin_51:
    s_setprio 0
    v_lshrrev_b32 v13, 3, v0
    v_and_b32 v14, 7, v0
    v_lshlrev_b32 v6, 4, v14
    v_lshl_add_u32 v6, v13, 12, v6
    s_lshr_b32 s65, s55, 2
    s_lshr_b32 s66, s55, 3
    s_xor_b32 s65, s65, s66
    s_and_b32 s65, s65, 1
    s_lshl_b32 s65, s65, 15
    s_lshl_b32 s66, s56, 12
    s_add_u32 s65, s65, s66
    s_add_u32 s65, s65, s61
    s_add_u32 s65, s65, 131072
    v_bfe_u32 v8, v0, 1, 3
    v_and_b32 v9, 1, v0
    v_lshlrev_b32 v9, 2, v9
    v_lshl_add_u32 v8, v8, 7, v9
    v_add_u32 v8, s65, v8
    s_add_u32 s20, s8, s65
    s_addc_u32 s21, s9, 0
    s_mov_b32 s22, s47
    s_mov_b32 s23, s47
    s_lshl_b32 s44, s56, 18
    s_lshl_b32 s66, s48, 16
    s_add_u32 s44, s44, s66
    s_lshl_b32 s66, s55, 7
    s_add_u32 s44, s44, s66
    s_add_u32 s44, s44, 3145728
    s_add_u32 s45, s44, 32768
    s_mul_i32 s66, s48, 12320
    s_add_u32 s66, s66, 109568
    v_add_u32 v12, s66, v15
    v_lshlrev_b32 v9, 1, v14
    v_xor_b32 v9, v9, v13
    s_lshl_b32 s65, s48, 11
    s_add_u32 s65, s65, 33792
    v_lshlrev_b32 v44, 8, v13
    v_lshl_add_u32 v44, v9, 4, v44
    v_xor_b32 v45, 16, v44
    v_add_u32 v44, s65, v44
    v_add_u32 v45, s65, v45
    v_lshrrev_b32 v9, 1, v14
    v_mul_u32_u24 v30, 12288, v9
    v_and_b32 v9, 1, v14
    v_lshl_add_u32 v30, v9, 10, v30
    v_lshl_add_u32 v30, v14, 4, v30
    v_lshl_add_u32 v30, v13, 1, v30
    s_lshl_b32 s65, s48, 4
    s_add_u32 s65, s65, 109568
    v_add_u32 v30, s65, v30
    v_mov_b32 v13, 155136
    v_mov_b32 v31, 155184
    v_add_u32 v14, 16, v5
    s_waitcnt vmcnt(0)
    buffer_store_dword v10, v11, s[8:11], s71 offen sc1
    v_mov_b32 v160, 0
    v_mov_b32 v161, 0
    v_mov_b32 v162, 0
    v_mov_b32 v163, 0
    v_mov_b32 v164, 0
    v_mov_b32 v165, 0
    v_mov_b32 v166, 0
    v_mov_b32 v167, 0
    v_mov_b32 v168, 0
    v_mov_b32 v169, 0
    v_mov_b32 v170, 0
    v_mov_b32 v171, 0
    v_mov_b32 v172, 0
    v_mov_b32 v173, 0
    v_mov_b32 v174, 0
    v_mov_b32 v175, 0
    v_cmp_ne_u32 vcc, s47, v56
    v_cmp_ne_u32 s[68:69], s47, v60
    s_or_b64 vcc, vcc, s[68:69]
    s_cbranch_vccz L_ok_58
    s_mov_b32 s70, 0
L_poll_59:
    buffer_load_dwordx4 v[56:59], v108, s[8:11], s42 offen offset:0 sc1
    buffer_load_dwordx4 v[60:63], v108, s[8:11], s42 offen offset:512 sc1
    s_waitcnt vmcnt(0)
    v_cmp_ne_u32 vcc, s47, v56
    v_cmp_ne_u32 s[68:69], s47, v60
    s_or_b64 vcc, vcc, s[68:69]
    s_add_u32 s70, s70, 1
    s_cmp_gt_u32 s70, 40000
    s_cbranch_scc1 L_ok_58
    s_cbranch_vccnz L_poll_59
L_ok_58:
    v_lshlrev_b32 v128, 16, v48
    v_and_b32 v129, 0xffff0000, v48
    v_lshlrev_b32 v130, 16, v49
    v_and_b32 v131, 0xffff0000, v49
    v_lshlrev_b32 v132, 16, v50
    v_and_b32 v133, 0xffff0000, v50
    v_lshlrev_b32 v134, 16, v51
    v_and_b32 v135, 0xffff0000, v51
    v_mul_f32 v58, 0xbede652a, v58
    v_mul_f32 v59, v58, v58
    v_mul_f32 v58, v58, v59
    v_mul_f32 v26, 0xbfb8aa3b, v59
    v_mul_f32 v27, 0xbfb8aa3b, v59
    v_sub_f32 v144, v128, v57
    v_sub_f32 v145, v129, v57
    v_sub_f32 v146, v130, v57
    v_sub_f32 v147, v131, v57
    v_sub_f32 v148, v132, v57
    v_sub_f32 v149, v133, v57
    v_sub_f32 v150, v134, v57
    v_sub_f32 v151, v135, v57
    v_mul_f32 v144, v144, v58
    v_mul_f32 v145, v145, v58
    v_mul_f32 v146, v146, v58
    v_mul_f32 v147, v147, v58
    v_mul_f32 v148, v148, v58
    v_mul_f32 v149, v149, v58
    v_mul_f32 v150, v150, v58
    v_mul_f32 v151, v151, v58
    v_lshlrev_b32 v136, 16, v52
    v_and_b32 v137, 0xffff0000, v52
    v_lshlrev_b32 v138, 16, v53
    v_and_b32 v139, 0xffff0000, v53
    v_lshlrev_b32 v140, 16, v54
    v_and_b32 v141, 0xffff0000, v54
    v_lshlrev_b32 v142, 16, v55
    v_and_b32 v143, 0xffff0000, v55
    v_mul_f32 v62, 0xbede652a, v62
    v_mul_f32 v63, v62, v62
    v_mul_f32 v62, v62, v63
    v_mul_f32 v28, 0xbfb8aa3b, v63
    v_mul_f32 v29, 0xbfb8aa3b, v63
    v_sub_f32 v152, v136, v61
    v_sub_f32 v153, v137, v61
    v_sub_f32 v154, v138, v61
    v_sub_f32 v155, v139, v61
    v_sub_f32 v156, v140, v61
    v_sub_f32 v157, v141, v61
    v_sub_f32 v158, v142, v61
    v_sub_f32 v159, v143, v61
    v_mul_f32 v152, v152, v62
    v_mul_f32 v153, v153, v62
    v_mul_f32 v154, v154, v62
    v_mul_f32 v155, v155, v62
    v_mul_f32 v156, v156, v62
    v_mul_f32 v157, v157, v62
    v_mul_f32 v158, v158, v62
    v_mul_f32 v159, v159, v62
    v_mov_b32 v24, 1.0
    v_mov_b32 v25, 1.0
    s_mov_b32 s70, 0
L_spin_60:
    ds_read_b32 v40, v14
    s_waitcnt lgkmcnt(0)
    v_cmp_ne_u32 vcc, 1, v40
    s_cbranch_vccz L_spinok_61
    s_add_u32 s70, s70, 1
    s_cmp_le_u32 s70, 2560000
    s_cbranch_scc1 L_spin_60
L_spinok_61:
    s_setprio 2
    s_mov_b32 s70, 0
L_sp_62_0:
    s_load_dwordx2 s[24:25], s[20:21], 0 glc
L_sp_62_1:
    s_load_dwordx2 s[26:27], s[20:21], 128 glc
L_sp_62_2:
    s_load_dwordx2 s[28:29], s[20:21], 256 glc
L_sp_62_3:
    s_load_dwordx2 s[30:31], s[20:21], 384 glc
L_sp_62_4:
    s_load_dwordx2 s[32:33], s[20:21], 512 glc
L_sp_62_5:
    s_load_dwordx2 s[34:35], s[20:21], 640 glc
L_sp_62_6:
    s_load_dwordx2 s[36:37], s[20:21], 768 glc
L_sp_62_7:
    s_load_dwordx2 s[38:39], s[20:21], 896 glc
    s_add_u32 s70, s70, 1
    s_waitcnt lgkmcnt(0)
    s_cmp_gt_u32 s70, 40000
    s_cbranch_scc1 L_ok_63
    s_cmp_lg_u64 s[24:25], s[22:23]
    s_cbranch_scc1 L_sp_62_0
    s_cmp_lg_u64 s[26:27], s[22:23]
    s_cbranch_scc1 L_sp_62_1
    s_cmp_lg_u64 s[28:29], s[22:23]
    s_cbranch_scc1 L_sp_62_2
    s_cmp_lg_u64 s[30:31], s[22:23]
    s_cbranch_scc1 L_sp_62_3
    s_cmp_lg_u64 s[32:33], s[22:23]
    s_cbranch_scc1 L_sp_62_4
    s_cmp_lg_u64 s[34:35], s[22:23]
    s_cbranch_scc1 L_sp_62_5
    s_cmp_lg_u64 s[36:37], s[22:23]
    s_cbranch_scc1 L_sp_62_6
    s_cmp_lg_u64 s[38:39], s[22:23]
    s_cbranch_scc1 L_sp_62_7
L_ok_63:
    buffer_load_dwordx4 v[64:67], v6, s[8:11], s44 offen sc1
    buffer_load_dwordx4 v[68:71], v6, s[8:11], s45 offen sc1
    s_setprio 0
    s_mov_b32 s70, 0
L_spin_64:
    ds_read_b128 v[40:43], v13
    s_waitcnt lgkmcnt(0)
    v_and_b32 v40, v40, v41
    v_and_b32 v42, v42, v43
    v_and_b32 v40, v40, v42
    v_cmp_ne_u32 vcc, 1, v40
    s_cbranch_vccz L_spinok_65
    s_add_u32 s70, s70, 1
    s_cmp_le_u32 s70, 2560000
    s_cbranch_scc1 L_spin_64
L_spinok_65:
    s_setprio 2
    ds_read_b128 v[192:195], v44 offset:0
    ds_read_b128 v[196:199], v45 offset:0
    ds_read_b128 v[200:203], v44 offset:8192
    ds_read_b128 v[204:207], v45 offset:8192
    ds_read_b128 v[208:211], v44 offset:16384
    ds_read_b128 v[212:215], v45 offset:16384
    ds_read_b128 v[216:219], v44 offset:24576
    ds_read_b128 v[220:223], v45 offset:24576
    s_waitcnt lgkmcnt(4)
    v_add_f32 v176, v192, v200
    v_add_f32 v177, v193, v201
    v_add_f32 v178, v194, v202
    v_add_f32 v179, v195, v203
    v_add_f32 v180, v196, v204
    v_add_f32 v181, v197, v205
    v_add_f32 v182, v198, v206
    v_add_f32 v183, v199, v207
    s_waitcnt lgkmcnt(2)
    v_add_f32 v176, v176, v208
    v_add_f32 v177, v177, v209
    v_add_f32 v178, v178, v210
    v_add_f32 v179, v179, v211
    v_add_f32 v180, v180, v212
    v_add_f32 v181, v181, v213
    v_add_f32 v182, v182, v214
    v_add_f32 v183, v183, v215
    s_waitcnt lgkmcnt(0)
    v_add_f32 v176, v176, v216
    v_add_f32 v177, v177, v217
    v_add_f32 v178, v178, v218
    v_add_f32 v179, v179, v219
    v_add_f32 v180, v180, v220
    v_add_f32 v181, v181, v221
    v_add_f32 v182, v182, v222
    v_add_f32 v183, v183, v223
    v_mul_f32 v224, v176, v26
    v_mul_f32 v225, v177, v26
    v_mul_f32 v226, v178, v26
    v_mul_f32 v227, v179, v26
    v_mul_f32 v228, v180, v26
    v_mul_f32 v229, v181, v26
    v_mul_f32 v230, v182, v26
    v_mul_f32 v231, v183, v26
    v_exp_f32 v224, v224
    v_exp_f32 v225, v225
    v_exp_f32 v226, v226
    v_exp_f32 v227, v227
    v_exp_f32 v228, v228
    v_exp_f32 v229, v229
    v_exp_f32 v230, v230
    v_exp_f32 v231, v231
    v_mul_f32 v176, v176, v144
    v_mul_f32 v177, v177, v145
    v_mul_f32 v178, v178, v146
    v_mul_f32 v179, v179, v147
    v_mul_f32 v180, v180, v148
    v_mul_f32 v181, v181, v149
    v_mul_f32 v182, v182, v150
    v_mul_f32 v183, v183, v151
    v_add_f32 v224, v224, v24
    v_add_f32 v225, v225, v24
    v_add_f32 v226, v226, v24
    v_add_f32 v227, v227, v24
    v_add_f32 v228, v228, v24
    v_add_f32 v229, v229, v24
    v_add_f32 v230, v230, v24
    v_add_f32 v231, v231, v24
    v_rcp_f32 v224, v224
    v_rcp_f32 v225, v225
    v_rcp_f32 v226, v226
    v_rcp_f32 v227, v227
    v_rcp_f32 v228, v228
    v_rcp_f32 v229, v229
    v_rcp_f32 v230, v230
    v_rcp_f32 v231, v231
    v_mul_f32 v176, v176, v224
    v_mul_f32 v177, v177, v225
    v_mul_f32 v178, v178, v226
    v_mul_f32 v179, v179, v227
    v_mul_f32 v180, v180, v228
    v_mul_f32 v181, v181, v229
    v_mul_f32 v182, v182, v230
    v_mul_f32 v183, v183, v231
    s_waitcnt vmcnt(0)
    ds_write_b128 v12, v[64:67] offset:0
    ds_write_b128 v12, v[68:71] offset:1040
    s_waitcnt lgkmcnt(0)
    s_barrier
    ds_read_b128 v[192:195], v44 offset:33792
    ds_read_b128 v[196:199], v45 offset:33792
    ds_read_b128 v[200:203], v44 offset:41984
    ds_read_b128 v[204:207], v45 offset:41984
    ds_read_b128 v[208:211], v44 offset:50176
    ds_read_b128 v[212:215], v45 offset:50176
    ds_read_b128 v[216:219], v44 offset:58368
    ds_read_b128 v[220:223], v45 offset:58368
    s_cmp_lg_u32 s2, 255
    s_cbranch_scc1 L_noepoch_66
    buffer_store_dword v10, v11, s[8:11], 0 offen sc1
L_noepoch_66:
    ds_read_u16_d16_hi v160, v30 offset:0
    ds_read_u16_d16_hi v161, v30 offset:128
    ds_read_u16_d16_hi v162, v30 offset:256
    ds_read_u16_d16_hi v163, v30 offset:384
    ds_read_u16_d16_hi v164, v30 offset:512
    ds_read_u16_d16_hi v165, v30 offset:640
    ds_read_u16_d16_hi v166, v30 offset:768
    s_waitcnt lgkmcnt(11)
    ds_read_u16_d16_hi v167, v30 offset:896
    ds_read_u16_d16_hi v168, v30 offset:64
    ds_read_u16_d16_hi v169, v30 offset:192
    ds_read_u16_d16_hi v170, v30 offset:320
    s_waitcnt lgkmcnt(11)
    ds_read_u16_d16_hi v171, v30 offset:448
    ds_read_u16_d16_hi v172, v30 offset:576
    ds_read_u16_d16_hi v173, v30 offset:704
    ds_read_u16_d16_hi v174, v30 offset:832
    s_waitcnt lgkmcnt(11)
    ds_read_u16_d16_hi v175, v30 offset:960
    v_pk_add_f32 v[184:185], v[192:193], v[200:201]
    v_pk_add_f32 v[186:187], v[194:195], v[202:203]
    v_pk_add_f32 v[188:189], v[196:197], v[204:205]
    v_pk_add_f32 v[190:191], v[198:199], v[206:207]
    v_pk_add_f32 v[184:185], v[184:185], v[208:209]
    v_pk_add_f32 v[186:187], v[186:187], v[210:211]
    v_pk_add_f32 v[188:189], v[188:189], v[212:213]
    v_pk_add_f32 v[190:191], v[190:191], v[214:215]
    v_pk_add_f32 v[184:185], v[184:185], v[216:217]
    v_pk_add_f32 v[186:187], v[186:187], v[218:219]
    v_pk_add_f32 v[188:189], v[188:189], v[220:221]
    v_pk_add_f32 v[190:191], v[190:191], v[222:223]
    v_pk_mul_f32 v[224:225], v[184:185], v[28:29]
    v_pk_mul_f32 v[226:227], v[186:187], v[28:29]
    v_pk_mul_f32 v[228:229], v[188:189], v[28:29]
    v_pk_mul_f32 v[230:231], v[190:191], v[28:29]
    v_exp_f32 v224, v224
    v_exp_f32 v225, v225
    v_exp_f32 v226, v226
    v_exp_f32 v227, v227
    v_exp_f32 v228, v228
    v_exp_f32 v229, v229
    v_exp_f32 v230, v230
    v_exp_f32 v231, v231
    v_pk_mul_f32 v[184:185], v[184:185], v[152:153]
    v_pk_mul_f32 v[186:187], v[186:187], v[154:155]
    v_pk_mul_f32 v[188:189], v[188:189], v[156:157]
    v_pk_mul_f32 v[190:191], v[190:191], v[158:159]
    v_pk_add_f32 v[224:225], v[224:225], v[24:25]
    v_pk_add_f32 v[226:227], v[226:227], v[24:25]
    v_pk_add_f32 v[228:229], v[228:229], v[24:25]
    v_pk_add_f32 v[230:231], v[230:231], v[24:25]
    v_rcp_f32 v224, v224
    v_rcp_f32 v225, v225
    v_rcp_f32 v226, v226
    v_rcp_f32 v227, v227
    v_rcp_f32 v228, v228
    v_rcp_f32 v229, v229
    v_rcp_f32 v230, v230
    v_rcp_f32 v231, v231
    s_waitcnt lgkmcnt(0)
    v_pk_fma_f32 v[176:177], v[176:177], v[160:161], v[128:129]
    v_pk_fma_f32 v[178:179], v[178:179], v[162:163], v[130:131]
    v_pk_fma_f32 v[180:181], v[180:181], v[164:165], v[132:133]
    v_pk_fma_f32 v[182:183], v[182:183], v[166:167], v[134:135]
    v_cvt_pk_bf16_f32 v32, v176, v177
    v_cvt_pk_bf16_f32 v33, v178, v179
    v_cvt_pk_bf16_f32 v34, v180, v181
    v_cvt_pk_bf16_f32 v35, v182, v183
    buffer_store_dwordx4 v[32:35], v107, s[16:19], s40 offen sc1
    v_pk_mul_f32 v[184:185], v[184:185], v[168:169]
    v_pk_mul_f32 v[186:187], v[186:187], v[170:171]
    v_pk_mul_f32 v[188:189], v[188:189], v[172:173]
    v_pk_mul_f32 v[190:191], v[190:191], v[174:175]
    v_pk_fma_f32 v[184:185], v[184:185], v[224:225], v[136:137]
    v_pk_fma_f32 v[186:187], v[186:187], v[226:227], v[138:139]
    v_pk_fma_f32 v[188:189], v[188:189], v[228:229], v[140:141]
    v_pk_fma_f32 v[190:191], v[190:191], v[230:231], v[142:143]
    v_cvt_pk_bf16_f32 v36, v184, v185
    v_cvt_pk_bf16_f32 v37, v186, v187
    v_cvt_pk_bf16_f32 v38, v188, v189
    v_cvt_pk_bf16_f32 v39, v190, v191
    buffer_store_dwordx4 v[36:39], v107, s[16:19], s41 offen sc1
    s_endpgm
L_code_end:
.section .rodata,"a"
.p2align 6
.amdhsa_kernel recurrent_scan__ssm_conv_h3__glu_gated_geglu__prompt_kernel
  .amdhsa_next_free_vgpr 256
  .amdhsa_next_free_sgpr 102
  .amdhsa_accum_offset 256
  .amdhsa_group_segment_fixed_size 0
  .amdhsa_kernarg_size 104
  .amdhsa_user_sgpr_count 2
  .amdhsa_user_sgpr_kernarg_segment_ptr 1
  .amdhsa_system_sgpr_workgroup_id_x 1
  .amdhsa_float_denorm_mode_32 3
.end_amdhsa_kernel
```
